```python
import torch

def _softmax(x, axis=-1):
    return torch.softmax(x, dim=axis)
def _gelu(x):
    return torch.nn.functional.gelu(x, approximate="tanh")
def _silu(x):
    return torch.nn.functional.silu(x)
def _sigmoid(x):
    return torch.sigmoid(x)
def _layernorm(x, axis=-1, eps=1e-5):
    m = x.mean(dim=axis, keepdim=True)
    v = x.var(dim=axis, keepdim=True, unbiased=False)
    return (x - m) / torch.sqrt(v + eps)
def _scatter_add(tgt, idx, src, axis=0):
    return tgt.clone().index_add_(axis, idx, src)
def _segment_sum(src, seg, n):
    out = torch.zeros((n,) + src.shape[1:], dtype=src.dtype)
    return out.index_add_(0, seg, src)
def _pad(x, pw):
    flat = tuple(v for pair in reversed(pw) for v in pair)
    return torch.nn.functional.pad(x, flat)

kernel_name = 'recurrent_scan__sliding_block__glu_gated_swiglu__prompt'

def setup_inputs():

    _w = (lambda a: (lambda t: t.to(torch.bfloat16) if t.is_floating_point() else t)(torch.as_tensor(a)))
    def _A_setup():
        B, S, D = 1, 2048, 512
        return {
            "x": _w((lambda *s: torch.randn(*s, dtype=torch.bfloat16) * 0.05)(B, S, D)),
            "wqkv": _w((lambda *s: torch.randn(*s, dtype=torch.bfloat16) * 0.2)(D, 3 * D)),
            "wo": _w((lambda *s: torch.randn(*s, dtype=torch.bfloat16) * 0.2)(D, D)),
        }
    _A_in = _A_setup()

    def _B_setup():
        B, S, D, F = 1, 2048, 512, 1376
        return {
            "x": _w((lambda *s: torch.randn(*s, dtype=torch.bfloat16) * 0.05)(B, S, D)),
            "w1": _w((lambda *s: torch.randn(*s, dtype=torch.bfloat16) * 0.1)(D, F) * (2.0 / D) ** 0.5),
            "w3": _w((lambda *s: torch.randn(*s, dtype=torch.bfloat16) * 0.1)(D, F) * (2.0 / D) ** 0.5),
            "w2": _w((lambda *s: torch.randn(*s, dtype=torch.bfloat16) * 0.1)(F, D) * (2.0 / F) ** 0.5),
        }
    _B_in = _B_setup()

    return {
        "A_x": _A_in["x"],
        "A_wqkv": _A_in["wqkv"],
        "A_wo": _A_in["wo"],
        "B_x": _B_in["x"],
        "B_w1": _B_in["w1"],
        "B_w3": _B_in["w3"],
        "B_w2": _B_in["w2"],
    }

def reference(A_x, A_wqkv, A_wo, B_x, B_w1, B_w3, B_w2):
    def _A_ref(x, wqkv, wo):
        B, S, D = x.shape
        H = 32; Dh = D // H; W = 256
        qkv = (lambda x, *d: x.permute(*d))((x @ wqkv).reshape(B, S, 3, H, Dh), 2, 0, 3, 1, 4)
        q, k, v = qkv[0], qkv[1], qkv[2]
        scores = torch.einsum("bhqd,bhkd->bhqk", q, k) * (Dh ** -0.5)
        idx = torch.arange(S)
        mask = (idx[:, None] - idx[None, :] >= 0) & (idx[:, None] - idx[None, :] < W)
        scores = torch.where(mask[None, None], scores, -1e9)
        p = _softmax(scores, axis=-1)
        o = torch.einsum("bhqk,bhkd->bhqd", p, v)
        return (lambda x, *d: x.permute(*d))(o, 0, 2, 1, 3).reshape(B, S, D) @ wo

    def _B_ref(x, w1, w3, w2):
        gate = torch.einsum("bsd,df->bsf", x, w1)
        up = torch.einsum("bsd,df->bsf", x, w3)
        h = _silu(gate) * up
        out = torch.einsum("bsf,fd->bsd", h, w2)
        return out

    x = A_x
    xn = _layernorm(x, axis=-1)
    s = _A_ref(xn, A_wqkv, A_wo)
    g = _silu(_B_ref(xn, B_w1, B_w3, B_w2))
    return x + s * g
```

```asm
; @launch kernel=k0_ln_kernel grid=(256,1,1) block=(256,1,1) lds=0
; @launch kernel=k1_proj_kernel grid=(256,1,1) block=(256,1,1) lds=148480
; @launch kernel=k2_attn_kernel grid=(512,1,1) block=(256,1,1) lds=0
; @launch kernel=k3_out_kernel grid=(256,1,1) block=(256,1,1) lds=163840
.amdgcn_target "amdgcn-amd-amdhsa--gfx950"
.text
.globl k0_ln_kernel
.p2align 8
.type k0_ln_kernel,@function
k0_ln_kernel:
    s_cmp_ge_u32 s2, 256
    s_cbranch_scc1 L_k0_end
    s_load_dwordx2 s[4:5], s[0:1], 0
    s_load_dwordx2 s[6:7], s[0:1], 72
    v_and_b32 v1, 31, v0
    v_lshrrev_b32 v2, 5, v0
    v_lshl_add_u32 v2, s2, 3, v2
    v_lshlrev_b32 v3, 10, v2
    v_lshl_add_u32 v3, v1, 4, v3
    s_waitcnt lgkmcnt(0)
    s_mov_b32 s8, s4
    s_mov_b32 s9, s5
    s_mov_b32 s10, 2097152
    s_mov_b32 s11, 0x00020000
    s_mov_b32 s12, s6
    s_mov_b32 s13, s7
    s_mov_b32 s14, 2097152
    s_mov_b32 s15, 0x00020000
    buffer_load_dwordx4 v[8:11], v3, s[8:11], 0 offen
    buffer_load_dwordx4 v[12:15], v3, s[8:11], 0 offen offset:512
    v_mov_b32 v4, 0x3f803f80
    v_mov_b32 v5, 0
    s_waitcnt vmcnt(0)
    v_dot2_f32_bf16 v5, v8, v4, v5
    v_dot2_f32_bf16 v5, v9, v4, v5
    v_dot2_f32_bf16 v5, v10, v4, v5
    v_dot2_f32_bf16 v5, v11, v4, v5
    v_dot2_f32_bf16 v5, v12, v4, v5
    v_dot2_f32_bf16 v5, v13, v4, v5
    v_dot2_f32_bf16 v5, v14, v4, v5
    v_dot2_f32_bf16 v5, v15, v4, v5
    s_nop 2
    v_add_f32_dpp v5, v5, v5 row_ror:8 row_mask:0xf bank_mask:0xf
    s_nop 1
    v_add_f32_dpp v5, v5, v5 row_ror:4 row_mask:0xf bank_mask:0xf
    s_nop 1
    v_add_f32_dpp v5, v5, v5 row_ror:2 row_mask:0xf bank_mask:0xf
    s_nop 1
    v_add_f32_dpp v5, v5, v5 row_ror:1 row_mask:0xf bank_mask:0xf
    v_mov_b32 v6, v5
    s_nop 1
    v_permlane16_swap_b32 v5, v6
    v_add_f32 v5, v5, v6
    v_mul_f32 v5, 0x3b000000, v5
    v_mov_b32 v6, 0
    v_lshlrev_b32 v16, 16, v8
    v_and_b32 v17, 0xffff0000, v8
    v_sub_f32 v32, v16, v5
    v_sub_f32 v33, v17, v5
    v_fmac_f32 v6, v32, v32
    v_fmac_f32 v6, v33, v33
    v_lshlrev_b32 v18, 16, v9
    v_and_b32 v19, 0xffff0000, v9
    v_sub_f32 v32, v18, v5
    v_sub_f32 v33, v19, v5
    v_fmac_f32 v6, v32, v32
    v_fmac_f32 v6, v33, v33
    v_lshlrev_b32 v20, 16, v10
    v_and_b32 v21, 0xffff0000, v10
    v_sub_f32 v32, v20, v5
    v_sub_f32 v33, v21, v5
    v_fmac_f32 v6, v32, v32
    v_fmac_f32 v6, v33, v33
    v_lshlrev_b32 v22, 16, v11
    v_and_b32 v23, 0xffff0000, v11
    v_sub_f32 v32, v22, v5
    v_sub_f32 v33, v23, v5
    v_fmac_f32 v6, v32, v32
    v_fmac_f32 v6, v33, v33
    v_lshlrev_b32 v24, 16, v12
    v_and_b32 v25, 0xffff0000, v12
    v_sub_f32 v32, v24, v5
    v_sub_f32 v33, v25, v5
    v_fmac_f32 v6, v32, v32
    v_fmac_f32 v6, v33, v33
    v_lshlrev_b32 v26, 16, v13
    v_and_b32 v27, 0xffff0000, v13
    v_sub_f32 v32, v26, v5
    v_sub_f32 v33, v27, v5
    v_fmac_f32 v6, v32, v32
    v_fmac_f32 v6, v33, v33
    v_lshlrev_b32 v28, 16, v14
    v_and_b32 v29, 0xffff0000, v14
    v_sub_f32 v32, v28, v5
    v_sub_f32 v33, v29, v5
    v_fmac_f32 v6, v32, v32
    v_fmac_f32 v6, v33, v33
    v_lshlrev_b32 v30, 16, v15
    v_and_b32 v31, 0xffff0000, v15
    v_sub_f32 v32, v30, v5
    v_sub_f32 v33, v31, v5
    v_fmac_f32 v6, v32, v32
    v_fmac_f32 v6, v33, v33
    s_nop 1
    v_add_f32_dpp v6, v6, v6 row_ror:8 row_mask:0xf bank_mask:0xf
    s_nop 1
    v_add_f32_dpp v6, v6, v6 row_ror:4 row_mask:0xf bank_mask:0xf
    s_nop 1
    v_add_f32_dpp v6, v6, v6 row_ror:2 row_mask:0xf bank_mask:0xf
    s_nop 1
    v_add_f32_dpp v6, v6, v6 row_ror:1 row_mask:0xf bank_mask:0xf
    v_mov_b32 v7, v6
    s_nop 1
    v_permlane16_swap_b32 v6, v7
    v_add_f32 v6, v6, v7
    v_mul_f32 v6, 0x3b000000, v6
    v_cvt_pk_bf16_f32 v7, v5, v6
    v_lshlrev_b32 v5, 16, v7
    v_and_b32 v6, 0xffff0000, v7
    v_add_f32 v6, 0x3727c5ac, v6
    v_cvt_pk_bf16_f32 v7, v6, v6
    v_lshlrev_b32 v6, 16, v7
    v_sqrt_f32 v6, v6
    s_nop 0
    v_cvt_pk_bf16_f32 v7, v6, v6
    v_lshlrev_b32 v6, 16, v7
    v_rcp_f32 v7, v6
    v_sub_f32 v32, v16, v5
    v_sub_f32 v33, v17, v5
    v_cvt_pk_bf16_f32 v34, v32, v33
    v_lshlrev_b32 v32, 16, v34
    v_and_b32 v33, 0xffff0000, v34
    v_mul_f32 v34, v32, v7
    v_mul_f32 v35, v33, v7
    v_fma_f32 v36, -v34, v6, v32
    v_fma_f32 v37, -v35, v6, v33
    v_fma_f32 v34, v36, v7, v34
    v_fma_f32 v35, v37, v7, v35
    v_cvt_pk_bf16_f32 v8, v34, v35
    v_sub_f32 v32, v18, v5
    v_sub_f32 v33, v19, v5
    v_cvt_pk_bf16_f32 v34, v32, v33
    v_lshlrev_b32 v32, 16, v34
    v_and_b32 v33, 0xffff0000, v34
    v_mul_f32 v34, v32, v7
    v_mul_f32 v35, v33, v7
    v_fma_f32 v36, -v34, v6, v32
    v_fma_f32 v37, -v35, v6, v33
    v_fma_f32 v34, v36, v7, v34
    v_fma_f32 v35, v37, v7, v35
    v_cvt_pk_bf16_f32 v9, v34, v35
    v_sub_f32 v32, v20, v5
    v_sub_f32 v33, v21, v5
    v_cvt_pk_bf16_f32 v34, v32, v33
    v_lshlrev_b32 v32, 16, v34
    v_and_b32 v33, 0xffff0000, v34
    v_mul_f32 v34, v32, v7
    v_mul_f32 v35, v33, v7
    v_fma_f32 v36, -v34, v6, v32
    v_fma_f32 v37, -v35, v6, v33
    v_fma_f32 v34, v36, v7, v34
    v_fma_f32 v35, v37, v7, v35
    v_cvt_pk_bf16_f32 v10, v34, v35
    v_sub_f32 v32, v22, v5
    v_sub_f32 v33, v23, v5
    v_cvt_pk_bf16_f32 v34, v32, v33
    v_lshlrev_b32 v32, 16, v34
    v_and_b32 v33, 0xffff0000, v34
    v_mul_f32 v34, v32, v7
    v_mul_f32 v35, v33, v7
    v_fma_f32 v36, -v34, v6, v32
    v_fma_f32 v37, -v35, v6, v33
    v_fma_f32 v34, v36, v7, v34
    v_fma_f32 v35, v37, v7, v35
    v_cvt_pk_bf16_f32 v11, v34, v35
    v_sub_f32 v32, v24, v5
    v_sub_f32 v33, v25, v5
    v_cvt_pk_bf16_f32 v34, v32, v33
    v_lshlrev_b32 v32, 16, v34
    v_and_b32 v33, 0xffff0000, v34
    v_mul_f32 v34, v32, v7
    v_mul_f32 v35, v33, v7
    v_fma_f32 v36, -v34, v6, v32
    v_fma_f32 v37, -v35, v6, v33
    v_fma_f32 v34, v36, v7, v34
    v_fma_f32 v35, v37, v7, v35
    v_cvt_pk_bf16_f32 v12, v34, v35
    v_sub_f32 v32, v26, v5
    v_sub_f32 v33, v27, v5
    v_cvt_pk_bf16_f32 v34, v32, v33
    v_lshlrev_b32 v32, 16, v34
    v_and_b32 v33, 0xffff0000, v34
    v_mul_f32 v34, v32, v7
    v_mul_f32 v35, v33, v7
    v_fma_f32 v36, -v34, v6, v32
    v_fma_f32 v37, -v35, v6, v33
    v_fma_f32 v34, v36, v7, v34
    v_fma_f32 v35, v37, v7, v35
    v_cvt_pk_bf16_f32 v13, v34, v35
    v_sub_f32 v32, v28, v5
    v_sub_f32 v33, v29, v5
    v_cvt_pk_bf16_f32 v34, v32, v33
    v_lshlrev_b32 v32, 16, v34
    v_and_b32 v33, 0xffff0000, v34
    v_mul_f32 v34, v32, v7
    v_mul_f32 v35, v33, v7
    v_fma_f32 v36, -v34, v6, v32
    v_fma_f32 v37, -v35, v6, v33
    v_fma_f32 v34, v36, v7, v34
    v_fma_f32 v35, v37, v7, v35
    v_cvt_pk_bf16_f32 v14, v34, v35
    v_sub_f32 v32, v30, v5
    v_sub_f32 v33, v31, v5
    v_cvt_pk_bf16_f32 v34, v32, v33
    v_lshlrev_b32 v32, 16, v34
    v_and_b32 v33, 0xffff0000, v34
    v_mul_f32 v34, v32, v7
    v_mul_f32 v35, v33, v7
    v_fma_f32 v36, -v34, v6, v32
    v_fma_f32 v37, -v35, v6, v33
    v_fma_f32 v34, v36, v7, v34
    v_fma_f32 v35, v37, v7, v35
    v_cvt_pk_bf16_f32 v15, v34, v35
    v_lshrrev_b32 v16, 1, v1
    v_lshlrev_b32 v16, 16, v16
    v_and_b32 v17, 1, v1
    v_lshl_add_u32 v16, v17, 4, v16
    v_lshl_add_u32 v16, v2, 5, v16
    buffer_store_dwordx4 v[8:11], v16, s[12:15], 0 offen
    s_nop 1
    v_add_u32 v16, 1048576, v16
    buffer_store_dwordx4 v[12:15], v16, s[12:15], 0 offen
    s_waitcnt vmcnt(0)
    s_nop 0
L_k0_end:
    s_endpgm
.globl k1_proj_kernel
.p2align 8
.type k1_proj_kernel,@function
k1_proj_kernel:
    s_cmp_ge_u32 s2, 256
    s_cbranch_scc1 L_k1_end
    s_load_dwordx2 s[4:5], s[0:1], 8
    s_load_dwordx2 s[6:7], s[0:1], 32
    s_load_dwordx2 s[8:9], s[0:1], 40
    s_load_dwordx2 s[10:11], s[0:1], 72
    s_and_b32 s3, s2, 7
    s_lshr_b32 s36, s2, 3
    s_and_b32 s12, s3, 3
    s_lshl_b32 s12, s12, 2
    s_and_b32 s37, s36, 3
    s_add_u32 s12, s12, s37
    s_lshr_b32 s13, s3, 2
    s_lshl_b32 s13, s13, 3
    s_lshr_b32 s37, s36, 2
    s_add_u32 s13, s13, s37
    v_and_b32 v1, 63, v0
    v_lshrrev_b32 v2, 6, v0
    s_nop 0
    v_readfirstlane_b32 s14, v2
    v_and_b32 v3, 31, v1
    v_lshrrev_b32 v4, 5, v1
    s_lshl_b32 s15, s13, 7
    s_lshl_b32 s37, s14, 5
    s_add_u32 s15, s15, s37
    v_add_u32 v5, s15, v3
    v_lshlrev_b32 v5, 5, v5
    v_lshl_add_u32 v5, v4, 4, v5
    s_waitcnt lgkmcnt(0)
    s_mov_b32 s16, s10
    s_mov_b32 s17, s11
    s_mov_b32 s18, 2097152
    s_mov_b32 s19, 0x00020000
    s_lshl_b32 s38, s14, 10
    v_lshrrev_b32 v6, 4, v1
    v_and_b32 v6, 1, v6
    v_lshrrev_b32 v7, 2, v1
    v_and_b32 v7, 3, v7
    v_and_b32 v8, 3, v1
    v_lshlrev_b32 v9, 1, v8
    v_and_b32 v9, 2, v9
    v_lshrrev_b32 v10, 1, v8
    v_or_b32 v9, v9, v10
    v_lshl_add_u32 v10, v4, 3, v7
    s_cmp_ge_u32 s12, 6
    s_nop 0
    s_cbranch_scc1 L_k1_f
    s_cmp_ge_u32 s12, 4
    s_cbranch_scc1 L_k1_v
    s_and_b32 s39, s12, 1
    s_lshl_b32 s42, s39, 9
    s_cmp_ge_u32 s12, 2
    s_cselect_b32 s40, 1024, 0
    s_add_u32 s42, s42, s40
    s_mov_b32 s20, s4
    s_mov_b32 s21, s5
    s_mov_b32 s22, 1572864
    s_mov_b32 s23, 0x00020000
    v_lshl_add_u32 v204, s14, 6, v1
    v_mul_u32_u24 v205, 1928, v204
    v_lshrrev_b32 v205, 16, v205
    v_mul_u32_u24 v206, 34, v205
    v_sub_u32 v206, v204, v206
    v_mul_u32_u24 v205, 3072, v205
    v_lshl_add_u32 v205, v206, 4, v205
    v_add_u32 v199, s42, v205
    v_lshl_add_u32 v204, s14, 6, v1
    v_add_u32 v204, 256, v204
    v_mul_u32_u24 v205, 1928, v204
    v_lshrrev_b32 v205, 16, v205
    v_mul_u32_u24 v206, 34, v205
    v_sub_u32 v206, v204, v206
    v_mul_u32_u24 v205, 3072, v205
    v_lshl_add_u32 v205, v206, 4, v205
    v_add_u32 v200, s42, v205
    v_lshl_add_u32 v204, s14, 6, v1
    v_add_u32 v204, 512, v204
    v_mul_u32_u24 v205, 1928, v204
    v_lshrrev_b32 v205, 16, v205
    v_mul_u32_u24 v206, 34, v205
    v_sub_u32 v206, v204, v206
    v_mul_u32_u24 v205, 3072, v205
    v_lshl_add_u32 v205, v206, 4, v205
    v_add_u32 v201, s42, v205
    v_lshl_add_u32 v204, s14, 6, v1
    v_add_u32 v204, 768, v204
    v_mul_u32_u24 v205, 1928, v204
    v_lshrrev_b32 v205, 16, v205
    v_mul_u32_u24 v206, 34, v205
    v_sub_u32 v206, v204, v206
    v_mul_u32_u24 v205, 3072, v205
    v_lshl_add_u32 v205, v206, 4, v205
    v_add_u32 v202, s42, v205
    v_add_u32 v204, 1024, v1
    v_mul_u32_u24 v205, 1928, v204
    v_lshrrev_b32 v205, 16, v205
    v_mul_u32_u24 v206, 34, v205
    v_sub_u32 v206, v204, v206
    v_mul_u32_u24 v205, 3072, v205
    v_lshl_add_u32 v205, v206, 4, v205
    v_add_u32 v203, s42, v205
    v_mul_u32_u24 v196, 544, v10
    v_lshl_add_u32 v196, v9, 3, v196
    v_mul_u32_u24 v204, 128, v6
    v_add_u32 v196, v196, v204
    s_mov_b32 s37, 0
    buffer_load_dwordx4 a[0:3], v5, s[16:19], s37 offen
    s_mov_b32 s37, 65536
    buffer_load_dwordx4 a[4:7], v5, s[16:19], s37 offen
    s_mov_b32 s44, 0
    s_cmp_ge_u32 s14, 1
    s_cbranch_scc1 L_k1_qk_dskip0
    s_mov_b32 m0, 16384
    s_nop 1
    buffer_load_dwordx4 v203, s[20:23], s44 offen lds
L_k1_qk_dskip0:
    s_nop 0
    s_add_u32 m0, s38, 0
    s_nop 0
    buffer_load_dwordx4 v199, s[20:23], s44 offen lds
    s_add_u32 m0, s38, 4096
    s_nop 0
    buffer_load_dwordx4 v200, s[20:23], s44 offen lds
    s_add_u32 m0, s38, 8192
    s_nop 0
    buffer_load_dwordx4 v201, s[20:23], s44 offen lds
    s_add_u32 m0, s38, 12288
    s_nop 0
    buffer_load_dwordx4 v202, s[20:23], s44 offen lds
    s_mov_b32 s37, 131072
    buffer_load_dwordx4 a[8:11], v5, s[16:19], s37 offen
    s_mov_b32 s37, 196608
    buffer_load_dwordx4 a[12:15], v5, s[16:19], s37 offen
    s_mov_b32 s44, 98304
    s_cmp_ge_u32 s14, 1
    s_cbranch_scc1 L_k1_qk_dskip1
    s_mov_b32 m0, 33792
    s_nop 1
    buffer_load_dwordx4 v203, s[20:23], s44 offen lds
L_k1_qk_dskip1:
    s_nop 0
    s_add_u32 m0, s38, 17408
    s_nop 0
    buffer_load_dwordx4 v199, s[20:23], s44 offen lds
    s_add_u32 m0, s38, 21504
    s_nop 0
    buffer_load_dwordx4 v200, s[20:23], s44 offen lds
    s_add_u32 m0, s38, 25600
    s_nop 0
    buffer_load_dwordx4 v201, s[20:23], s44 offen lds
    s_add_u32 m0, s38, 29696
    s_nop 0
    buffer_load_dwordx4 v202, s[20:23], s44 offen lds
    s_waitcnt vmcnt(6)
    s_barrier
    s_mov_b32 s37, 262144
    buffer_load_dwordx4 a[16:19], v5, s[16:19], s37 offen
    s_mov_b32 s37, 327680
    buffer_load_dwordx4 a[20:23], v5, s[16:19], s37 offen
    s_mov_b32 s44, 196608
    s_cmp_ge_u32 s14, 1
    s_cbranch_scc1 L_k1_qk_dskip2
    s_mov_b32 m0, 51200
    s_nop 1
    buffer_load_dwordx4 v203, s[20:23], s44 offen lds
L_k1_qk_dskip2:
    s_nop 0
    s_add_u32 m0, s38, 34816
    s_nop 0
    buffer_load_dwordx4 v199, s[20:23], s44 offen lds
    s_add_u32 m0, s38, 38912
    s_nop 0
    buffer_load_dwordx4 v200, s[20:23], s44 offen lds
    s_add_u32 m0, s38, 43008
    s_nop 0
    buffer_load_dwordx4 v201, s[20:23], s44 offen lds
    s_add_u32 m0, s38, 47104
    s_nop 0
    buffer_load_dwordx4 v202, s[20:23], s44 offen lds
    s_mov_b32 s37, 393216
    buffer_load_dwordx4 a[24:27], v5, s[16:19], s37 offen
    s_mov_b32 s37, 458752
    buffer_load_dwordx4 a[28:31], v5, s[16:19], s37 offen
    s_mov_b32 s44, 294912
    s_cmp_ge_u32 s14, 1
    s_cbranch_scc1 L_k1_qk_dskip3
    s_mov_b32 m0, 68608
    s_nop 1
    buffer_load_dwordx4 v203, s[20:23], s44 offen lds
L_k1_qk_dskip3:
    s_nop 0
    s_add_u32 m0, s38, 52224
    s_nop 0
    buffer_load_dwordx4 v199, s[20:23], s44 offen lds
    s_add_u32 m0, s38, 56320
    s_nop 0
    buffer_load_dwordx4 v200, s[20:23], s44 offen lds
    s_add_u32 m0, s38, 60416
    s_nop 0
    buffer_load_dwordx4 v201, s[20:23], s44 offen lds
    s_add_u32 m0, s38, 64512
    s_nop 0
    buffer_load_dwordx4 v202, s[20:23], s44 offen lds
    v_add_u32 v197, 0, v196
    ds_read_b64_tr_b16 v[168:169], v197 offset:0
    ds_read_b64_tr_b16 v[170:171], v197 offset:2176
    ds_read_b64_tr_b16 v[172:173], v197 offset:32
    ds_read_b64_tr_b16 v[174:175], v197 offset:2208
    ds_read_b64_tr_b16 v[176:177], v197 offset:64
    ds_read_b64_tr_b16 v[178:179], v197 offset:2240
    ds_read_b64_tr_b16 v[180:181], v197 offset:96
    ds_read_b64_tr_b16 v[182:183], v197 offset:2272
    ds_read_b64_tr_b16 v[184:185], v197 offset:256
    ds_read_b64_tr_b16 v[186:187], v197 offset:2432
    ds_read_b64_tr_b16 v[188:189], v197 offset:288
    ds_read_b64_tr_b16 v[190:191], v197 offset:2464
    s_waitcnt lgkmcnt(10)
    v_mfma_f32_32x32x16_bf16 v[40:55], v[168:171], a[0:3], 0
    ds_read_b64_tr_b16 v[192:193], v197 offset:320
    ds_read_b64_tr_b16 v[194:195], v197 offset:2496
    s_waitcnt lgkmcnt(10)
    v_mfma_f32_32x32x16_bf16 v[56:71], v[172:175], a[0:3], 0
    ds_read_b64_tr_b16 v[168:169], v197 offset:352
    ds_read_b64_tr_b16 v[170:171], v197 offset:2528
    s_waitcnt lgkmcnt(10)
    v_mfma_f32_32x32x16_bf16 v[72:87], v[176:179], a[0:3], 0
    ds_read_b64_tr_b16 v[172:173], v197 offset:8704
    ds_read_b64_tr_b16 v[174:175], v197 offset:10880
    s_waitcnt lgkmcnt(10)
    v_mfma_f32_32x32x16_bf16 v[88:103], v[180:183], a[0:3], 0
    ds_read_b64_tr_b16 v[176:177], v197 offset:8736
    ds_read_b64_tr_b16 v[178:179], v197 offset:10912
    s_waitcnt lgkmcnt(10)
    v_mfma_f32_32x32x16_bf16 v[104:119], v[184:187], a[0:3], 0
    ds_read_b64_tr_b16 v[180:181], v197 offset:8768
    ds_read_b64_tr_b16 v[182:183], v197 offset:10944
    s_waitcnt lgkmcnt(10)
    v_mfma_f32_32x32x16_bf16 v[120:135], v[188:191], a[0:3], 0
    ds_read_b64_tr_b16 v[184:185], v197 offset:8800
    ds_read_b64_tr_b16 v[186:187], v197 offset:10976
    s_waitcnt lgkmcnt(10)
    v_mfma_f32_32x32x16_bf16 v[136:151], v[192:195], a[0:3], 0
    ds_read_b64_tr_b16 v[188:189], v197 offset:8960
    ds_read_b64_tr_b16 v[190:191], v197 offset:11136
    s_waitcnt lgkmcnt(10)
    v_mfma_f32_32x32x16_bf16 v[152:167], v[168:171], a[0:3], 0
    ds_read_b64_tr_b16 v[192:193], v197 offset:8992
    ds_read_b64_tr_b16 v[194:195], v197 offset:11168
    s_waitcnt lgkmcnt(10)
    v_mfma_f32_32x32x16_bf16 v[40:55], v[172:175], a[4:7], v[40:55]
    ds_read_b64_tr_b16 v[168:169], v197 offset:9024
    ds_read_b64_tr_b16 v[170:171], v197 offset:11200
    s_waitcnt lgkmcnt(10)
    v_mfma_f32_32x32x16_bf16 v[56:71], v[176:179], a[4:7], v[56:71]
    ds_read_b64_tr_b16 v[172:173], v197 offset:9056
    ds_read_b64_tr_b16 v[174:175], v197 offset:11232
    s_waitcnt lgkmcnt(10)
    v_mfma_f32_32x32x16_bf16 v[72:87], v[180:183], a[4:7], v[72:87]
    s_waitcnt vmcnt(12)
    s_barrier
    s_mov_b32 s37, 524288
    buffer_load_dwordx4 a[32:35], v5, s[16:19], s37 offen
    s_mov_b32 s37, 589824
    buffer_load_dwordx4 a[36:39], v5, s[16:19], s37 offen
    s_mov_b32 s44, 393216
    s_cmp_ge_u32 s14, 1
    s_cbranch_scc1 L_k1_qk_dskip4
    s_mov_b32 m0, 86016
    s_nop 1
    buffer_load_dwordx4 v203, s[20:23], s44 offen lds
L_k1_qk_dskip4:
    s_nop 0
    s_add_u32 m0, s38, 69632
    s_nop 0
    buffer_load_dwordx4 v199, s[20:23], s44 offen lds
    s_add_u32 m0, s38, 73728
    s_nop 0
    buffer_load_dwordx4 v200, s[20:23], s44 offen lds
    s_add_u32 m0, s38, 77824
    s_nop 0
    buffer_load_dwordx4 v201, s[20:23], s44 offen lds
    s_add_u32 m0, s38, 81920
    s_nop 0
    buffer_load_dwordx4 v202, s[20:23], s44 offen lds
    s_mov_b32 s37, 655360
    buffer_load_dwordx4 a[40:43], v5, s[16:19], s37 offen
    s_mov_b32 s37, 720896
    buffer_load_dwordx4 a[44:47], v5, s[16:19], s37 offen
    s_mov_b32 s44, 491520
    s_cmp_ge_u32 s14, 1
    s_cbranch_scc1 L_k1_qk_dskip5
    s_mov_b32 m0, 103424
    s_nop 1
    buffer_load_dwordx4 v203, s[20:23], s44 offen lds
L_k1_qk_dskip5:
    s_nop 0
    s_add_u32 m0, s38, 87040
    s_nop 0
    buffer_load_dwordx4 v199, s[20:23], s44 offen lds
    s_add_u32 m0, s38, 91136
    s_nop 0
    buffer_load_dwordx4 v200, s[20:23], s44 offen lds
    s_add_u32 m0, s38, 95232
    s_nop 0
    buffer_load_dwordx4 v201, s[20:23], s44 offen lds
    s_add_u32 m0, s38, 99328
    s_nop 0
    buffer_load_dwordx4 v202, s[20:23], s44 offen lds
    v_add_u32 v198, 17408, v196
    ds_read_b64_tr_b16 v[176:177], v198 offset:0
    ds_read_b64_tr_b16 v[178:179], v198 offset:2176
    s_waitcnt lgkmcnt(10)
    v_mfma_f32_32x32x16_bf16 v[88:103], v[184:187], a[4:7], v[88:103]
    ds_read_b64_tr_b16 v[180:181], v198 offset:32
    ds_read_b64_tr_b16 v[182:183], v198 offset:2208
    s_waitcnt lgkmcnt(10)
    v_mfma_f32_32x32x16_bf16 v[104:119], v[188:191], a[4:7], v[104:119]
    ds_read_b64_tr_b16 v[184:185], v198 offset:64
    ds_read_b64_tr_b16 v[186:187], v198 offset:2240
    s_waitcnt lgkmcnt(10)
    v_mfma_f32_32x32x16_bf16 v[120:135], v[192:195], a[4:7], v[120:135]
    ds_read_b64_tr_b16 v[188:189], v198 offset:96
    ds_read_b64_tr_b16 v[190:191], v198 offset:2272
    s_waitcnt lgkmcnt(10)
    v_mfma_f32_32x32x16_bf16 v[136:151], v[168:171], a[4:7], v[136:151]
    ds_read_b64_tr_b16 v[192:193], v198 offset:256
    ds_read_b64_tr_b16 v[194:195], v198 offset:2432
    s_waitcnt lgkmcnt(10)
    v_mfma_f32_32x32x16_bf16 v[152:167], v[172:175], a[4:7], v[152:167]
    ds_read_b64_tr_b16 v[168:169], v198 offset:288
    ds_read_b64_tr_b16 v[170:171], v198 offset:2464
    s_waitcnt lgkmcnt(10)
    v_mfma_f32_32x32x16_bf16 v[40:55], v[176:179], a[8:11], v[40:55]
    ds_read_b64_tr_b16 v[172:173], v198 offset:320
    ds_read_b64_tr_b16 v[174:175], v198 offset:2496
    s_waitcnt lgkmcnt(10)
    v_mfma_f32_32x32x16_bf16 v[56:71], v[180:183], a[8:11], v[56:71]
    ds_read_b64_tr_b16 v[176:177], v198 offset:352
    ds_read_b64_tr_b16 v[178:179], v198 offset:2528
    s_waitcnt lgkmcnt(10)
    v_mfma_f32_32x32x16_bf16 v[72:87], v[184:187], a[8:11], v[72:87]
    ds_read_b64_tr_b16 v[180:181], v198 offset:8704
    ds_read_b64_tr_b16 v[182:183], v198 offset:10880
    s_waitcnt lgkmcnt(10)
    v_mfma_f32_32x32x16_bf16 v[88:103], v[188:191], a[8:11], v[88:103]
    ds_read_b64_tr_b16 v[184:185], v198 offset:8736
    ds_read_b64_tr_b16 v[186:187], v198 offset:10912
    s_waitcnt lgkmcnt(10)
    v_mfma_f32_32x32x16_bf16 v[104:119], v[192:195], a[8:11], v[104:119]
    ds_read_b64_tr_b16 v[188:189], v198 offset:8768
    ds_read_b64_tr_b16 v[190:191], v198 offset:10944
    s_waitcnt lgkmcnt(10)
    v_mfma_f32_32x32x16_bf16 v[120:135], v[168:171], a[8:11], v[120:135]
    ds_read_b64_tr_b16 v[192:193], v198 offset:8800
    ds_read_b64_tr_b16 v[194:195], v198 offset:10976
    s_waitcnt lgkmcnt(10)
    v_mfma_f32_32x32x16_bf16 v[136:151], v[172:175], a[8:11], v[136:151]
    ds_read_b64_tr_b16 v[168:169], v198 offset:8960
    ds_read_b64_tr_b16 v[170:171], v198 offset:11136
    s_waitcnt lgkmcnt(10)
    v_mfma_f32_32x32x16_bf16 v[152:167], v[176:179], a[8:11], v[152:167]
    ds_read_b64_tr_b16 v[172:173], v198 offset:8992
    ds_read_b64_tr_b16 v[174:175], v198 offset:11168
    s_waitcnt lgkmcnt(10)
    v_mfma_f32_32x32x16_bf16 v[40:55], v[180:183], a[12:15], v[40:55]
    ds_read_b64_tr_b16 v[176:177], v198 offset:9024
    ds_read_b64_tr_b16 v[178:179], v198 offset:11200
    s_waitcnt lgkmcnt(10)
    v_mfma_f32_32x32x16_bf16 v[56:71], v[184:187], a[12:15], v[56:71]
    ds_read_b64_tr_b16 v[180:181], v198 offset:9056
    ds_read_b64_tr_b16 v[182:183], v198 offset:11232
    s_waitcnt lgkmcnt(10)
    v_mfma_f32_32x32x16_bf16 v[72:87], v[188:191], a[12:15], v[72:87]
    s_waitcnt vmcnt(18)
    s_barrier
    s_mov_b32 s37, 786432
    buffer_load_dwordx4 a[48:51], v5, s[16:19], s37 offen
    s_mov_b32 s37, 851968
    buffer_load_dwordx4 a[52:55], v5, s[16:19], s37 offen
    s_mov_b32 s44, 589824
    s_cmp_ge_u32 s14, 1
    s_cbranch_scc1 L_k1_qk_dskip6
    s_mov_b32 m0, 120832
    s_nop 1
    buffer_load_dwordx4 v203, s[20:23], s44 offen lds
L_k1_qk_dskip6:
    s_nop 0
    s_add_u32 m0, s38, 104448
    s_nop 0
    buffer_load_dwordx4 v199, s[20:23], s44 offen lds
    s_add_u32 m0, s38, 108544
    s_nop 0
    buffer_load_dwordx4 v200, s[20:23], s44 offen lds
    s_add_u32 m0, s38, 112640
    s_nop 0
    buffer_load_dwordx4 v201, s[20:23], s44 offen lds
    s_add_u32 m0, s38, 116736
    s_nop 0
    buffer_load_dwordx4 v202, s[20:23], s44 offen lds
    s_mov_b32 s37, 917504
    buffer_load_dwordx4 a[56:59], v5, s[16:19], s37 offen
    s_mov_b32 s37, 983040
    buffer_load_dwordx4 a[60:63], v5, s[16:19], s37 offen
    s_mov_b32 s44, 688128
    s_cmp_ge_u32 s14, 1
    s_cbranch_scc1 L_k1_qk_dskip7
    s_mov_b32 m0, 138240
    s_nop 1
    buffer_load_dwordx4 v203, s[20:23], s44 offen lds
L_k1_qk_dskip7:
    s_nop 0
    s_add_u32 m0, s38, 121856
    s_nop 0
    buffer_load_dwordx4 v199, s[20:23], s44 offen lds
    s_add_u32 m0, s38, 125952
    s_nop 0
    buffer_load_dwordx4 v200, s[20:23], s44 offen lds
    s_add_u32 m0, s38, 130048
    s_nop 0
    buffer_load_dwordx4 v201, s[20:23], s44 offen lds
    s_add_u32 m0, s38, 134144
    s_nop 0
    buffer_load_dwordx4 v202, s[20:23], s44 offen lds
    v_add_u32 v197, 34816, v196
    ds_read_b64_tr_b16 v[184:185], v197 offset:0
    ds_read_b64_tr_b16 v[186:187], v197 offset:2176
    s_waitcnt lgkmcnt(10)
    v_mfma_f32_32x32x16_bf16 v[88:103], v[192:195], a[12:15], v[88:103]
    ds_read_b64_tr_b16 v[188:189], v197 offset:32
    ds_read_b64_tr_b16 v[190:191], v197 offset:2208
    s_waitcnt lgkmcnt(10)
    v_mfma_f32_32x32x16_bf16 v[104:119], v[168:171], a[12:15], v[104:119]
    ds_read_b64_tr_b16 v[192:193], v197 offset:64
    ds_read_b64_tr_b16 v[194:195], v197 offset:2240
    s_waitcnt lgkmcnt(10)
    v_mfma_f32_32x32x16_bf16 v[120:135], v[172:175], a[12:15], v[120:135]
    ds_read_b64_tr_b16 v[168:169], v197 offset:96
    ds_read_b64_tr_b16 v[170:171], v197 offset:2272
    s_waitcnt lgkmcnt(10)
    v_mfma_f32_32x32x16_bf16 v[136:151], v[176:179], a[12:15], v[136:151]
    ds_read_b64_tr_b16 v[172:173], v197 offset:256
    ds_read_b64_tr_b16 v[174:175], v197 offset:2432
    s_waitcnt lgkmcnt(10)
    v_mfma_f32_32x32x16_bf16 v[152:167], v[180:183], a[12:15], v[152:167]
    ds_read_b64_tr_b16 v[176:177], v197 offset:288
    ds_read_b64_tr_b16 v[178:179], v197 offset:2464
    s_waitcnt lgkmcnt(10)
    v_mfma_f32_32x32x16_bf16 v[40:55], v[184:187], a[16:19], v[40:55]
    ds_read_b64_tr_b16 v[180:181], v197 offset:320
    ds_read_b64_tr_b16 v[182:183], v197 offset:2496
    s_waitcnt lgkmcnt(10)
    v_mfma_f32_32x32x16_bf16 v[56:71], v[188:191], a[16:19], v[56:71]
    ds_read_b64_tr_b16 v[184:185], v197 offset:352
    ds_read_b64_tr_b16 v[186:187], v197 offset:2528
    s_waitcnt lgkmcnt(10)
    v_mfma_f32_32x32x16_bf16 v[72:87], v[192:195], a[16:19], v[72:87]
    ds_read_b64_tr_b16 v[188:189], v197 offset:8704
    ds_read_b64_tr_b16 v[190:191], v197 offset:10880
    s_waitcnt lgkmcnt(10)
    v_mfma_f32_32x32x16_bf16 v[88:103], v[168:171], a[16:19], v[88:103]
    ds_read_b64_tr_b16 v[192:193], v197 offset:8736
    ds_read_b64_tr_b16 v[194:195], v197 offset:10912
    s_waitcnt lgkmcnt(10)
    v_mfma_f32_32x32x16_bf16 v[104:119], v[172:175], a[16:19], v[104:119]
    ds_read_b64_tr_b16 v[168:169], v197 offset:8768
    ds_read_b64_tr_b16 v[170:171], v197 offset:10944
    s_waitcnt lgkmcnt(10)
    v_mfma_f32_32x32x16_bf16 v[120:135], v[176:179], a[16:19], v[120:135]
    ds_read_b64_tr_b16 v[172:173], v197 offset:8800
    ds_read_b64_tr_b16 v[174:175], v197 offset:10976
    s_waitcnt lgkmcnt(10)
    v_mfma_f32_32x32x16_bf16 v[136:151], v[180:183], a[16:19], v[136:151]
    ds_read_b64_tr_b16 v[176:177], v197 offset:8960
    ds_read_b64_tr_b16 v[178:179], v197 offset:11136
    s_waitcnt lgkmcnt(10)
    v_mfma_f32_32x32x16_bf16 v[152:167], v[184:187], a[16:19], v[152:167]
    ds_read_b64_tr_b16 v[180:181], v197 offset:8992
    ds_read_b64_tr_b16 v[182:183], v197 offset:11168
    s_waitcnt lgkmcnt(10)
    v_mfma_f32_32x32x16_bf16 v[40:55], v[188:191], a[20:23], v[40:55]
    ds_read_b64_tr_b16 v[184:185], v197 offset:9024
    ds_read_b64_tr_b16 v[186:187], v197 offset:11200
    s_waitcnt lgkmcnt(10)
    v_mfma_f32_32x32x16_bf16 v[56:71], v[192:195], a[20:23], v[56:71]
    ds_read_b64_tr_b16 v[188:189], v197 offset:9056
    ds_read_b64_tr_b16 v[190:191], v197 offset:11232
    s_waitcnt lgkmcnt(10)
    v_mfma_f32_32x32x16_bf16 v[72:87], v[168:171], a[20:23], v[72:87]
    s_waitcnt vmcnt(24)
    s_barrier
    s_mov_b32 s37, 1048576
    buffer_load_dwordx4 a[64:67], v5, s[16:19], s37 offen
    s_mov_b32 s37, 1114112
    buffer_load_dwordx4 a[68:71], v5, s[16:19], s37 offen
    s_mov_b32 s44, 786432
    s_cmp_ge_u32 s14, 1
    s_cbranch_scc1 L_k1_qk_dskip8
    s_mov_b32 m0, 16384
    s_nop 1
    buffer_load_dwordx4 v203, s[20:23], s44 offen lds
L_k1_qk_dskip8:
    s_nop 0
    s_add_u32 m0, s38, 0
    s_nop 0
    buffer_load_dwordx4 v199, s[20:23], s44 offen lds
    s_add_u32 m0, s38, 4096
    s_nop 0
    buffer_load_dwordx4 v200, s[20:23], s44 offen lds
    s_add_u32 m0, s38, 8192
    s_nop 0
    buffer_load_dwordx4 v201, s[20:23], s44 offen lds
    s_add_u32 m0, s38, 12288
    s_nop 0
    buffer_load_dwordx4 v202, s[20:23], s44 offen lds
    v_add_u32 v198, 52224, v196
    ds_read_b64_tr_b16 v[192:193], v198 offset:0
    ds_read_b64_tr_b16 v[194:195], v198 offset:2176
    s_waitcnt lgkmcnt(10)
    v_mfma_f32_32x32x16_bf16 v[88:103], v[172:175], a[20:23], v[88:103]
    ds_read_b64_tr_b16 v[168:169], v198 offset:32
    ds_read_b64_tr_b16 v[170:171], v198 offset:2208
    s_waitcnt lgkmcnt(10)
    v_mfma_f32_32x32x16_bf16 v[104:119], v[176:179], a[20:23], v[104:119]
    ds_read_b64_tr_b16 v[172:173], v198 offset:64
    ds_read_b64_tr_b16 v[174:175], v198 offset:2240
    s_waitcnt lgkmcnt(10)
    v_mfma_f32_32x32x16_bf16 v[120:135], v[180:183], a[20:23], v[120:135]
    ds_read_b64_tr_b16 v[176:177], v198 offset:96
    ds_read_b64_tr_b16 v[178:179], v198 offset:2272
    s_waitcnt lgkmcnt(10)
    v_mfma_f32_32x32x16_bf16 v[136:151], v[184:187], a[20:23], v[136:151]
    ds_read_b64_tr_b16 v[180:181], v198 offset:256
    ds_read_b64_tr_b16 v[182:183], v198 offset:2432
    s_waitcnt lgkmcnt(10)
    v_mfma_f32_32x32x16_bf16 v[152:167], v[188:191], a[20:23], v[152:167]
    ds_read_b64_tr_b16 v[184:185], v198 offset:288
    ds_read_b64_tr_b16 v[186:187], v198 offset:2464
    s_waitcnt lgkmcnt(10)
    v_mfma_f32_32x32x16_bf16 v[40:55], v[192:195], a[24:27], v[40:55]
    ds_read_b64_tr_b16 v[188:189], v198 offset:320
    ds_read_b64_tr_b16 v[190:191], v198 offset:2496
    s_waitcnt lgkmcnt(10)
    v_mfma_f32_32x32x16_bf16 v[56:71], v[168:171], a[24:27], v[56:71]
    ds_read_b64_tr_b16 v[192:193], v198 offset:352
    ds_read_b64_tr_b16 v[194:195], v198 offset:2528
    s_waitcnt lgkmcnt(10)
    v_mfma_f32_32x32x16_bf16 v[72:87], v[172:175], a[24:27], v[72:87]
    ds_read_b64_tr_b16 v[168:169], v198 offset:8704
    ds_read_b64_tr_b16 v[170:171], v198 offset:10880
    s_waitcnt lgkmcnt(10)
    v_mfma_f32_32x32x16_bf16 v[88:103], v[176:179], a[24:27], v[88:103]
    ds_read_b64_tr_b16 v[172:173], v198 offset:8736
    ds_read_b64_tr_b16 v[174:175], v198 offset:10912
    s_waitcnt lgkmcnt(10)
    v_mfma_f32_32x32x16_bf16 v[104:119], v[180:183], a[24:27], v[104:119]
    ds_read_b64_tr_b16 v[176:177], v198 offset:8768
    ds_read_b64_tr_b16 v[178:179], v198 offset:10944
    s_waitcnt lgkmcnt(10)
    v_mfma_f32_32x32x16_bf16 v[120:135], v[184:187], a[24:27], v[120:135]
    ds_read_b64_tr_b16 v[180:181], v198 offset:8800
    ds_read_b64_tr_b16 v[182:183], v198 offset:10976
    s_waitcnt lgkmcnt(10)
    v_mfma_f32_32x32x16_bf16 v[136:151], v[188:191], a[24:27], v[136:151]
    ds_read_b64_tr_b16 v[184:185], v198 offset:8960
    ds_read_b64_tr_b16 v[186:187], v198 offset:11136
    s_waitcnt lgkmcnt(10)
    v_mfma_f32_32x32x16_bf16 v[152:167], v[192:195], a[24:27], v[152:167]
    ds_read_b64_tr_b16 v[188:189], v198 offset:8992
    ds_read_b64_tr_b16 v[190:191], v198 offset:11168
    s_waitcnt lgkmcnt(10)
    v_mfma_f32_32x32x16_bf16 v[40:55], v[168:171], a[28:31], v[40:55]
    ds_read_b64_tr_b16 v[192:193], v198 offset:9024
    ds_read_b64_tr_b16 v[194:195], v198 offset:11200
    s_waitcnt lgkmcnt(10)
    v_mfma_f32_32x32x16_bf16 v[56:71], v[172:175], a[28:31], v[56:71]
    ds_read_b64_tr_b16 v[168:169], v198 offset:9056
    ds_read_b64_tr_b16 v[170:171], v198 offset:11232
    s_waitcnt lgkmcnt(10)
    v_mfma_f32_32x32x16_bf16 v[72:87], v[176:179], a[28:31], v[72:87]
    s_waitcnt vmcnt(24)
    s_barrier
    s_mov_b32 s37, 1179648
    buffer_load_dwordx4 a[72:75], v5, s[16:19], s37 offen
    s_mov_b32 s37, 1245184
    buffer_load_dwordx4 a[76:79], v5, s[16:19], s37 offen
    s_mov_b32 s44, 884736
    s_cmp_ge_u32 s14, 1
    s_cbranch_scc1 L_k1_qk_dskip9
    s_mov_b32 m0, 33792
    s_nop 1
    buffer_load_dwordx4 v203, s[20:23], s44 offen lds
L_k1_qk_dskip9:
    s_nop 0
    s_add_u32 m0, s38, 17408
    s_nop 0
    buffer_load_dwordx4 v199, s[20:23], s44 offen lds
    s_add_u32 m0, s38, 21504
    s_nop 0
    buffer_load_dwordx4 v200, s[20:23], s44 offen lds
    s_add_u32 m0, s38, 25600
    s_nop 0
    buffer_load_dwordx4 v201, s[20:23], s44 offen lds
    s_add_u32 m0, s38, 29696
    s_nop 0
    buffer_load_dwordx4 v202, s[20:23], s44 offen lds
    v_add_u32 v197, 69632, v196
    ds_read_b64_tr_b16 v[172:173], v197 offset:0
    ds_read_b64_tr_b16 v[174:175], v197 offset:2176
    s_waitcnt lgkmcnt(10)
    v_mfma_f32_32x32x16_bf16 v[88:103], v[180:183], a[28:31], v[88:103]
    ds_read_b64_tr_b16 v[176:177], v197 offset:32
    ds_read_b64_tr_b16 v[178:179], v197 offset:2208
    s_waitcnt lgkmcnt(10)
    v_mfma_f32_32x32x16_bf16 v[104:119], v[184:187], a[28:31], v[104:119]
    ds_read_b64_tr_b16 v[180:181], v197 offset:64
    ds_read_b64_tr_b16 v[182:183], v197 offset:2240
    s_waitcnt lgkmcnt(10)
    v_mfma_f32_32x32x16_bf16 v[120:135], v[188:191], a[28:31], v[120:135]
    ds_read_b64_tr_b16 v[184:185], v197 offset:96
    ds_read_b64_tr_b16 v[186:187], v197 offset:2272
    s_waitcnt lgkmcnt(10)
    v_mfma_f32_32x32x16_bf16 v[136:151], v[192:195], a[28:31], v[136:151]
    ds_read_b64_tr_b16 v[188:189], v197 offset:256
    ds_read_b64_tr_b16 v[190:191], v197 offset:2432
    s_waitcnt lgkmcnt(10)
    v_mfma_f32_32x32x16_bf16 v[152:167], v[168:171], a[28:31], v[152:167]
    ds_read_b64_tr_b16 v[192:193], v197 offset:288
    ds_read_b64_tr_b16 v[194:195], v197 offset:2464
    s_waitcnt lgkmcnt(10)
    v_mfma_f32_32x32x16_bf16 v[40:55], v[172:175], a[32:35], v[40:55]
    ds_read_b64_tr_b16 v[168:169], v197 offset:320
    ds_read_b64_tr_b16 v[170:171], v197 offset:2496
    s_waitcnt lgkmcnt(10)
    v_mfma_f32_32x32x16_bf16 v[56:71], v[176:179], a[32:35], v[56:71]
    ds_read_b64_tr_b16 v[172:173], v197 offset:352
    ds_read_b64_tr_b16 v[174:175], v197 offset:2528
    s_waitcnt lgkmcnt(10)
    v_mfma_f32_32x32x16_bf16 v[72:87], v[180:183], a[32:35], v[72:87]
    ds_read_b64_tr_b16 v[176:177], v197 offset:8704
    ds_read_b64_tr_b16 v[178:179], v197 offset:10880
    s_waitcnt lgkmcnt(10)
    v_mfma_f32_32x32x16_bf16 v[88:103], v[184:187], a[32:35], v[88:103]
    ds_read_b64_tr_b16 v[180:181], v197 offset:8736
    ds_read_b64_tr_b16 v[182:183], v197 offset:10912
    s_waitcnt lgkmcnt(10)
    v_mfma_f32_32x32x16_bf16 v[104:119], v[188:191], a[32:35], v[104:119]
    ds_read_b64_tr_b16 v[184:185], v197 offset:8768
    ds_read_b64_tr_b16 v[186:187], v197 offset:10944
    s_waitcnt lgkmcnt(10)
    v_mfma_f32_32x32x16_bf16 v[120:135], v[192:195], a[32:35], v[120:135]
    ds_read_b64_tr_b16 v[188:189], v197 offset:8800
    ds_read_b64_tr_b16 v[190:191], v197 offset:10976
    s_waitcnt lgkmcnt(10)
    v_mfma_f32_32x32x16_bf16 v[136:151], v[168:171], a[32:35], v[136:151]
    ds_read_b64_tr_b16 v[192:193], v197 offset:8960
    ds_read_b64_tr_b16 v[194:195], v197 offset:11136
    s_waitcnt lgkmcnt(10)
    v_mfma_f32_32x32x16_bf16 v[152:167], v[172:175], a[32:35], v[152:167]
    ds_read_b64_tr_b16 v[168:169], v197 offset:8992
    ds_read_b64_tr_b16 v[170:171], v197 offset:11168
    s_waitcnt lgkmcnt(10)
    v_mfma_f32_32x32x16_bf16 v[40:55], v[176:179], a[36:39], v[40:55]
    ds_read_b64_tr_b16 v[172:173], v197 offset:9024
    ds_read_b64_tr_b16 v[174:175], v197 offset:11200
    s_waitcnt lgkmcnt(10)
    v_mfma_f32_32x32x16_bf16 v[56:71], v[180:183], a[36:39], v[56:71]
    ds_read_b64_tr_b16 v[176:177], v197 offset:9056
    ds_read_b64_tr_b16 v[178:179], v197 offset:11232
    s_waitcnt lgkmcnt(10)
    v_mfma_f32_32x32x16_bf16 v[72:87], v[184:187], a[36:39], v[72:87]
    s_waitcnt vmcnt(24)
    s_barrier
    s_mov_b32 s37, 1310720
    buffer_load_dwordx4 a[80:83], v5, s[16:19], s37 offen
    s_mov_b32 s37, 1376256
    buffer_load_dwordx4 a[84:87], v5, s[16:19], s37 offen
    s_mov_b32 s44, 983040
    s_cmp_ge_u32 s14, 1
    s_cbranch_scc1 L_k1_qk_dskip10
    s_mov_b32 m0, 51200
    s_nop 1
    buffer_load_dwordx4 v203, s[20:23], s44 offen lds
L_k1_qk_dskip10:
    s_nop 0
    s_add_u32 m0, s38, 34816
    s_nop 0
    buffer_load_dwordx4 v199, s[20:23], s44 offen lds
    s_add_u32 m0, s38, 38912
    s_nop 0
    buffer_load_dwordx4 v200, s[20:23], s44 offen lds
    s_add_u32 m0, s38, 43008
    s_nop 0
    buffer_load_dwordx4 v201, s[20:23], s44 offen lds
    s_add_u32 m0, s38, 47104
    s_nop 0
    buffer_load_dwordx4 v202, s[20:23], s44 offen lds
    v_add_u32 v198, 87040, v196
    ds_read_b64_tr_b16 v[180:181], v198 offset:0
    ds_read_b64_tr_b16 v[182:183], v198 offset:2176
    s_waitcnt lgkmcnt(10)
    v_mfma_f32_32x32x16_bf16 v[88:103], v[188:191], a[36:39], v[88:103]
    ds_read_b64_tr_b16 v[184:185], v198 offset:32
    ds_read_b64_tr_b16 v[186:187], v198 offset:2208
    s_waitcnt lgkmcnt(10)
    v_mfma_f32_32x32x16_bf16 v[104:119], v[192:195], a[36:39], v[104:119]
    ds_read_b64_tr_b16 v[188:189], v198 offset:64
    ds_read_b64_tr_b16 v[190:191], v198 offset:2240
    s_waitcnt lgkmcnt(10)
    v_mfma_f32_32x32x16_bf16 v[120:135], v[168:171], a[36:39], v[120:135]
    ds_read_b64_tr_b16 v[192:193], v198 offset:96
    ds_read_b64_tr_b16 v[194:195], v198 offset:2272
    s_waitcnt lgkmcnt(10)
    v_mfma_f32_32x32x16_bf16 v[136:151], v[172:175], a[36:39], v[136:151]
    ds_read_b64_tr_b16 v[168:169], v198 offset:256
    ds_read_b64_tr_b16 v[170:171], v198 offset:2432
    s_waitcnt lgkmcnt(10)
    v_mfma_f32_32x32x16_bf16 v[152:167], v[176:179], a[36:39], v[152:167]
    ds_read_b64_tr_b16 v[172:173], v198 offset:288
    ds_read_b64_tr_b16 v[174:175], v198 offset:2464
    s_waitcnt lgkmcnt(10)
    v_mfma_f32_32x32x16_bf16 v[40:55], v[180:183], a[40:43], v[40:55]
    ds_read_b64_tr_b16 v[176:177], v198 offset:320
    ds_read_b64_tr_b16 v[178:179], v198 offset:2496
    s_waitcnt lgkmcnt(10)
    v_mfma_f32_32x32x16_bf16 v[56:71], v[184:187], a[40:43], v[56:71]
    ds_read_b64_tr_b16 v[180:181], v198 offset:352
    ds_read_b64_tr_b16 v[182:183], v198 offset:2528
    s_waitcnt lgkmcnt(10)
    v_mfma_f32_32x32x16_bf16 v[72:87], v[188:191], a[40:43], v[72:87]
    ds_read_b64_tr_b16 v[184:185], v198 offset:8704
    ds_read_b64_tr_b16 v[186:187], v198 offset:10880
    s_waitcnt lgkmcnt(10)
    v_mfma_f32_32x32x16_bf16 v[88:103], v[192:195], a[40:43], v[88:103]
    ds_read_b64_tr_b16 v[188:189], v198 offset:8736
    ds_read_b64_tr_b16 v[190:191], v198 offset:10912
    s_waitcnt lgkmcnt(10)
    v_mfma_f32_32x32x16_bf16 v[104:119], v[168:171], a[40:43], v[104:119]
    ds_read_b64_tr_b16 v[192:193], v198 offset:8768
    ds_read_b64_tr_b16 v[194:195], v198 offset:10944
    s_waitcnt lgkmcnt(10)
    v_mfma_f32_32x32x16_bf16 v[120:135], v[172:175], a[40:43], v[120:135]
    ds_read_b64_tr_b16 v[168:169], v198 offset:8800
    ds_read_b64_tr_b16 v[170:171], v198 offset:10976
    s_waitcnt lgkmcnt(10)
    v_mfma_f32_32x32x16_bf16 v[136:151], v[176:179], a[40:43], v[136:151]
    ds_read_b64_tr_b16 v[172:173], v198 offset:8960
    ds_read_b64_tr_b16 v[174:175], v198 offset:11136
    s_waitcnt lgkmcnt(10)
    v_mfma_f32_32x32x16_bf16 v[152:167], v[180:183], a[40:43], v[152:167]
    ds_read_b64_tr_b16 v[176:177], v198 offset:8992
    ds_read_b64_tr_b16 v[178:179], v198 offset:11168
    s_waitcnt lgkmcnt(10)
    v_mfma_f32_32x32x16_bf16 v[40:55], v[184:187], a[44:47], v[40:55]
    ds_read_b64_tr_b16 v[180:181], v198 offset:9024
    ds_read_b64_tr_b16 v[182:183], v198 offset:11200
    s_waitcnt lgkmcnt(10)
    v_mfma_f32_32x32x16_bf16 v[56:71], v[188:191], a[44:47], v[56:71]
    ds_read_b64_tr_b16 v[184:185], v198 offset:9056
    ds_read_b64_tr_b16 v[186:187], v198 offset:11232
    s_waitcnt lgkmcnt(10)
    v_mfma_f32_32x32x16_bf16 v[72:87], v[192:195], a[44:47], v[72:87]
    s_waitcnt vmcnt(24)
    s_barrier
    s_mov_b32 s37, 1441792
    buffer_load_dwordx4 a[88:91], v5, s[16:19], s37 offen
    s_mov_b32 s37, 1507328
    buffer_load_dwordx4 a[92:95], v5, s[16:19], s37 offen
    s_mov_b32 s44, 1081344
    s_cmp_ge_u32 s14, 1
    s_cbranch_scc1 L_k1_qk_dskip11
    s_mov_b32 m0, 68608
    s_nop 1
    buffer_load_dwordx4 v203, s[20:23], s44 offen lds
L_k1_qk_dskip11:
    s_nop 0
    s_add_u32 m0, s38, 52224
    s_nop 0
    buffer_load_dwordx4 v199, s[20:23], s44 offen lds
    s_add_u32 m0, s38, 56320
    s_nop 0
    buffer_load_dwordx4 v200, s[20:23], s44 offen lds
    s_add_u32 m0, s38, 60416
    s_nop 0
    buffer_load_dwordx4 v201, s[20:23], s44 offen lds
    s_add_u32 m0, s38, 64512
    s_nop 0
    buffer_load_dwordx4 v202, s[20:23], s44 offen lds
    v_add_u32 v197, 104448, v196
    ds_read_b64_tr_b16 v[188:189], v197 offset:0
    ds_read_b64_tr_b16 v[190:191], v197 offset:2176
    s_waitcnt lgkmcnt(10)
    v_mfma_f32_32x32x16_bf16 v[88:103], v[168:171], a[44:47], v[88:103]
    ds_read_b64_tr_b16 v[192:193], v197 offset:32
    ds_read_b64_tr_b16 v[194:195], v197 offset:2208
    s_waitcnt lgkmcnt(10)
    v_mfma_f32_32x32x16_bf16 v[104:119], v[172:175], a[44:47], v[104:119]
    ds_read_b64_tr_b16 v[168:169], v197 offset:64
    ds_read_b64_tr_b16 v[170:171], v197 offset:2240
    s_waitcnt lgkmcnt(10)
    v_mfma_f32_32x32x16_bf16 v[120:135], v[176:179], a[44:47], v[120:135]
    ds_read_b64_tr_b16 v[172:173], v197 offset:96
    ds_read_b64_tr_b16 v[174:175], v197 offset:2272
    s_waitcnt lgkmcnt(10)
    v_mfma_f32_32x32x16_bf16 v[136:151], v[180:183], a[44:47], v[136:151]
    ds_read_b64_tr_b16 v[176:177], v197 offset:256
    ds_read_b64_tr_b16 v[178:179], v197 offset:2432
    s_waitcnt lgkmcnt(10)
    v_mfma_f32_32x32x16_bf16 v[152:167], v[184:187], a[44:47], v[152:167]
    ds_read_b64_tr_b16 v[180:181], v197 offset:288
    ds_read_b64_tr_b16 v[182:183], v197 offset:2464
    s_waitcnt lgkmcnt(10)
    v_mfma_f32_32x32x16_bf16 v[40:55], v[188:191], a[48:51], v[40:55]
    ds_read_b64_tr_b16 v[184:185], v197 offset:320
    ds_read_b64_tr_b16 v[186:187], v197 offset:2496
    s_waitcnt lgkmcnt(10)
    v_mfma_f32_32x32x16_bf16 v[56:71], v[192:195], a[48:51], v[56:71]
    ds_read_b64_tr_b16 v[188:189], v197 offset:352
    ds_read_b64_tr_b16 v[190:191], v197 offset:2528
    s_waitcnt lgkmcnt(10)
    v_mfma_f32_32x32x16_bf16 v[72:87], v[168:171], a[48:51], v[72:87]
    ds_read_b64_tr_b16 v[192:193], v197 offset:8704
    ds_read_b64_tr_b16 v[194:195], v197 offset:10880
    s_waitcnt lgkmcnt(10)
    v_mfma_f32_32x32x16_bf16 v[88:103], v[172:175], a[48:51], v[88:103]
    ds_read_b64_tr_b16 v[168:169], v197 offset:8736
    ds_read_b64_tr_b16 v[170:171], v197 offset:10912
    s_waitcnt lgkmcnt(10)
    v_mfma_f32_32x32x16_bf16 v[104:119], v[176:179], a[48:51], v[104:119]
    ds_read_b64_tr_b16 v[172:173], v197 offset:8768
    ds_read_b64_tr_b16 v[174:175], v197 offset:10944
    s_waitcnt lgkmcnt(10)
    v_mfma_f32_32x32x16_bf16 v[120:135], v[180:183], a[48:51], v[120:135]
    ds_read_b64_tr_b16 v[176:177], v197 offset:8800
    ds_read_b64_tr_b16 v[178:179], v197 offset:10976
    s_waitcnt lgkmcnt(10)
    v_mfma_f32_32x32x16_bf16 v[136:151], v[184:187], a[48:51], v[136:151]
    ds_read_b64_tr_b16 v[180:181], v197 offset:8960
    ds_read_b64_tr_b16 v[182:183], v197 offset:11136
    s_waitcnt lgkmcnt(10)
    v_mfma_f32_32x32x16_bf16 v[152:167], v[188:191], a[48:51], v[152:167]
    ds_read_b64_tr_b16 v[184:185], v197 offset:8992
    ds_read_b64_tr_b16 v[186:187], v197 offset:11168
    s_waitcnt lgkmcnt(10)
    v_mfma_f32_32x32x16_bf16 v[40:55], v[192:195], a[52:55], v[40:55]
    ds_read_b64_tr_b16 v[188:189], v197 offset:9024
    ds_read_b64_tr_b16 v[190:191], v197 offset:11200
    s_waitcnt lgkmcnt(10)
    v_mfma_f32_32x32x16_bf16 v[56:71], v[168:171], a[52:55], v[56:71]
    ds_read_b64_tr_b16 v[192:193], v197 offset:9056
    ds_read_b64_tr_b16 v[194:195], v197 offset:11232
    s_waitcnt lgkmcnt(10)
    v_mfma_f32_32x32x16_bf16 v[72:87], v[172:175], a[52:55], v[72:87]
    s_waitcnt vmcnt(24)
    s_barrier
    s_mov_b32 s37, 1572864
    buffer_load_dwordx4 a[96:99], v5, s[16:19], s37 offen
    s_mov_b32 s37, 1638400
    buffer_load_dwordx4 a[100:103], v5, s[16:19], s37 offen
    s_mov_b32 s44, 1179648
    s_cmp_ge_u32 s14, 1
    s_cbranch_scc1 L_k1_qk_dskip12
    s_mov_b32 m0, 86016
    s_nop 1
    buffer_load_dwordx4 v203, s[20:23], s44 offen lds
L_k1_qk_dskip12:
    s_nop 0
    s_add_u32 m0, s38, 69632
    s_nop 0
    buffer_load_dwordx4 v199, s[20:23], s44 offen lds
    s_add_u32 m0, s38, 73728
    s_nop 0
    buffer_load_dwordx4 v200, s[20:23], s44 offen lds
    s_add_u32 m0, s38, 77824
    s_nop 0
    buffer_load_dwordx4 v201, s[20:23], s44 offen lds
    s_add_u32 m0, s38, 81920
    s_nop 0
    buffer_load_dwordx4 v202, s[20:23], s44 offen lds
    v_add_u32 v198, 121856, v196
    ds_read_b64_tr_b16 v[168:169], v198 offset:0
    ds_read_b64_tr_b16 v[170:171], v198 offset:2176
    s_waitcnt lgkmcnt(10)
    v_mfma_f32_32x32x16_bf16 v[88:103], v[176:179], a[52:55], v[88:103]
    ds_read_b64_tr_b16 v[172:173], v198 offset:32
    ds_read_b64_tr_b16 v[174:175], v198 offset:2208
    s_waitcnt lgkmcnt(10)
    v_mfma_f32_32x32x16_bf16 v[104:119], v[180:183], a[52:55], v[104:119]
    ds_read_b64_tr_b16 v[176:177], v198 offset:64
    ds_read_b64_tr_b16 v[178:179], v198 offset:2240
    s_waitcnt lgkmcnt(10)
    v_mfma_f32_32x32x16_bf16 v[120:135], v[184:187], a[52:55], v[120:135]
    ds_read_b64_tr_b16 v[180:181], v198 offset:96
    ds_read_b64_tr_b16 v[182:183], v198 offset:2272
    s_waitcnt lgkmcnt(10)
    v_mfma_f32_32x32x16_bf16 v[136:151], v[188:191], a[52:55], v[136:151]
    ds_read_b64_tr_b16 v[184:185], v198 offset:256
    ds_read_b64_tr_b16 v[186:187], v198 offset:2432
    s_waitcnt lgkmcnt(10)
    v_mfma_f32_32x32x16_bf16 v[152:167], v[192:195], a[52:55], v[152:167]
    ds_read_b64_tr_b16 v[188:189], v198 offset:288
    ds_read_b64_tr_b16 v[190:191], v198 offset:2464
    s_waitcnt lgkmcnt(10)
    v_mfma_f32_32x32x16_bf16 v[40:55], v[168:171], a[56:59], v[40:55]
    ds_read_b64_tr_b16 v[192:193], v198 offset:320
    ds_read_b64_tr_b16 v[194:195], v198 offset:2496
    s_waitcnt lgkmcnt(10)
    v_mfma_f32_32x32x16_bf16 v[56:71], v[172:175], a[56:59], v[56:71]
    ds_read_b64_tr_b16 v[168:169], v198 offset:352
    ds_read_b64_tr_b16 v[170:171], v198 offset:2528
    s_waitcnt lgkmcnt(10)
    v_mfma_f32_32x32x16_bf16 v[72:87], v[176:179], a[56:59], v[72:87]
    ds_read_b64_tr_b16 v[172:173], v198 offset:8704
    ds_read_b64_tr_b16 v[174:175], v198 offset:10880
    s_waitcnt lgkmcnt(10)
    v_mfma_f32_32x32x16_bf16 v[88:103], v[180:183], a[56:59], v[88:103]
    ds_read_b64_tr_b16 v[176:177], v198 offset:8736
    ds_read_b64_tr_b16 v[178:179], v198 offset:10912
    s_waitcnt lgkmcnt(10)
    v_mfma_f32_32x32x16_bf16 v[104:119], v[184:187], a[56:59], v[104:119]
    ds_read_b64_tr_b16 v[180:181], v198 offset:8768
    ds_read_b64_tr_b16 v[182:183], v198 offset:10944
    s_waitcnt lgkmcnt(10)
    v_mfma_f32_32x32x16_bf16 v[120:135], v[188:191], a[56:59], v[120:135]
    ds_read_b64_tr_b16 v[184:185], v198 offset:8800
    ds_read_b64_tr_b16 v[186:187], v198 offset:10976
    s_waitcnt lgkmcnt(10)
    v_mfma_f32_32x32x16_bf16 v[136:151], v[192:195], a[56:59], v[136:151]
    ds_read_b64_tr_b16 v[188:189], v198 offset:8960
    ds_read_b64_tr_b16 v[190:191], v198 offset:11136
    s_waitcnt lgkmcnt(10)
    v_mfma_f32_32x32x16_bf16 v[152:167], v[168:171], a[56:59], v[152:167]
    ds_read_b64_tr_b16 v[192:193], v198 offset:8992
    ds_read_b64_tr_b16 v[194:195], v198 offset:11168
    s_waitcnt lgkmcnt(10)
    v_mfma_f32_32x32x16_bf16 v[40:55], v[172:175], a[60:63], v[40:55]
    ds_read_b64_tr_b16 v[168:169], v198 offset:9024
    ds_read_b64_tr_b16 v[170:171], v198 offset:11200
    s_waitcnt lgkmcnt(10)
    v_mfma_f32_32x32x16_bf16 v[56:71], v[176:179], a[60:63], v[56:71]
    ds_read_b64_tr_b16 v[172:173], v198 offset:9056
    ds_read_b64_tr_b16 v[174:175], v198 offset:11232
    s_waitcnt lgkmcnt(10)
    v_mfma_f32_32x32x16_bf16 v[72:87], v[180:183], a[60:63], v[72:87]
    s_waitcnt vmcnt(24)
    s_barrier
    s_mov_b32 s37, 1703936
    buffer_load_dwordx4 a[104:107], v5, s[16:19], s37 offen
    s_mov_b32 s37, 1769472
    buffer_load_dwordx4 a[108:111], v5, s[16:19], s37 offen
    s_mov_b32 s44, 1277952
    s_cmp_ge_u32 s14, 1
    s_cbranch_scc1 L_k1_qk_dskip13
    s_mov_b32 m0, 103424
    s_nop 1
    buffer_load_dwordx4 v203, s[20:23], s44 offen lds
L_k1_qk_dskip13:
    s_nop 0
    s_add_u32 m0, s38, 87040
    s_nop 0
    buffer_load_dwordx4 v199, s[20:23], s44 offen lds
    s_add_u32 m0, s38, 91136
    s_nop 0
    buffer_load_dwordx4 v200, s[20:23], s44 offen lds
    s_add_u32 m0, s38, 95232
    s_nop 0
    buffer_load_dwordx4 v201, s[20:23], s44 offen lds
    s_add_u32 m0, s38, 99328
    s_nop 0
    buffer_load_dwordx4 v202, s[20:23], s44 offen lds
    v_add_u32 v197, 0, v196
    ds_read_b64_tr_b16 v[176:177], v197 offset:0
    ds_read_b64_tr_b16 v[178:179], v197 offset:2176
    s_waitcnt lgkmcnt(10)
    v_mfma_f32_32x32x16_bf16 v[88:103], v[184:187], a[60:63], v[88:103]
    ds_read_b64_tr_b16 v[180:181], v197 offset:32
    ds_read_b64_tr_b16 v[182:183], v197 offset:2208
    s_waitcnt lgkmcnt(10)
    v_mfma_f32_32x32x16_bf16 v[104:119], v[188:191], a[60:63], v[104:119]
    ds_read_b64_tr_b16 v[184:185], v197 offset:64
    ds_read_b64_tr_b16 v[186:187], v197 offset:2240
    s_waitcnt lgkmcnt(10)
    v_mfma_f32_32x32x16_bf16 v[120:135], v[192:195], a[60:63], v[120:135]
    ds_read_b64_tr_b16 v[188:189], v197 offset:96
    ds_read_b64_tr_b16 v[190:191], v197 offset:2272
    s_waitcnt lgkmcnt(10)
    v_mfma_f32_32x32x16_bf16 v[136:151], v[168:171], a[60:63], v[136:151]
    ds_read_b64_tr_b16 v[192:193], v197 offset:256
    ds_read_b64_tr_b16 v[194:195], v197 offset:2432
    s_waitcnt lgkmcnt(10)
    v_mfma_f32_32x32x16_bf16 v[152:167], v[172:175], a[60:63], v[152:167]
    ds_read_b64_tr_b16 v[168:169], v197 offset:288
    ds_read_b64_tr_b16 v[170:171], v197 offset:2464
    s_waitcnt lgkmcnt(10)
    v_mfma_f32_32x32x16_bf16 v[40:55], v[176:179], a[64:67], v[40:55]
    ds_read_b64_tr_b16 v[172:173], v197 offset:320
    ds_read_b64_tr_b16 v[174:175], v197 offset:2496
    s_waitcnt lgkmcnt(10)
    v_mfma_f32_32x32x16_bf16 v[56:71], v[180:183], a[64:67], v[56:71]
    ds_read_b64_tr_b16 v[176:177], v197 offset:352
    ds_read_b64_tr_b16 v[178:179], v197 offset:2528
    s_waitcnt lgkmcnt(10)
    v_mfma_f32_32x32x16_bf16 v[72:87], v[184:187], a[64:67], v[72:87]
    ds_read_b64_tr_b16 v[180:181], v197 offset:8704
    ds_read_b64_tr_b16 v[182:183], v197 offset:10880
    s_waitcnt lgkmcnt(10)
    v_mfma_f32_32x32x16_bf16 v[88:103], v[188:191], a[64:67], v[88:103]
    ds_read_b64_tr_b16 v[184:185], v197 offset:8736
    ds_read_b64_tr_b16 v[186:187], v197 offset:10912
    s_waitcnt lgkmcnt(10)
    v_mfma_f32_32x32x16_bf16 v[104:119], v[192:195], a[64:67], v[104:119]
    ds_read_b64_tr_b16 v[188:189], v197 offset:8768
    ds_read_b64_tr_b16 v[190:191], v197 offset:10944
    s_waitcnt lgkmcnt(10)
    v_mfma_f32_32x32x16_bf16 v[120:135], v[168:171], a[64:67], v[120:135]
    ds_read_b64_tr_b16 v[192:193], v197 offset:8800
    ds_read_b64_tr_b16 v[194:195], v197 offset:10976
    s_waitcnt lgkmcnt(10)
    v_mfma_f32_32x32x16_bf16 v[136:151], v[172:175], a[64:67], v[136:151]
    ds_read_b64_tr_b16 v[168:169], v197 offset:8960
    ds_read_b64_tr_b16 v[170:171], v197 offset:11136
    s_waitcnt lgkmcnt(10)
    v_mfma_f32_32x32x16_bf16 v[152:167], v[176:179], a[64:67], v[152:167]
    ds_read_b64_tr_b16 v[172:173], v197 offset:8992
    ds_read_b64_tr_b16 v[174:175], v197 offset:11168
    s_waitcnt lgkmcnt(10)
    v_mfma_f32_32x32x16_bf16 v[40:55], v[180:183], a[68:71], v[40:55]
    ds_read_b64_tr_b16 v[176:177], v197 offset:9024
    ds_read_b64_tr_b16 v[178:179], v197 offset:11200
    s_waitcnt lgkmcnt(10)
    v_mfma_f32_32x32x16_bf16 v[56:71], v[184:187], a[68:71], v[56:71]
    ds_read_b64_tr_b16 v[180:181], v197 offset:9056
    ds_read_b64_tr_b16 v[182:183], v197 offset:11232
    s_waitcnt lgkmcnt(10)
    v_mfma_f32_32x32x16_bf16 v[72:87], v[188:191], a[68:71], v[72:87]
    s_waitcnt vmcnt(24)
    s_barrier
    s_mov_b32 s37, 1835008
    buffer_load_dwordx4 a[112:115], v5, s[16:19], s37 offen
    s_mov_b32 s37, 1900544
    buffer_load_dwordx4 a[116:119], v5, s[16:19], s37 offen
    s_mov_b32 s44, 1376256
    s_cmp_ge_u32 s14, 1
    s_cbranch_scc1 L_k1_qk_dskip14
    s_mov_b32 m0, 120832
    s_nop 1
    buffer_load_dwordx4 v203, s[20:23], s44 offen lds
L_k1_qk_dskip14:
    s_nop 0
    s_add_u32 m0, s38, 104448
    s_nop 0
    buffer_load_dwordx4 v199, s[20:23], s44 offen lds
    s_add_u32 m0, s38, 108544
    s_nop 0
    buffer_load_dwordx4 v200, s[20:23], s44 offen lds
    s_add_u32 m0, s38, 112640
    s_nop 0
    buffer_load_dwordx4 v201, s[20:23], s44 offen lds
    s_add_u32 m0, s38, 116736
    s_nop 0
    buffer_load_dwordx4 v202, s[20:23], s44 offen lds
    v_add_u32 v198, 17408, v196
    ds_read_b64_tr_b16 v[184:185], v198 offset:0
    ds_read_b64_tr_b16 v[186:187], v198 offset:2176
    s_waitcnt lgkmcnt(10)
    v_mfma_f32_32x32x16_bf16 v[88:103], v[192:195], a[68:71], v[88:103]
    ds_read_b64_tr_b16 v[188:189], v198 offset:32
    ds_read_b64_tr_b16 v[190:191], v198 offset:2208
    s_waitcnt lgkmcnt(10)
    v_mfma_f32_32x32x16_bf16 v[104:119], v[168:171], a[68:71], v[104:119]
    ds_read_b64_tr_b16 v[192:193], v198 offset:64
    ds_read_b64_tr_b16 v[194:195], v198 offset:2240
    s_waitcnt lgkmcnt(10)
    v_mfma_f32_32x32x16_bf16 v[120:135], v[172:175], a[68:71], v[120:135]
    ds_read_b64_tr_b16 v[168:169], v198 offset:96
    ds_read_b64_tr_b16 v[170:171], v198 offset:2272
    s_waitcnt lgkmcnt(10)
    v_mfma_f32_32x32x16_bf16 v[136:151], v[176:179], a[68:71], v[136:151]
    ds_read_b64_tr_b16 v[172:173], v198 offset:256
    ds_read_b64_tr_b16 v[174:175], v198 offset:2432
    s_waitcnt lgkmcnt(10)
    v_mfma_f32_32x32x16_bf16 v[152:167], v[180:183], a[68:71], v[152:167]
    ds_read_b64_tr_b16 v[176:177], v198 offset:288
    ds_read_b64_tr_b16 v[178:179], v198 offset:2464
    s_waitcnt lgkmcnt(10)
    v_mfma_f32_32x32x16_bf16 v[40:55], v[184:187], a[72:75], v[40:55]
    ds_read_b64_tr_b16 v[180:181], v198 offset:320
    ds_read_b64_tr_b16 v[182:183], v198 offset:2496
    s_waitcnt lgkmcnt(10)
    v_mfma_f32_32x32x16_bf16 v[56:71], v[188:191], a[72:75], v[56:71]
    ds_read_b64_tr_b16 v[184:185], v198 offset:352
    ds_read_b64_tr_b16 v[186:187], v198 offset:2528
    s_waitcnt lgkmcnt(10)
    v_mfma_f32_32x32x16_bf16 v[72:87], v[192:195], a[72:75], v[72:87]
    ds_read_b64_tr_b16 v[188:189], v198 offset:8704
    ds_read_b64_tr_b16 v[190:191], v198 offset:10880
    s_waitcnt lgkmcnt(10)
    v_mfma_f32_32x32x16_bf16 v[88:103], v[168:171], a[72:75], v[88:103]
    ds_read_b64_tr_b16 v[192:193], v198 offset:8736
    ds_read_b64_tr_b16 v[194:195], v198 offset:10912
    s_waitcnt lgkmcnt(10)
    v_mfma_f32_32x32x16_bf16 v[104:119], v[172:175], a[72:75], v[104:119]
    ds_read_b64_tr_b16 v[168:169], v198 offset:8768
    ds_read_b64_tr_b16 v[170:171], v198 offset:10944
    s_waitcnt lgkmcnt(10)
    v_mfma_f32_32x32x16_bf16 v[120:135], v[176:179], a[72:75], v[120:135]
    ds_read_b64_tr_b16 v[172:173], v198 offset:8800
    ds_read_b64_tr_b16 v[174:175], v198 offset:10976
    s_waitcnt lgkmcnt(10)
    v_mfma_f32_32x32x16_bf16 v[136:151], v[180:183], a[72:75], v[136:151]
    ds_read_b64_tr_b16 v[176:177], v198 offset:8960
    ds_read_b64_tr_b16 v[178:179], v198 offset:11136
    s_waitcnt lgkmcnt(10)
    v_mfma_f32_32x32x16_bf16 v[152:167], v[184:187], a[72:75], v[152:167]
    ds_read_b64_tr_b16 v[180:181], v198 offset:8992
    ds_read_b64_tr_b16 v[182:183], v198 offset:11168
    s_waitcnt lgkmcnt(10)
    v_mfma_f32_32x32x16_bf16 v[40:55], v[188:191], a[76:79], v[40:55]
    ds_read_b64_tr_b16 v[184:185], v198 offset:9024
    ds_read_b64_tr_b16 v[186:187], v198 offset:11200
    s_waitcnt lgkmcnt(10)
    v_mfma_f32_32x32x16_bf16 v[56:71], v[192:195], a[76:79], v[56:71]
    ds_read_b64_tr_b16 v[188:189], v198 offset:9056
    ds_read_b64_tr_b16 v[190:191], v198 offset:11232
    s_waitcnt lgkmcnt(10)
    v_mfma_f32_32x32x16_bf16 v[72:87], v[168:171], a[76:79], v[72:87]
    s_waitcnt vmcnt(24)
    s_barrier
    s_mov_b32 s37, 1966080
    buffer_load_dwordx4 a[120:123], v5, s[16:19], s37 offen
    s_mov_b32 s37, 2031616
    buffer_load_dwordx4 a[124:127], v5, s[16:19], s37 offen
    s_mov_b32 s44, 1474560
    s_cmp_ge_u32 s14, 1
    s_cbranch_scc1 L_k1_qk_dskip15
    s_mov_b32 m0, 138240
    s_nop 1
    buffer_load_dwordx4 v203, s[20:23], s44 offen lds
L_k1_qk_dskip15:
    s_nop 0
    s_add_u32 m0, s38, 121856
    s_nop 0
    buffer_load_dwordx4 v199, s[20:23], s44 offen lds
    s_add_u32 m0, s38, 125952
    s_nop 0
    buffer_load_dwordx4 v200, s[20:23], s44 offen lds
    s_add_u32 m0, s38, 130048
    s_nop 0
    buffer_load_dwordx4 v201, s[20:23], s44 offen lds
    s_add_u32 m0, s38, 134144
    s_nop 0
    buffer_load_dwordx4 v202, s[20:23], s44 offen lds
    v_add_u32 v197, 34816, v196
    ds_read_b64_tr_b16 v[192:193], v197 offset:0
    ds_read_b64_tr_b16 v[194:195], v197 offset:2176
    s_waitcnt lgkmcnt(10)
    v_mfma_f32_32x32x16_bf16 v[88:103], v[172:175], a[76:79], v[88:103]
    ds_read_b64_tr_b16 v[168:169], v197 offset:32
    ds_read_b64_tr_b16 v[170:171], v197 offset:2208
    s_waitcnt lgkmcnt(10)
    v_mfma_f32_32x32x16_bf16 v[104:119], v[176:179], a[76:79], v[104:119]
    ds_read_b64_tr_b16 v[172:173], v197 offset:64
    ds_read_b64_tr_b16 v[174:175], v197 offset:2240
    s_waitcnt lgkmcnt(10)
    v_mfma_f32_32x32x16_bf16 v[120:135], v[180:183], a[76:79], v[120:135]
    ds_read_b64_tr_b16 v[176:177], v197 offset:96
    ds_read_b64_tr_b16 v[178:179], v197 offset:2272
    s_waitcnt lgkmcnt(10)
    v_mfma_f32_32x32x16_bf16 v[136:151], v[184:187], a[76:79], v[136:151]
    ds_read_b64_tr_b16 v[180:181], v197 offset:256
    ds_read_b64_tr_b16 v[182:183], v197 offset:2432
    s_waitcnt lgkmcnt(10)
    v_mfma_f32_32x32x16_bf16 v[152:167], v[188:191], a[76:79], v[152:167]
    ds_read_b64_tr_b16 v[184:185], v197 offset:288
    ds_read_b64_tr_b16 v[186:187], v197 offset:2464
    s_waitcnt lgkmcnt(10)
    v_mfma_f32_32x32x16_bf16 v[40:55], v[192:195], a[80:83], v[40:55]
    ds_read_b64_tr_b16 v[188:189], v197 offset:320
    ds_read_b64_tr_b16 v[190:191], v197 offset:2496
    s_waitcnt lgkmcnt(10)
    v_mfma_f32_32x32x16_bf16 v[56:71], v[168:171], a[80:83], v[56:71]
    ds_read_b64_tr_b16 v[192:193], v197 offset:352
    ds_read_b64_tr_b16 v[194:195], v197 offset:2528
    s_waitcnt lgkmcnt(10)
    v_mfma_f32_32x32x16_bf16 v[72:87], v[172:175], a[80:83], v[72:87]
    ds_read_b64_tr_b16 v[168:169], v197 offset:8704
    ds_read_b64_tr_b16 v[170:171], v197 offset:10880
    s_waitcnt lgkmcnt(10)
    v_mfma_f32_32x32x16_bf16 v[88:103], v[176:179], a[80:83], v[88:103]
    ds_read_b64_tr_b16 v[172:173], v197 offset:8736
    ds_read_b64_tr_b16 v[174:175], v197 offset:10912
    s_waitcnt lgkmcnt(10)
    v_mfma_f32_32x32x16_bf16 v[104:119], v[180:183], a[80:83], v[104:119]
    ds_read_b64_tr_b16 v[176:177], v197 offset:8768
    ds_read_b64_tr_b16 v[178:179], v197 offset:10944
    s_waitcnt lgkmcnt(10)
    v_mfma_f32_32x32x16_bf16 v[120:135], v[184:187], a[80:83], v[120:135]
    ds_read_b64_tr_b16 v[180:181], v197 offset:8800
    ds_read_b64_tr_b16 v[182:183], v197 offset:10976
    s_waitcnt lgkmcnt(10)
    v_mfma_f32_32x32x16_bf16 v[136:151], v[188:191], a[80:83], v[136:151]
    ds_read_b64_tr_b16 v[184:185], v197 offset:8960
    ds_read_b64_tr_b16 v[186:187], v197 offset:11136
    s_waitcnt lgkmcnt(10)
    v_mfma_f32_32x32x16_bf16 v[152:167], v[192:195], a[80:83], v[152:167]
    ds_read_b64_tr_b16 v[188:189], v197 offset:8992
    ds_read_b64_tr_b16 v[190:191], v197 offset:11168
    s_waitcnt lgkmcnt(10)
    v_mfma_f32_32x32x16_bf16 v[40:55], v[168:171], a[84:87], v[40:55]
    ds_read_b64_tr_b16 v[192:193], v197 offset:9024
    ds_read_b64_tr_b16 v[194:195], v197 offset:11200
    s_waitcnt lgkmcnt(10)
    v_mfma_f32_32x32x16_bf16 v[56:71], v[172:175], a[84:87], v[56:71]
    ds_read_b64_tr_b16 v[168:169], v197 offset:9056
    ds_read_b64_tr_b16 v[170:171], v197 offset:11232
    s_waitcnt lgkmcnt(10)
    v_mfma_f32_32x32x16_bf16 v[72:87], v[176:179], a[84:87], v[72:87]
    s_waitcnt vmcnt(24)
    s_barrier
    v_add_u32 v198, 52224, v196
    ds_read_b64_tr_b16 v[172:173], v198 offset:0
    ds_read_b64_tr_b16 v[174:175], v198 offset:2176
    s_waitcnt lgkmcnt(10)
    v_mfma_f32_32x32x16_bf16 v[88:103], v[180:183], a[84:87], v[88:103]
    ds_read_b64_tr_b16 v[176:177], v198 offset:32
    ds_read_b64_tr_b16 v[178:179], v198 offset:2208
    s_waitcnt lgkmcnt(10)
    v_mfma_f32_32x32x16_bf16 v[104:119], v[184:187], a[84:87], v[104:119]
    ds_read_b64_tr_b16 v[180:181], v198 offset:64
    ds_read_b64_tr_b16 v[182:183], v198 offset:2240
    s_waitcnt lgkmcnt(10)
    v_mfma_f32_32x32x16_bf16 v[120:135], v[188:191], a[84:87], v[120:135]
    ds_read_b64_tr_b16 v[184:185], v198 offset:96
    ds_read_b64_tr_b16 v[186:187], v198 offset:2272
    s_waitcnt lgkmcnt(10)
    v_mfma_f32_32x32x16_bf16 v[136:151], v[192:195], a[84:87], v[136:151]
    ds_read_b64_tr_b16 v[188:189], v198 offset:256
    ds_read_b64_tr_b16 v[190:191], v198 offset:2432
    s_waitcnt lgkmcnt(10)
    v_mfma_f32_32x32x16_bf16 v[152:167], v[168:171], a[84:87], v[152:167]
    ds_read_b64_tr_b16 v[192:193], v198 offset:288
    ds_read_b64_tr_b16 v[194:195], v198 offset:2464
    s_waitcnt lgkmcnt(10)
    v_mfma_f32_32x32x16_bf16 v[40:55], v[172:175], a[88:91], v[40:55]
    ds_read_b64_tr_b16 v[168:169], v198 offset:320
    ds_read_b64_tr_b16 v[170:171], v198 offset:2496
    s_waitcnt lgkmcnt(10)
    v_mfma_f32_32x32x16_bf16 v[56:71], v[176:179], a[88:91], v[56:71]
    ds_read_b64_tr_b16 v[172:173], v198 offset:352
    ds_read_b64_tr_b16 v[174:175], v198 offset:2528
    s_waitcnt lgkmcnt(10)
    v_mfma_f32_32x32x16_bf16 v[72:87], v[180:183], a[88:91], v[72:87]
    ds_read_b64_tr_b16 v[176:177], v198 offset:8704
    ds_read_b64_tr_b16 v[178:179], v198 offset:10880
    s_waitcnt lgkmcnt(10)
    v_mfma_f32_32x32x16_bf16 v[88:103], v[184:187], a[88:91], v[88:103]
    ds_read_b64_tr_b16 v[180:181], v198 offset:8736
    ds_read_b64_tr_b16 v[182:183], v198 offset:10912
    s_waitcnt lgkmcnt(10)
    v_mfma_f32_32x32x16_bf16 v[104:119], v[188:191], a[88:91], v[104:119]
    ds_read_b64_tr_b16 v[184:185], v198 offset:8768
    ds_read_b64_tr_b16 v[186:187], v198 offset:10944
    s_waitcnt lgkmcnt(10)
    v_mfma_f32_32x32x16_bf16 v[120:135], v[192:195], a[88:91], v[120:135]
    ds_read_b64_tr_b16 v[188:189], v198 offset:8800
    ds_read_b64_tr_b16 v[190:191], v198 offset:10976
    s_waitcnt lgkmcnt(10)
    v_mfma_f32_32x32x16_bf16 v[136:151], v[168:171], a[88:91], v[136:151]
    ds_read_b64_tr_b16 v[192:193], v198 offset:8960
    ds_read_b64_tr_b16 v[194:195], v198 offset:11136
    s_waitcnt lgkmcnt(10)
    v_mfma_f32_32x32x16_bf16 v[152:167], v[172:175], a[88:91], v[152:167]
    ds_read_b64_tr_b16 v[168:169], v198 offset:8992
    ds_read_b64_tr_b16 v[170:171], v198 offset:11168
    s_waitcnt lgkmcnt(10)
    v_mfma_f32_32x32x16_bf16 v[40:55], v[176:179], a[92:95], v[40:55]
    ds_read_b64_tr_b16 v[172:173], v198 offset:9024
    ds_read_b64_tr_b16 v[174:175], v198 offset:11200
    s_waitcnt lgkmcnt(10)
    v_mfma_f32_32x32x16_bf16 v[56:71], v[180:183], a[92:95], v[56:71]
    ds_read_b64_tr_b16 v[176:177], v198 offset:9056
    ds_read_b64_tr_b16 v[178:179], v198 offset:11232
    s_waitcnt lgkmcnt(10)
    v_mfma_f32_32x32x16_bf16 v[72:87], v[184:187], a[92:95], v[72:87]
    s_waitcnt vmcnt(18)
    s_barrier
    v_add_u32 v197, 69632, v196
    ds_read_b64_tr_b16 v[180:181], v197 offset:0
    ds_read_b64_tr_b16 v[182:183], v197 offset:2176
    s_waitcnt lgkmcnt(10)
    v_mfma_f32_32x32x16_bf16 v[88:103], v[188:191], a[92:95], v[88:103]
    ds_read_b64_tr_b16 v[184:185], v197 offset:32
    ds_read_b64_tr_b16 v[186:187], v197 offset:2208
    s_waitcnt lgkmcnt(10)
    v_mfma_f32_32x32x16_bf16 v[104:119], v[192:195], a[92:95], v[104:119]
    ds_read_b64_tr_b16 v[188:189], v197 offset:64
    ds_read_b64_tr_b16 v[190:191], v197 offset:2240
    s_waitcnt lgkmcnt(10)
    v_mfma_f32_32x32x16_bf16 v[120:135], v[168:171], a[92:95], v[120:135]
    ds_read_b64_tr_b16 v[192:193], v197 offset:96
    ds_read_b64_tr_b16 v[194:195], v197 offset:2272
    s_waitcnt lgkmcnt(10)
    v_mfma_f32_32x32x16_bf16 v[136:151], v[172:175], a[92:95], v[136:151]
    ds_read_b64_tr_b16 v[168:169], v197 offset:256
    ds_read_b64_tr_b16 v[170:171], v197 offset:2432
    s_waitcnt lgkmcnt(10)
    v_mfma_f32_32x32x16_bf16 v[152:167], v[176:179], a[92:95], v[152:167]
    ds_read_b64_tr_b16 v[172:173], v197 offset:288
    ds_read_b64_tr_b16 v[174:175], v197 offset:2464
    s_waitcnt lgkmcnt(10)
    v_mfma_f32_32x32x16_bf16 v[40:55], v[180:183], a[96:99], v[40:55]
    ds_read_b64_tr_b16 v[176:177], v197 offset:320
    ds_read_b64_tr_b16 v[178:179], v197 offset:2496
    s_waitcnt lgkmcnt(10)
    v_mfma_f32_32x32x16_bf16 v[56:71], v[184:187], a[96:99], v[56:71]
    ds_read_b64_tr_b16 v[180:181], v197 offset:352
    ds_read_b64_tr_b16 v[182:183], v197 offset:2528
    s_waitcnt lgkmcnt(10)
    v_mfma_f32_32x32x16_bf16 v[72:87], v[188:191], a[96:99], v[72:87]
    ds_read_b64_tr_b16 v[184:185], v197 offset:8704
    ds_read_b64_tr_b16 v[186:187], v197 offset:10880
    s_waitcnt lgkmcnt(10)
    v_mfma_f32_32x32x16_bf16 v[88:103], v[192:195], a[96:99], v[88:103]
    ds_read_b64_tr_b16 v[188:189], v197 offset:8736
    ds_read_b64_tr_b16 v[190:191], v197 offset:10912
    s_waitcnt lgkmcnt(10)
    v_mfma_f32_32x32x16_bf16 v[104:119], v[168:171], a[96:99], v[104:119]
    ds_read_b64_tr_b16 v[192:193], v197 offset:8768
    ds_read_b64_tr_b16 v[194:195], v197 offset:10944
    s_waitcnt lgkmcnt(10)
    v_mfma_f32_32x32x16_bf16 v[120:135], v[172:175], a[96:99], v[120:135]
    ds_read_b64_tr_b16 v[168:169], v197 offset:8800
    ds_read_b64_tr_b16 v[170:171], v197 offset:10976
    s_waitcnt lgkmcnt(10)
    v_mfma_f32_32x32x16_bf16 v[136:151], v[176:179], a[96:99], v[136:151]
    ds_read_b64_tr_b16 v[172:173], v197 offset:8960
    ds_read_b64_tr_b16 v[174:175], v197 offset:11136
    s_waitcnt lgkmcnt(10)
    v_mfma_f32_32x32x16_bf16 v[152:167], v[180:183], a[96:99], v[152:167]
    ds_read_b64_tr_b16 v[176:177], v197 offset:8992
    ds_read_b64_tr_b16 v[178:179], v197 offset:11168
    s_waitcnt lgkmcnt(10)
    v_mfma_f32_32x32x16_bf16 v[40:55], v[184:187], a[100:103], v[40:55]
    ds_read_b64_tr_b16 v[180:181], v197 offset:9024
    ds_read_b64_tr_b16 v[182:183], v197 offset:11200
    s_waitcnt lgkmcnt(10)
    v_mfma_f32_32x32x16_bf16 v[56:71], v[188:191], a[100:103], v[56:71]
    ds_read_b64_tr_b16 v[184:185], v197 offset:9056
    ds_read_b64_tr_b16 v[186:187], v197 offset:11232
    s_waitcnt lgkmcnt(10)
    v_mfma_f32_32x32x16_bf16 v[72:87], v[192:195], a[100:103], v[72:87]
    s_waitcnt vmcnt(12)
    s_barrier
    v_add_u32 v198, 87040, v196
    ds_read_b64_tr_b16 v[188:189], v198 offset:0
    ds_read_b64_tr_b16 v[190:191], v198 offset:2176
    s_waitcnt lgkmcnt(10)
    v_mfma_f32_32x32x16_bf16 v[88:103], v[168:171], a[100:103], v[88:103]
    ds_read_b64_tr_b16 v[192:193], v198 offset:32
    ds_read_b64_tr_b16 v[194:195], v198 offset:2208
    s_waitcnt lgkmcnt(10)
    v_mfma_f32_32x32x16_bf16 v[104:119], v[172:175], a[100:103], v[104:119]
    ds_read_b64_tr_b16 v[168:169], v198 offset:64
    ds_read_b64_tr_b16 v[170:171], v198 offset:2240
    s_waitcnt lgkmcnt(10)
    v_mfma_f32_32x32x16_bf16 v[120:135], v[176:179], a[100:103], v[120:135]
    ds_read_b64_tr_b16 v[172:173], v198 offset:96
    ds_read_b64_tr_b16 v[174:175], v198 offset:2272
    s_waitcnt lgkmcnt(10)
    v_mfma_f32_32x32x16_bf16 v[136:151], v[180:183], a[100:103], v[136:151]
    ds_read_b64_tr_b16 v[176:177], v198 offset:256
    ds_read_b64_tr_b16 v[178:179], v198 offset:2432
    s_waitcnt lgkmcnt(10)
    v_mfma_f32_32x32x16_bf16 v[152:167], v[184:187], a[100:103], v[152:167]
    ds_read_b64_tr_b16 v[180:181], v198 offset:288
    ds_read_b64_tr_b16 v[182:183], v198 offset:2464
    s_waitcnt lgkmcnt(10)
    v_mfma_f32_32x32x16_bf16 v[40:55], v[188:191], a[104:107], v[40:55]
    ds_read_b64_tr_b16 v[184:185], v198 offset:320
    ds_read_b64_tr_b16 v[186:187], v198 offset:2496
    s_waitcnt lgkmcnt(10)
    v_mfma_f32_32x32x16_bf16 v[56:71], v[192:195], a[104:107], v[56:71]
    ds_read_b64_tr_b16 v[188:189], v198 offset:352
    ds_read_b64_tr_b16 v[190:191], v198 offset:2528
    s_waitcnt lgkmcnt(10)
    v_mfma_f32_32x32x16_bf16 v[72:87], v[168:171], a[104:107], v[72:87]
    ds_read_b64_tr_b16 v[192:193], v198 offset:8704
    ds_read_b64_tr_b16 v[194:195], v198 offset:10880
    s_waitcnt lgkmcnt(10)
    v_mfma_f32_32x32x16_bf16 v[88:103], v[172:175], a[104:107], v[88:103]
    ds_read_b64_tr_b16 v[168:169], v198 offset:8736
    ds_read_b64_tr_b16 v[170:171], v198 offset:10912
    s_waitcnt lgkmcnt(10)
    v_mfma_f32_32x32x16_bf16 v[104:119], v[176:179], a[104:107], v[104:119]
    ds_read_b64_tr_b16 v[172:173], v198 offset:8768
    ds_read_b64_tr_b16 v[174:175], v198 offset:10944
    s_waitcnt lgkmcnt(10)
    v_mfma_f32_32x32x16_bf16 v[120:135], v[180:183], a[104:107], v[120:135]
    ds_read_b64_tr_b16 v[176:177], v198 offset:8800
    ds_read_b64_tr_b16 v[178:179], v198 offset:10976
    s_waitcnt lgkmcnt(10)
    v_mfma_f32_32x32x16_bf16 v[136:151], v[184:187], a[104:107], v[136:151]
    ds_read_b64_tr_b16 v[180:181], v198 offset:8960
    ds_read_b64_tr_b16 v[182:183], v198 offset:11136
    s_waitcnt lgkmcnt(10)
    v_mfma_f32_32x32x16_bf16 v[152:167], v[188:191], a[104:107], v[152:167]
    ds_read_b64_tr_b16 v[184:185], v198 offset:8992
    ds_read_b64_tr_b16 v[186:187], v198 offset:11168
    s_waitcnt lgkmcnt(10)
    v_mfma_f32_32x32x16_bf16 v[40:55], v[192:195], a[108:111], v[40:55]
    ds_read_b64_tr_b16 v[188:189], v198 offset:9024
    ds_read_b64_tr_b16 v[190:191], v198 offset:11200
    s_waitcnt lgkmcnt(10)
    v_mfma_f32_32x32x16_bf16 v[56:71], v[168:171], a[108:111], v[56:71]
    ds_read_b64_tr_b16 v[192:193], v198 offset:9056
    ds_read_b64_tr_b16 v[194:195], v198 offset:11232
    s_waitcnt lgkmcnt(10)
    v_mfma_f32_32x32x16_bf16 v[72:87], v[172:175], a[108:111], v[72:87]
    s_waitcnt vmcnt(6)
    s_barrier
    v_add_u32 v197, 104448, v196
    ds_read_b64_tr_b16 v[168:169], v197 offset:0
    ds_read_b64_tr_b16 v[170:171], v197 offset:2176
    s_waitcnt lgkmcnt(10)
    v_mfma_f32_32x32x16_bf16 v[88:103], v[176:179], a[108:111], v[88:103]
    ds_read_b64_tr_b16 v[172:173], v197 offset:32
    ds_read_b64_tr_b16 v[174:175], v197 offset:2208
    s_waitcnt lgkmcnt(10)
    v_mfma_f32_32x32x16_bf16 v[104:119], v[180:183], a[108:111], v[104:119]
    ds_read_b64_tr_b16 v[176:177], v197 offset:64
    ds_read_b64_tr_b16 v[178:179], v197 offset:2240
    s_waitcnt lgkmcnt(10)
    v_mfma_f32_32x32x16_bf16 v[120:135], v[184:187], a[108:111], v[120:135]
    ds_read_b64_tr_b16 v[180:181], v197 offset:96
    ds_read_b64_tr_b16 v[182:183], v197 offset:2272
    s_waitcnt lgkmcnt(10)
    v_mfma_f32_32x32x16_bf16 v[136:151], v[188:191], a[108:111], v[136:151]
    ds_read_b64_tr_b16 v[184:185], v197 offset:256
    ds_read_b64_tr_b16 v[186:187], v197 offset:2432
    s_waitcnt lgkmcnt(10)
    v_mfma_f32_32x32x16_bf16 v[152:167], v[192:195], a[108:111], v[152:167]
    ds_read_b64_tr_b16 v[188:189], v197 offset:288
    ds_read_b64_tr_b16 v[190:191], v197 offset:2464
    s_waitcnt lgkmcnt(10)
    v_mfma_f32_32x32x16_bf16 v[40:55], v[168:171], a[112:115], v[40:55]
    ds_read_b64_tr_b16 v[192:193], v197 offset:320
    ds_read_b64_tr_b16 v[194:195], v197 offset:2496
    s_waitcnt lgkmcnt(10)
    v_mfma_f32_32x32x16_bf16 v[56:71], v[172:175], a[112:115], v[56:71]
    ds_read_b64_tr_b16 v[168:169], v197 offset:352
    ds_read_b64_tr_b16 v[170:171], v197 offset:2528
    s_waitcnt lgkmcnt(10)
    v_mfma_f32_32x32x16_bf16 v[72:87], v[176:179], a[112:115], v[72:87]
    ds_read_b64_tr_b16 v[172:173], v197 offset:8704
    ds_read_b64_tr_b16 v[174:175], v197 offset:10880
    s_waitcnt lgkmcnt(10)
    v_mfma_f32_32x32x16_bf16 v[88:103], v[180:183], a[112:115], v[88:103]
    ds_read_b64_tr_b16 v[176:177], v197 offset:8736
    ds_read_b64_tr_b16 v[178:179], v197 offset:10912
    s_waitcnt lgkmcnt(10)
    v_mfma_f32_32x32x16_bf16 v[104:119], v[184:187], a[112:115], v[104:119]
    ds_read_b64_tr_b16 v[180:181], v197 offset:8768
    ds_read_b64_tr_b16 v[182:183], v197 offset:10944
    s_waitcnt lgkmcnt(10)
    v_mfma_f32_32x32x16_bf16 v[120:135], v[188:191], a[112:115], v[120:135]
    ds_read_b64_tr_b16 v[184:185], v197 offset:8800
    ds_read_b64_tr_b16 v[186:187], v197 offset:10976
    s_waitcnt lgkmcnt(10)
    v_mfma_f32_32x32x16_bf16 v[136:151], v[192:195], a[112:115], v[136:151]
    ds_read_b64_tr_b16 v[188:189], v197 offset:8960
    ds_read_b64_tr_b16 v[190:191], v197 offset:11136
    s_waitcnt lgkmcnt(10)
    v_mfma_f32_32x32x16_bf16 v[152:167], v[168:171], a[112:115], v[152:167]
    ds_read_b64_tr_b16 v[192:193], v197 offset:8992
    ds_read_b64_tr_b16 v[194:195], v197 offset:11168
    s_waitcnt lgkmcnt(10)
    v_mfma_f32_32x32x16_bf16 v[40:55], v[172:175], a[116:119], v[40:55]
    ds_read_b64_tr_b16 v[168:169], v197 offset:9024
    ds_read_b64_tr_b16 v[170:171], v197 offset:11200
    s_waitcnt lgkmcnt(10)
    v_mfma_f32_32x32x16_bf16 v[56:71], v[176:179], a[116:119], v[56:71]
    ds_read_b64_tr_b16 v[172:173], v197 offset:9056
    ds_read_b64_tr_b16 v[174:175], v197 offset:11232
    s_waitcnt lgkmcnt(10)
    v_mfma_f32_32x32x16_bf16 v[72:87], v[180:183], a[116:119], v[72:87]
    s_waitcnt vmcnt(0)
    s_barrier
    v_add_u32 v198, 121856, v196
    ds_read_b64_tr_b16 v[176:177], v198 offset:0
    ds_read_b64_tr_b16 v[178:179], v198 offset:2176
    s_waitcnt lgkmcnt(10)
    v_mfma_f32_32x32x16_bf16 v[88:103], v[184:187], a[116:119], v[88:103]
    ds_read_b64_tr_b16 v[180:181], v198 offset:32
    ds_read_b64_tr_b16 v[182:183], v198 offset:2208
    s_waitcnt lgkmcnt(10)
    v_mfma_f32_32x32x16_bf16 v[104:119], v[188:191], a[116:119], v[104:119]
    ds_read_b64_tr_b16 v[184:185], v198 offset:64
    ds_read_b64_tr_b16 v[186:187], v198 offset:2240
    s_waitcnt lgkmcnt(10)
    v_mfma_f32_32x32x16_bf16 v[120:135], v[192:195], a[116:119], v[120:135]
    ds_read_b64_tr_b16 v[188:189], v198 offset:96
    ds_read_b64_tr_b16 v[190:191], v198 offset:2272
    s_waitcnt lgkmcnt(10)
    v_mfma_f32_32x32x16_bf16 v[136:151], v[168:171], a[116:119], v[136:151]
    ds_read_b64_tr_b16 v[192:193], v198 offset:256
    ds_read_b64_tr_b16 v[194:195], v198 offset:2432
    s_waitcnt lgkmcnt(10)
    v_mfma_f32_32x32x16_bf16 v[152:167], v[172:175], a[116:119], v[152:167]
    ds_read_b64_tr_b16 v[168:169], v198 offset:288
    ds_read_b64_tr_b16 v[170:171], v198 offset:2464
    s_waitcnt lgkmcnt(10)
    v_mfma_f32_32x32x16_bf16 v[40:55], v[176:179], a[120:123], v[40:55]
    ds_read_b64_tr_b16 v[172:173], v198 offset:320
    ds_read_b64_tr_b16 v[174:175], v198 offset:2496
    s_waitcnt lgkmcnt(10)
    v_mfma_f32_32x32x16_bf16 v[56:71], v[180:183], a[120:123], v[56:71]
    ds_read_b64_tr_b16 v[176:177], v198 offset:352
    ds_read_b64_tr_b16 v[178:179], v198 offset:2528
    s_waitcnt lgkmcnt(10)
    v_mfma_f32_32x32x16_bf16 v[72:87], v[184:187], a[120:123], v[72:87]
    ds_read_b64_tr_b16 v[180:181], v198 offset:8704
    ds_read_b64_tr_b16 v[182:183], v198 offset:10880
    s_waitcnt lgkmcnt(10)
    v_mfma_f32_32x32x16_bf16 v[88:103], v[188:191], a[120:123], v[88:103]
    ds_read_b64_tr_b16 v[184:185], v198 offset:8736
    ds_read_b64_tr_b16 v[186:187], v198 offset:10912
    s_waitcnt lgkmcnt(10)
    v_mfma_f32_32x32x16_bf16 v[104:119], v[192:195], a[120:123], v[104:119]
    ds_read_b64_tr_b16 v[188:189], v198 offset:8768
    ds_read_b64_tr_b16 v[190:191], v198 offset:10944
    s_waitcnt lgkmcnt(10)
    v_mfma_f32_32x32x16_bf16 v[120:135], v[168:171], a[120:123], v[120:135]
    ds_read_b64_tr_b16 v[192:193], v198 offset:8800
    ds_read_b64_tr_b16 v[194:195], v198 offset:10976
    s_waitcnt lgkmcnt(10)
    v_mfma_f32_32x32x16_bf16 v[136:151], v[172:175], a[120:123], v[136:151]
    ds_read_b64_tr_b16 v[168:169], v198 offset:8960
    ds_read_b64_tr_b16 v[170:171], v198 offset:11136
    s_waitcnt lgkmcnt(10)
    v_mfma_f32_32x32x16_bf16 v[152:167], v[176:179], a[120:123], v[152:167]
    ds_read_b64_tr_b16 v[172:173], v198 offset:8992
    ds_read_b64_tr_b16 v[174:175], v198 offset:11168
    s_waitcnt lgkmcnt(10)
    v_mfma_f32_32x32x16_bf16 v[40:55], v[180:183], a[124:127], v[40:55]
    ds_read_b64_tr_b16 v[176:177], v198 offset:9024
    ds_read_b64_tr_b16 v[178:179], v198 offset:11200
    s_waitcnt lgkmcnt(10)
    v_mfma_f32_32x32x16_bf16 v[56:71], v[184:187], a[124:127], v[56:71]
    ds_read_b64_tr_b16 v[180:181], v198 offset:9056
    ds_read_b64_tr_b16 v[182:183], v198 offset:11232
    s_waitcnt lgkmcnt(10)
    v_mfma_f32_32x32x16_bf16 v[72:87], v[188:191], a[124:127], v[72:87]
    s_waitcnt lgkmcnt(8)
    v_mfma_f32_32x32x16_bf16 v[88:103], v[192:195], a[124:127], v[88:103]
    s_waitcnt lgkmcnt(6)
    v_mfma_f32_32x32x16_bf16 v[104:119], v[168:171], a[124:127], v[104:119]
    s_waitcnt lgkmcnt(4)
    v_mfma_f32_32x32x16_bf16 v[120:135], v[172:175], a[124:127], v[120:135]
    s_waitcnt lgkmcnt(2)
    v_mfma_f32_32x32x16_bf16 v[136:151], v[176:179], a[124:127], v[136:151]
    s_waitcnt lgkmcnt(0)
    v_mfma_f32_32x32x16_bf16 v[152:167], v[180:183], a[124:127], v[152:167]
    s_cmp_ge_u32 s12, 2
    s_mov_b32 s47, 2097152
    s_cselect_b32 s44, 4194304, s47
    s_add_u32 s32, s10, s44
    s_addc_u32 s33, s11, 0
    s_mov_b32 s34, 2097152
    s_mov_b32 s35, 0x00020000
    s_and_b32 s39, s12, 1
    s_lshl_b32 s45, s39, 20
    v_cvt_pk_bf16_f32 v204, v40, v41
    v_cvt_pk_bf16_f32 v205, v42, v43
    v_cvt_pk_bf16_f32 v206, v44, v45
    v_cvt_pk_bf16_f32 v207, v46, v47
    s_add_u32 s46, s45, 0
    buffer_store_dwordx4 v[204:207], v5, s[32:35], s46 offen
    s_nop 1
    v_cvt_pk_bf16_f32 v204, v48, v49
    v_cvt_pk_bf16_f32 v205, v50, v51
    v_cvt_pk_bf16_f32 v206, v52, v53
    v_cvt_pk_bf16_f32 v207, v54, v55
    s_add_u32 s46, s45, 262144
    buffer_store_dwordx4 v[204:207], v5, s[32:35], s46 offen
    s_nop 1
    v_cvt_pk_bf16_f32 v204, v56, v57
    v_cvt_pk_bf16_f32 v205, v58, v59
    v_cvt_pk_bf16_f32 v206, v60, v61
    v_cvt_pk_bf16_f32 v207, v62, v63
    s_add_u32 s46, s45, 65536
    buffer_store_dwordx4 v[204:207], v5, s[32:35], s46 offen
    s_nop 1
    v_cvt_pk_bf16_f32 v204, v64, v65
    v_cvt_pk_bf16_f32 v205, v66, v67
    v_cvt_pk_bf16_f32 v206, v68, v69
    v_cvt_pk_bf16_f32 v207, v70, v71
    s_add_u32 s46, s45, 327680
    buffer_store_dwordx4 v[204:207], v5, s[32:35], s46 offen
    s_nop 1
    v_cvt_pk_bf16_f32 v204, v72, v73
    v_cvt_pk_bf16_f32 v205, v74, v75
    v_cvt_pk_bf16_f32 v206, v76, v77
    v_cvt_pk_bf16_f32 v207, v78, v79
    s_add_u32 s46, s45, 131072
    buffer_store_dwordx4 v[204:207], v5, s[32:35], s46 offen
    s_nop 1
    v_cvt_pk_bf16_f32 v204, v80, v81
    v_cvt_pk_bf16_f32 v205, v82, v83
    v_cvt_pk_bf16_f32 v206, v84, v85
    v_cvt_pk_bf16_f32 v207, v86, v87
    s_add_u32 s46, s45, 393216
    buffer_store_dwordx4 v[204:207], v5, s[32:35], s46 offen
    s_nop 1
    v_cvt_pk_bf16_f32 v204, v88, v89
    v_cvt_pk_bf16_f32 v205, v90, v91
    v_cvt_pk_bf16_f32 v206, v92, v93
    v_cvt_pk_bf16_f32 v207, v94, v95
    s_add_u32 s46, s45, 196608
    buffer_store_dwordx4 v[204:207], v5, s[32:35], s46 offen
    s_nop 1
    v_cvt_pk_bf16_f32 v204, v96, v97
    v_cvt_pk_bf16_f32 v205, v98, v99
    v_cvt_pk_bf16_f32 v206, v100, v101
    v_cvt_pk_bf16_f32 v207, v102, v103
    s_add_u32 s46, s45, 458752
    buffer_store_dwordx4 v[204:207], v5, s[32:35], s46 offen
    s_nop 1
    v_cvt_pk_bf16_f32 v204, v104, v105
    v_cvt_pk_bf16_f32 v205, v106, v107
    v_cvt_pk_bf16_f32 v206, v108, v109
    v_cvt_pk_bf16_f32 v207, v110, v111
    s_add_u32 s46, s45, 524288
    buffer_store_dwordx4 v[204:207], v5, s[32:35], s46 offen
    s_nop 1
    v_cvt_pk_bf16_f32 v204, v112, v113
    v_cvt_pk_bf16_f32 v205, v114, v115
    v_cvt_pk_bf16_f32 v206, v116, v117
    v_cvt_pk_bf16_f32 v207, v118, v119
    s_add_u32 s46, s45, 786432
    buffer_store_dwordx4 v[204:207], v5, s[32:35], s46 offen
    s_nop 1
    v_cvt_pk_bf16_f32 v204, v120, v121
    v_cvt_pk_bf16_f32 v205, v122, v123
    v_cvt_pk_bf16_f32 v206, v124, v125
    v_cvt_pk_bf16_f32 v207, v126, v127
    s_add_u32 s46, s45, 589824
    buffer_store_dwordx4 v[204:207], v5, s[32:35], s46 offen
    s_nop 1
    v_cvt_pk_bf16_f32 v204, v128, v129
    v_cvt_pk_bf16_f32 v205, v130, v131
    v_cvt_pk_bf16_f32 v206, v132, v133
    v_cvt_pk_bf16_f32 v207, v134, v135
    s_add_u32 s46, s45, 851968
    buffer_store_dwordx4 v[204:207], v5, s[32:35], s46 offen
    s_nop 1
    v_cvt_pk_bf16_f32 v204, v136, v137
    v_cvt_pk_bf16_f32 v205, v138, v139
    v_cvt_pk_bf16_f32 v206, v140, v141
    v_cvt_pk_bf16_f32 v207, v142, v143
    s_add_u32 s46, s45, 655360
    buffer_store_dwordx4 v[204:207], v5, s[32:35], s46 offen
    s_nop 1
    v_cvt_pk_bf16_f32 v204, v144, v145
    v_cvt_pk_bf16_f32 v205, v146, v147
    v_cvt_pk_bf16_f32 v206, v148, v149
    v_cvt_pk_bf16_f32 v207, v150, v151
    s_add_u32 s46, s45, 917504
    buffer_store_dwordx4 v[204:207], v5, s[32:35], s46 offen
    s_nop 1
    v_cvt_pk_bf16_f32 v204, v152, v153
    v_cvt_pk_bf16_f32 v205, v154, v155
    v_cvt_pk_bf16_f32 v206, v156, v157
    v_cvt_pk_bf16_f32 v207, v158, v159
    s_add_u32 s46, s45, 720896
    buffer_store_dwordx4 v[204:207], v5, s[32:35], s46 offen
    s_nop 1
    v_cvt_pk_bf16_f32 v204, v160, v161
    v_cvt_pk_bf16_f32 v205, v162, v163
    v_cvt_pk_bf16_f32 v206, v164, v165
    v_cvt_pk_bf16_f32 v207, v166, v167
    s_add_u32 s46, s45, 983040
    buffer_store_dwordx4 v[204:207], v5, s[32:35], s46 offen
    s_nop 1
    s_branch L_k1_end
L_k1_v:
    s_and_b32 s39, s12, 1
    s_lshl_b32 s42, s39, 9
    s_add_u32 s42, s42, 2048
    s_mov_b32 s20, s4
    s_mov_b32 s21, s5
    s_mov_b32 s22, 1572864
    s_mov_b32 s23, 0x00020000
    v_lshl_add_u32 v204, s14, 6, v1
    v_mul_u32_u24 v205, 1928, v204
    v_lshrrev_b32 v205, 16, v205
    v_mul_u32_u24 v206, 34, v205
    v_sub_u32 v206, v204, v206
    v_mul_u32_u24 v205, 3072, v205
    v_lshl_add_u32 v205, v206, 4, v205
    v_add_u32 v199, s42, v205
    v_lshl_add_u32 v204, s14, 6, v1
    v_add_u32 v204, 256, v204
    v_mul_u32_u24 v205, 1928, v204
    v_lshrrev_b32 v205, 16, v205
    v_mul_u32_u24 v206, 34, v205
    v_sub_u32 v206, v204, v206
    v_mul_u32_u24 v205, 3072, v205
    v_lshl_add_u32 v205, v206, 4, v205
    v_add_u32 v200, s42, v205
    v_lshl_add_u32 v204, s14, 6, v1
    v_add_u32 v204, 512, v204
    v_mul_u32_u24 v205, 1928, v204
    v_lshrrev_b32 v205, 16, v205
    v_mul_u32_u24 v206, 34, v205
    v_sub_u32 v206, v204, v206
    v_mul_u32_u24 v205, 3072, v205
    v_lshl_add_u32 v205, v206, 4, v205
    v_add_u32 v201, s42, v205
    v_lshl_add_u32 v204, s14, 6, v1
    v_add_u32 v204, 768, v204
    v_mul_u32_u24 v205, 1928, v204
    v_lshrrev_b32 v205, 16, v205
    v_mul_u32_u24 v206, 34, v205
    v_sub_u32 v206, v204, v206
    v_mul_u32_u24 v205, 3072, v205
    v_lshl_add_u32 v205, v206, 4, v205
    v_add_u32 v202, s42, v205
    v_add_u32 v204, 1024, v1
    v_mul_u32_u24 v205, 1928, v204
    v_lshrrev_b32 v205, 16, v205
    v_mul_u32_u24 v206, 34, v205
    v_sub_u32 v206, v204, v206
    v_mul_u32_u24 v205, 3072, v205
    v_lshl_add_u32 v205, v206, 4, v205
    v_add_u32 v203, s42, v205
    v_mul_u32_u24 v196, 544, v10
    v_lshl_add_u32 v196, v8, 3, v196
    v_mul_u32_u24 v204, 128, v6
    v_add_u32 v196, v196, v204
    s_mov_b32 s37, 0
    buffer_load_dwordx4 a[0:3], v5, s[16:19], s37 offen
    s_mov_b32 s37, 65536
    buffer_load_dwordx4 a[4:7], v5, s[16:19], s37 offen
    s_mov_b32 s44, 0
    s_cmp_ge_u32 s14, 1
    s_cbranch_scc1 L_k1_v_dskip0
    s_mov_b32 m0, 16384
    s_nop 1
    buffer_load_dwordx4 v203, s[20:23], s44 offen lds
L_k1_v_dskip0:
    s_nop 0
    s_add_u32 m0, s38, 0
    s_nop 0
    buffer_load_dwordx4 v199, s[20:23], s44 offen lds
    s_add_u32 m0, s38, 4096
    s_nop 0
    buffer_load_dwordx4 v200, s[20:23], s44 offen lds
    s_add_u32 m0, s38, 8192
    s_nop 0
    buffer_load_dwordx4 v201, s[20:23], s44 offen lds
    s_add_u32 m0, s38, 12288
    s_nop 0
    buffer_load_dwordx4 v202, s[20:23], s44 offen lds
    s_mov_b32 s37, 131072
    buffer_load_dwordx4 a[8:11], v5, s[16:19], s37 offen
    s_mov_b32 s37, 196608
    buffer_load_dwordx4 a[12:15], v5, s[16:19], s37 offen
    s_mov_b32 s44, 98304
    s_cmp_ge_u32 s14, 1
    s_cbranch_scc1 L_k1_v_dskip1
    s_mov_b32 m0, 33792
    s_nop 1
    buffer_load_dwordx4 v203, s[20:23], s44 offen lds
L_k1_v_dskip1:
    s_nop 0
    s_add_u32 m0, s38, 17408
    s_nop 0
    buffer_load_dwordx4 v199, s[20:23], s44 offen lds
    s_add_u32 m0, s38, 21504
    s_nop 0
    buffer_load_dwordx4 v200, s[20:23], s44 offen lds
    s_add_u32 m0, s38, 25600
    s_nop 0
    buffer_load_dwordx4 v201, s[20:23], s44 offen lds
    s_add_u32 m0, s38, 29696
    s_nop 0
    buffer_load_dwordx4 v202, s[20:23], s44 offen lds
    s_waitcnt vmcnt(6)
    s_barrier
    s_mov_b32 s37, 262144
    buffer_load_dwordx4 a[16:19], v5, s[16:19], s37 offen
    s_mov_b32 s37, 327680
    buffer_load_dwordx4 a[20:23], v5, s[16:19], s37 offen
    s_mov_b32 s44, 196608
    s_cmp_ge_u32 s14, 1
    s_cbranch_scc1 L_k1_v_dskip2
    s_mov_b32 m0, 51200
    s_nop 1
    buffer_load_dwordx4 v203, s[20:23], s44 offen lds
L_k1_v_dskip2:
    s_nop 0
    s_add_u32 m0, s38, 34816
    s_nop 0
    buffer_load_dwordx4 v199, s[20:23], s44 offen lds
    s_add_u32 m0, s38, 38912
    s_nop 0
    buffer_load_dwordx4 v200, s[20:23], s44 offen lds
    s_add_u32 m0, s38, 43008
    s_nop 0
    buffer_load_dwordx4 v201, s[20:23], s44 offen lds
    s_add_u32 m0, s38, 47104
    s_nop 0
    buffer_load_dwordx4 v202, s[20:23], s44 offen lds
    s_mov_b32 s37, 393216
    buffer_load_dwordx4 a[24:27], v5, s[16:19], s37 offen
    s_mov_b32 s37, 458752
    buffer_load_dwordx4 a[28:31], v5, s[16:19], s37 offen
    s_mov_b32 s44, 294912
    s_cmp_ge_u32 s14, 1
    s_cbranch_scc1 L_k1_v_dskip3
    s_mov_b32 m0, 68608
    s_nop 1
    buffer_load_dwordx4 v203, s[20:23], s44 offen lds
L_k1_v_dskip3:
    s_nop 0
    s_add_u32 m0, s38, 52224
    s_nop 0
    buffer_load_dwordx4 v199, s[20:23], s44 offen lds
    s_add_u32 m0, s38, 56320
    s_nop 0
    buffer_load_dwordx4 v200, s[20:23], s44 offen lds
    s_add_u32 m0, s38, 60416
    s_nop 0
    buffer_load_dwordx4 v201, s[20:23], s44 offen lds
    s_add_u32 m0, s38, 64512
    s_nop 0
    buffer_load_dwordx4 v202, s[20:23], s44 offen lds
    v_add_u32 v197, 0, v196
    ds_read_b64_tr_b16 v[168:169], v197 offset:0
    ds_read_b64_tr_b16 v[170:171], v197 offset:2176
    ds_read_b64_tr_b16 v[172:173], v197 offset:32
    ds_read_b64_tr_b16 v[174:175], v197 offset:2208
    ds_read_b64_tr_b16 v[176:177], v197 offset:64
    ds_read_b64_tr_b16 v[178:179], v197 offset:2240
    ds_read_b64_tr_b16 v[180:181], v197 offset:96
    ds_read_b64_tr_b16 v[182:183], v197 offset:2272
    ds_read_b64_tr_b16 v[184:185], v197 offset:256
    ds_read_b64_tr_b16 v[186:187], v197 offset:2432
    ds_read_b64_tr_b16 v[188:189], v197 offset:288
    ds_read_b64_tr_b16 v[190:191], v197 offset:2464
    s_waitcnt lgkmcnt(10)
    v_mfma_f32_32x32x16_bf16 v[40:55], a[0:3], v[168:171], 0
    ds_read_b64_tr_b16 v[192:193], v197 offset:320
    ds_read_b64_tr_b16 v[194:195], v197 offset:2496
    s_waitcnt lgkmcnt(10)
    v_mfma_f32_32x32x16_bf16 v[56:71], a[0:3], v[172:175], 0
    ds_read_b64_tr_b16 v[168:169], v197 offset:352
    ds_read_b64_tr_b16 v[170:171], v197 offset:2528
    s_waitcnt lgkmcnt(10)
    v_mfma_f32_32x32x16_bf16 v[72:87], a[0:3], v[176:179], 0
    ds_read_b64_tr_b16 v[172:173], v197 offset:8704
    ds_read_b64_tr_b16 v[174:175], v197 offset:10880
    s_waitcnt lgkmcnt(10)
    v_mfma_f32_32x32x16_bf16 v[88:103], a[0:3], v[180:183], 0
    ds_read_b64_tr_b16 v[176:177], v197 offset:8736
    ds_read_b64_tr_b16 v[178:179], v197 offset:10912
    s_waitcnt lgkmcnt(10)
    v_mfma_f32_32x32x16_bf16 v[104:119], a[0:3], v[184:187], 0
    ds_read_b64_tr_b16 v[180:181], v197 offset:8768
    ds_read_b64_tr_b16 v[182:183], v197 offset:10944
    s_waitcnt lgkmcnt(10)
    v_mfma_f32_32x32x16_bf16 v[120:135], a[0:3], v[188:191], 0
    ds_read_b64_tr_b16 v[184:185], v197 offset:8800
    ds_read_b64_tr_b16 v[186:187], v197 offset:10976
    s_waitcnt lgkmcnt(10)
    v_mfma_f32_32x32x16_bf16 v[136:151], a[0:3], v[192:195], 0
    ds_read_b64_tr_b16 v[188:189], v197 offset:8960
    ds_read_b64_tr_b16 v[190:191], v197 offset:11136
    s_waitcnt lgkmcnt(10)
    v_mfma_f32_32x32x16_bf16 v[152:167], a[0:3], v[168:171], 0
    ds_read_b64_tr_b16 v[192:193], v197 offset:8992
    ds_read_b64_tr_b16 v[194:195], v197 offset:11168
    s_waitcnt lgkmcnt(10)
    v_mfma_f32_32x32x16_bf16 v[40:55], a[4:7], v[172:175], v[40:55]
    ds_read_b64_tr_b16 v[168:169], v197 offset:9024
    ds_read_b64_tr_b16 v[170:171], v197 offset:11200
    s_waitcnt lgkmcnt(10)
    v_mfma_f32_32x32x16_bf16 v[56:71], a[4:7], v[176:179], v[56:71]
    ds_read_b64_tr_b16 v[172:173], v197 offset:9056
    ds_read_b64_tr_b16 v[174:175], v197 offset:11232
    s_waitcnt lgkmcnt(10)
    v_mfma_f32_32x32x16_bf16 v[72:87], a[4:7], v[180:183], v[72:87]
    s_waitcnt vmcnt(12)
    s_barrier
    s_mov_b32 s37, 524288
    buffer_load_dwordx4 a[32:35], v5, s[16:19], s37 offen
    s_mov_b32 s37, 589824
    buffer_load_dwordx4 a[36:39], v5, s[16:19], s37 offen
    s_mov_b32 s44, 393216
    s_cmp_ge_u32 s14, 1
    s_cbranch_scc1 L_k1_v_dskip4
    s_mov_b32 m0, 86016
    s_nop 1
    buffer_load_dwordx4 v203, s[20:23], s44 offen lds
L_k1_v_dskip4:
    s_nop 0
    s_add_u32 m0, s38, 69632
    s_nop 0
    buffer_load_dwordx4 v199, s[20:23], s44 offen lds
    s_add_u32 m0, s38, 73728
    s_nop 0
    buffer_load_dwordx4 v200, s[20:23], s44 offen lds
    s_add_u32 m0, s38, 77824
    s_nop 0
    buffer_load_dwordx4 v201, s[20:23], s44 offen lds
    s_add_u32 m0, s38, 81920
    s_nop 0
    buffer_load_dwordx4 v202, s[20:23], s44 offen lds
    s_mov_b32 s37, 655360
    buffer_load_dwordx4 a[40:43], v5, s[16:19], s37 offen
    s_mov_b32 s37, 720896
    buffer_load_dwordx4 a[44:47], v5, s[16:19], s37 offen
    s_mov_b32 s44, 491520
    s_cmp_ge_u32 s14, 1
    s_cbranch_scc1 L_k1_v_dskip5
    s_mov_b32 m0, 103424
    s_nop 1
    buffer_load_dwordx4 v203, s[20:23], s44 offen lds
L_k1_v_dskip5:
    s_nop 0
    s_add_u32 m0, s38, 87040
    s_nop 0
    buffer_load_dwordx4 v199, s[20:23], s44 offen lds
    s_add_u32 m0, s38, 91136
    s_nop 0
    buffer_load_dwordx4 v200, s[20:23], s44 offen lds
    s_add_u32 m0, s38, 95232
    s_nop 0
    buffer_load_dwordx4 v201, s[20:23], s44 offen lds
    s_add_u32 m0, s38, 99328
    s_nop 0
    buffer_load_dwordx4 v202, s[20:23], s44 offen lds
    v_add_u32 v198, 17408, v196
    ds_read_b64_tr_b16 v[176:177], v198 offset:0
    ds_read_b64_tr_b16 v[178:179], v198 offset:2176
    s_waitcnt lgkmcnt(10)
    v_mfma_f32_32x32x16_bf16 v[88:103], a[4:7], v[184:187], v[88:103]
    ds_read_b64_tr_b16 v[180:181], v198 offset:32
    ds_read_b64_tr_b16 v[182:183], v198 offset:2208
    s_waitcnt lgkmcnt(10)
    v_mfma_f32_32x32x16_bf16 v[104:119], a[4:7], v[188:191], v[104:119]
    ds_read_b64_tr_b16 v[184:185], v198 offset:64
    ds_read_b64_tr_b16 v[186:187], v198 offset:2240
    s_waitcnt lgkmcnt(10)
    v_mfma_f32_32x32x16_bf16 v[120:135], a[4:7], v[192:195], v[120:135]
    ds_read_b64_tr_b16 v[188:189], v198 offset:96
    ds_read_b64_tr_b16 v[190:191], v198 offset:2272
    s_waitcnt lgkmcnt(10)
    v_mfma_f32_32x32x16_bf16 v[136:151], a[4:7], v[168:171], v[136:151]
    ds_read_b64_tr_b16 v[192:193], v198 offset:256
    ds_read_b64_tr_b16 v[194:195], v198 offset:2432
    s_waitcnt lgkmcnt(10)
    v_mfma_f32_32x32x16_bf16 v[152:167], a[4:7], v[172:175], v[152:167]
    ds_read_b64_tr_b16 v[168:169], v198 offset:288
    ds_read_b64_tr_b16 v[170:171], v198 offset:2464
    s_waitcnt lgkmcnt(10)
    v_mfma_f32_32x32x16_bf16 v[40:55], a[8:11], v[176:179], v[40:55]
    ds_read_b64_tr_b16 v[172:173], v198 offset:320
    ds_read_b64_tr_b16 v[174:175], v198 offset:2496
    s_waitcnt lgkmcnt(10)
    v_mfma_f32_32x32x16_bf16 v[56:71], a[8:11], v[180:183], v[56:71]
    ds_read_b64_tr_b16 v[176:177], v198 offset:352
    ds_read_b64_tr_b16 v[178:179], v198 offset:2528
    s_waitcnt lgkmcnt(10)
    v_mfma_f32_32x32x16_bf16 v[72:87], a[8:11], v[184:187], v[72:87]
    ds_read_b64_tr_b16 v[180:181], v198 offset:8704
    ds_read_b64_tr_b16 v[182:183], v198 offset:10880
    s_waitcnt lgkmcnt(10)
    v_mfma_f32_32x32x16_bf16 v[88:103], a[8:11], v[188:191], v[88:103]
    ds_read_b64_tr_b16 v[184:185], v198 offset:8736
    ds_read_b64_tr_b16 v[186:187], v198 offset:10912
    s_waitcnt lgkmcnt(10)
    v_mfma_f32_32x32x16_bf16 v[104:119], a[8:11], v[192:195], v[104:119]
    ds_read_b64_tr_b16 v[188:189], v198 offset:8768
    ds_read_b64_tr_b16 v[190:191], v198 offset:10944
    s_waitcnt lgkmcnt(10)
    v_mfma_f32_32x32x16_bf16 v[120:135], a[8:11], v[168:171], v[120:135]
    ds_read_b64_tr_b16 v[192:193], v198 offset:8800
    ds_read_b64_tr_b16 v[194:195], v198 offset:10976
    s_waitcnt lgkmcnt(10)
    v_mfma_f32_32x32x16_bf16 v[136:151], a[8:11], v[172:175], v[136:151]
    ds_read_b64_tr_b16 v[168:169], v198 offset:8960
    ds_read_b64_tr_b16 v[170:171], v198 offset:11136
    s_waitcnt lgkmcnt(10)
    v_mfma_f32_32x32x16_bf16 v[152:167], a[8:11], v[176:179], v[152:167]
    ds_read_b64_tr_b16 v[172:173], v198 offset:8992
    ds_read_b64_tr_b16 v[174:175], v198 offset:11168
    s_waitcnt lgkmcnt(10)
    v_mfma_f32_32x32x16_bf16 v[40:55], a[12:15], v[180:183], v[40:55]
    ds_read_b64_tr_b16 v[176:177], v198 offset:9024
    ds_read_b64_tr_b16 v[178:179], v198 offset:11200
    s_waitcnt lgkmcnt(10)
    v_mfma_f32_32x32x16_bf16 v[56:71], a[12:15], v[184:187], v[56:71]
    ds_read_b64_tr_b16 v[180:181], v198 offset:9056
    ds_read_b64_tr_b16 v[182:183], v198 offset:11232
    s_waitcnt lgkmcnt(10)
    v_mfma_f32_32x32x16_bf16 v[72:87], a[12:15], v[188:191], v[72:87]
    s_waitcnt vmcnt(18)
    s_barrier
    s_mov_b32 s37, 786432
    buffer_load_dwordx4 a[48:51], v5, s[16:19], s37 offen
    s_mov_b32 s37, 851968
    buffer_load_dwordx4 a[52:55], v5, s[16:19], s37 offen
    s_mov_b32 s44, 589824
    s_cmp_ge_u32 s14, 1
    s_cbranch_scc1 L_k1_v_dskip6
    s_mov_b32 m0, 120832
    s_nop 1
    buffer_load_dwordx4 v203, s[20:23], s44 offen lds
L_k1_v_dskip6:
    s_nop 0
    s_add_u32 m0, s38, 104448
    s_nop 0
    buffer_load_dwordx4 v199, s[20:23], s44 offen lds
    s_add_u32 m0, s38, 108544
    s_nop 0
    buffer_load_dwordx4 v200, s[20:23], s44 offen lds
    s_add_u32 m0, s38, 112640
    s_nop 0
    buffer_load_dwordx4 v201, s[20:23], s44 offen lds
    s_add_u32 m0, s38, 116736
    s_nop 0
    buffer_load_dwordx4 v202, s[20:23], s44 offen lds
    s_mov_b32 s37, 917504
    buffer_load_dwordx4 a[56:59], v5, s[16:19], s37 offen
    s_mov_b32 s37, 983040
    buffer_load_dwordx4 a[60:63], v5, s[16:19], s37 offen
    s_mov_b32 s44, 688128
    s_cmp_ge_u32 s14, 1
    s_cbranch_scc1 L_k1_v_dskip7
    s_mov_b32 m0, 138240
    s_nop 1
    buffer_load_dwordx4 v203, s[20:23], s44 offen lds
L_k1_v_dskip7:
    s_nop 0
    s_add_u32 m0, s38, 121856
    s_nop 0
    buffer_load_dwordx4 v199, s[20:23], s44 offen lds
    s_add_u32 m0, s38, 125952
    s_nop 0
    buffer_load_dwordx4 v200, s[20:23], s44 offen lds
    s_add_u32 m0, s38, 130048
    s_nop 0
    buffer_load_dwordx4 v201, s[20:23], s44 offen lds
    s_add_u32 m0, s38, 134144
    s_nop 0
    buffer_load_dwordx4 v202, s[20:23], s44 offen lds
    v_add_u32 v197, 34816, v196
    ds_read_b64_tr_b16 v[184:185], v197 offset:0
    ds_read_b64_tr_b16 v[186:187], v197 offset:2176
    s_waitcnt lgkmcnt(10)
    v_mfma_f32_32x32x16_bf16 v[88:103], a[12:15], v[192:195], v[88:103]
    ds_read_b64_tr_b16 v[188:189], v197 offset:32
    ds_read_b64_tr_b16 v[190:191], v197 offset:2208
    s_waitcnt lgkmcnt(10)
    v_mfma_f32_32x32x16_bf16 v[104:119], a[12:15], v[168:171], v[104:119]
    ds_read_b64_tr_b16 v[192:193], v197 offset:64
    ds_read_b64_tr_b16 v[194:195], v197 offset:2240
    s_waitcnt lgkmcnt(10)
    v_mfma_f32_32x32x16_bf16 v[120:135], a[12:15], v[172:175], v[120:135]
    ds_read_b64_tr_b16 v[168:169], v197 offset:96
    ds_read_b64_tr_b16 v[170:171], v197 offset:2272
    s_waitcnt lgkmcnt(10)
    v_mfma_f32_32x32x16_bf16 v[136:151], a[12:15], v[176:179], v[136:151]
    ds_read_b64_tr_b16 v[172:173], v197 offset:256
    ds_read_b64_tr_b16 v[174:175], v197 offset:2432
    s_waitcnt lgkmcnt(10)
    v_mfma_f32_32x32x16_bf16 v[152:167], a[12:15], v[180:183], v[152:167]
    ds_read_b64_tr_b16 v[176:177], v197 offset:288
    ds_read_b64_tr_b16 v[178:179], v197 offset:2464
    s_waitcnt lgkmcnt(10)
    v_mfma_f32_32x32x16_bf16 v[40:55], a[16:19], v[184:187], v[40:55]
    ds_read_b64_tr_b16 v[180:181], v197 offset:320
    ds_read_b64_tr_b16 v[182:183], v197 offset:2496
    s_waitcnt lgkmcnt(10)
    v_mfma_f32_32x32x16_bf16 v[56:71], a[16:19], v[188:191], v[56:71]
    ds_read_b64_tr_b16 v[184:185], v197 offset:352
    ds_read_b64_tr_b16 v[186:187], v197 offset:2528
    s_waitcnt lgkmcnt(10)
    v_mfma_f32_32x32x16_bf16 v[72:87], a[16:19], v[192:195], v[72:87]
    ds_read_b64_tr_b16 v[188:189], v197 offset:8704
    ds_read_b64_tr_b16 v[190:191], v197 offset:10880
    s_waitcnt lgkmcnt(10)
    v_mfma_f32_32x32x16_bf16 v[88:103], a[16:19], v[168:171], v[88:103]
    ds_read_b64_tr_b16 v[192:193], v197 offset:8736
    ds_read_b64_tr_b16 v[194:195], v197 offset:10912
    s_waitcnt lgkmcnt(10)
    v_mfma_f32_32x32x16_bf16 v[104:119], a[16:19], v[172:175], v[104:119]
    ds_read_b64_tr_b16 v[168:169], v197 offset:8768
    ds_read_b64_tr_b16 v[170:171], v197 offset:10944
    s_waitcnt lgkmcnt(10)
    v_mfma_f32_32x32x16_bf16 v[120:135], a[16:19], v[176:179], v[120:135]
    ds_read_b64_tr_b16 v[172:173], v197 offset:8800
    ds_read_b64_tr_b16 v[174:175], v197 offset:10976
    s_waitcnt lgkmcnt(10)
    v_mfma_f32_32x32x16_bf16 v[136:151], a[16:19], v[180:183], v[136:151]
    ds_read_b64_tr_b16 v[176:177], v197 offset:8960
    ds_read_b64_tr_b16 v[178:179], v197 offset:11136
    s_waitcnt lgkmcnt(10)
    v_mfma_f32_32x32x16_bf16 v[152:167], a[16:19], v[184:187], v[152:167]
    ds_read_b64_tr_b16 v[180:181], v197 offset:8992
    ds_read_b64_tr_b16 v[182:183], v197 offset:11168
    s_waitcnt lgkmcnt(10)
    v_mfma_f32_32x32x16_bf16 v[40:55], a[20:23], v[188:191], v[40:55]
    ds_read_b64_tr_b16 v[184:185], v197 offset:9024
    ds_read_b64_tr_b16 v[186:187], v197 offset:11200
    s_waitcnt lgkmcnt(10)
    v_mfma_f32_32x32x16_bf16 v[56:71], a[20:23], v[192:195], v[56:71]
    ds_read_b64_tr_b16 v[188:189], v197 offset:9056
    ds_read_b64_tr_b16 v[190:191], v197 offset:11232
    s_waitcnt lgkmcnt(10)
    v_mfma_f32_32x32x16_bf16 v[72:87], a[20:23], v[168:171], v[72:87]
    s_waitcnt vmcnt(24)
    s_barrier
    s_mov_b32 s37, 1048576
    buffer_load_dwordx4 a[64:67], v5, s[16:19], s37 offen
    s_mov_b32 s37, 1114112
    buffer_load_dwordx4 a[68:71], v5, s[16:19], s37 offen
    s_mov_b32 s44, 786432
    s_cmp_ge_u32 s14, 1
    s_cbranch_scc1 L_k1_v_dskip8
    s_mov_b32 m0, 16384
    s_nop 1
    buffer_load_dwordx4 v203, s[20:23], s44 offen lds
L_k1_v_dskip8:
    s_nop 0
    s_add_u32 m0, s38, 0
    s_nop 0
    buffer_load_dwordx4 v199, s[20:23], s44 offen lds
    s_add_u32 m0, s38, 4096
    s_nop 0
    buffer_load_dwordx4 v200, s[20:23], s44 offen lds
    s_add_u32 m0, s38, 8192
    s_nop 0
    buffer_load_dwordx4 v201, s[20:23], s44 offen lds
    s_add_u32 m0, s38, 12288
    s_nop 0
    buffer_load_dwordx4 v202, s[20:23], s44 offen lds
    v_add_u32 v198, 52224, v196
    ds_read_b64_tr_b16 v[192:193], v198 offset:0
    ds_read_b64_tr_b16 v[194:195], v198 offset:2176
    s_waitcnt lgkmcnt(10)
    v_mfma_f32_32x32x16_bf16 v[88:103], a[20:23], v[172:175], v[88:103]
    ds_read_b64_tr_b16 v[168:169], v198 offset:32
    ds_read_b64_tr_b16 v[170:171], v198 offset:2208
    s_waitcnt lgkmcnt(10)
    v_mfma_f32_32x32x16_bf16 v[104:119], a[20:23], v[176:179], v[104:119]
    ds_read_b64_tr_b16 v[172:173], v198 offset:64
    ds_read_b64_tr_b16 v[174:175], v198 offset:2240
    s_waitcnt lgkmcnt(10)
    v_mfma_f32_32x32x16_bf16 v[120:135], a[20:23], v[180:183], v[120:135]
    ds_read_b64_tr_b16 v[176:177], v198 offset:96
    ds_read_b64_tr_b16 v[178:179], v198 offset:2272
    s_waitcnt lgkmcnt(10)
    v_mfma_f32_32x32x16_bf16 v[136:151], a[20:23], v[184:187], v[136:151]
    ds_read_b64_tr_b16 v[180:181], v198 offset:256
    ds_read_b64_tr_b16 v[182:183], v198 offset:2432
    s_waitcnt lgkmcnt(10)
    v_mfma_f32_32x32x16_bf16 v[152:167], a[20:23], v[188:191], v[152:167]
    ds_read_b64_tr_b16 v[184:185], v198 offset:288
    ds_read_b64_tr_b16 v[186:187], v198 offset:2464
    s_waitcnt lgkmcnt(10)
    v_mfma_f32_32x32x16_bf16 v[40:55], a[24:27], v[192:195], v[40:55]
    ds_read_b64_tr_b16 v[188:189], v198 offset:320
    ds_read_b64_tr_b16 v[190:191], v198 offset:2496
    s_waitcnt lgkmcnt(10)
    v_mfma_f32_32x32x16_bf16 v[56:71], a[24:27], v[168:171], v[56:71]
    ds_read_b64_tr_b16 v[192:193], v198 offset:352
    ds_read_b64_tr_b16 v[194:195], v198 offset:2528
    s_waitcnt lgkmcnt(10)
    v_mfma_f32_32x32x16_bf16 v[72:87], a[24:27], v[172:175], v[72:87]
    ds_read_b64_tr_b16 v[168:169], v198 offset:8704
    ds_read_b64_tr_b16 v[170:171], v198 offset:10880
    s_waitcnt lgkmcnt(10)
    v_mfma_f32_32x32x16_bf16 v[88:103], a[24:27], v[176:179], v[88:103]
    ds_read_b64_tr_b16 v[172:173], v198 offset:8736
    ds_read_b64_tr_b16 v[174:175], v198 offset:10912
    s_waitcnt lgkmcnt(10)
    v_mfma_f32_32x32x16_bf16 v[104:119], a[24:27], v[180:183], v[104:119]
    ds_read_b64_tr_b16 v[176:177], v198 offset:8768
    ds_read_b64_tr_b16 v[178:179], v198 offset:10944
    s_waitcnt lgkmcnt(10)
    v_mfma_f32_32x32x16_bf16 v[120:135], a[24:27], v[184:187], v[120:135]
    ds_read_b64_tr_b16 v[180:181], v198 offset:8800
    ds_read_b64_tr_b16 v[182:183], v198 offset:10976
    s_waitcnt lgkmcnt(10)
    v_mfma_f32_32x32x16_bf16 v[136:151], a[24:27], v[188:191], v[136:151]
    ds_read_b64_tr_b16 v[184:185], v198 offset:8960
    ds_read_b64_tr_b16 v[186:187], v198 offset:11136
    s_waitcnt lgkmcnt(10)
    v_mfma_f32_32x32x16_bf16 v[152:167], a[24:27], v[192:195], v[152:167]
    ds_read_b64_tr_b16 v[188:189], v198 offset:8992
    ds_read_b64_tr_b16 v[190:191], v198 offset:11168
    s_waitcnt lgkmcnt(10)
    v_mfma_f32_32x32x16_bf16 v[40:55], a[28:31], v[168:171], v[40:55]
    ds_read_b64_tr_b16 v[192:193], v198 offset:9024
    ds_read_b64_tr_b16 v[194:195], v198 offset:11200
    s_waitcnt lgkmcnt(10)
    v_mfma_f32_32x32x16_bf16 v[56:71], a[28:31], v[172:175], v[56:71]
    ds_read_b64_tr_b16 v[168:169], v198 offset:9056
    ds_read_b64_tr_b16 v[170:171], v198 offset:11232
    s_waitcnt lgkmcnt(10)
    v_mfma_f32_32x32x16_bf16 v[72:87], a[28:31], v[176:179], v[72:87]
    s_waitcnt vmcnt(24)
    s_barrier
    s_mov_b32 s37, 1179648
    buffer_load_dwordx4 a[72:75], v5, s[16:19], s37 offen
    s_mov_b32 s37, 1245184
    buffer_load_dwordx4 a[76:79], v5, s[16:19], s37 offen
    s_mov_b32 s44, 884736
    s_cmp_ge_u32 s14, 1
    s_cbranch_scc1 L_k1_v_dskip9
    s_mov_b32 m0, 33792
    s_nop 1
    buffer_load_dwordx4 v203, s[20:23], s44 offen lds
L_k1_v_dskip9:
    s_nop 0
    s_add_u32 m0, s38, 17408
    s_nop 0
    buffer_load_dwordx4 v199, s[20:23], s44 offen lds
    s_add_u32 m0, s38, 21504
    s_nop 0
    buffer_load_dwordx4 v200, s[20:23], s44 offen lds
    s_add_u32 m0, s38, 25600
    s_nop 0
    buffer_load_dwordx4 v201, s[20:23], s44 offen lds
    s_add_u32 m0, s38, 29696
    s_nop 0
    buffer_load_dwordx4 v202, s[20:23], s44 offen lds
    v_add_u32 v197, 69632, v196
    ds_read_b64_tr_b16 v[172:173], v197 offset:0
    ds_read_b64_tr_b16 v[174:175], v197 offset:2176
    s_waitcnt lgkmcnt(10)
    v_mfma_f32_32x32x16_bf16 v[88:103], a[28:31], v[180:183], v[88:103]
    ds_read_b64_tr_b16 v[176:177], v197 offset:32
    ds_read_b64_tr_b16 v[178:179], v197 offset:2208
    s_waitcnt lgkmcnt(10)
    v_mfma_f32_32x32x16_bf16 v[104:119], a[28:31], v[184:187], v[104:119]
    ds_read_b64_tr_b16 v[180:181], v197 offset:64
    ds_read_b64_tr_b16 v[182:183], v197 offset:2240
    s_waitcnt lgkmcnt(10)
    v_mfma_f32_32x32x16_bf16 v[120:135], a[28:31], v[188:191], v[120:135]
    ds_read_b64_tr_b16 v[184:185], v197 offset:96
    ds_read_b64_tr_b16 v[186:187], v197 offset:2272
    s_waitcnt lgkmcnt(10)
    v_mfma_f32_32x32x16_bf16 v[136:151], a[28:31], v[192:195], v[136:151]
    ds_read_b64_tr_b16 v[188:189], v197 offset:256
    ds_read_b64_tr_b16 v[190:191], v197 offset:2432
    s_waitcnt lgkmcnt(10)
    v_mfma_f32_32x32x16_bf16 v[152:167], a[28:31], v[168:171], v[152:167]
    ds_read_b64_tr_b16 v[192:193], v197 offset:288
    ds_read_b64_tr_b16 v[194:195], v197 offset:2464
    s_waitcnt lgkmcnt(10)
    v_mfma_f32_32x32x16_bf16 v[40:55], a[32:35], v[172:175], v[40:55]
    ds_read_b64_tr_b16 v[168:169], v197 offset:320
    ds_read_b64_tr_b16 v[170:171], v197 offset:2496
    s_waitcnt lgkmcnt(10)
    v_mfma_f32_32x32x16_bf16 v[56:71], a[32:35], v[176:179], v[56:71]
    ds_read_b64_tr_b16 v[172:173], v197 offset:352
    ds_read_b64_tr_b16 v[174:175], v197 offset:2528
    s_waitcnt lgkmcnt(10)
    v_mfma_f32_32x32x16_bf16 v[72:87], a[32:35], v[180:183], v[72:87]
    ds_read_b64_tr_b16 v[176:177], v197 offset:8704
    ds_read_b64_tr_b16 v[178:179], v197 offset:10880
    s_waitcnt lgkmcnt(10)
    v_mfma_f32_32x32x16_bf16 v[88:103], a[32:35], v[184:187], v[88:103]
    ds_read_b64_tr_b16 v[180:181], v197 offset:8736
    ds_read_b64_tr_b16 v[182:183], v197 offset:10912
    s_waitcnt lgkmcnt(10)
    v_mfma_f32_32x32x16_bf16 v[104:119], a[32:35], v[188:191], v[104:119]
    ds_read_b64_tr_b16 v[184:185], v197 offset:8768
    ds_read_b64_tr_b16 v[186:187], v197 offset:10944
    s_waitcnt lgkmcnt(10)
    v_mfma_f32_32x32x16_bf16 v[120:135], a[32:35], v[192:195], v[120:135]
    ds_read_b64_tr_b16 v[188:189], v197 offset:8800
    ds_read_b64_tr_b16 v[190:191], v197 offset:10976
    s_waitcnt lgkmcnt(10)
    v_mfma_f32_32x32x16_bf16 v[136:151], a[32:35], v[168:171], v[136:151]
    ds_read_b64_tr_b16 v[192:193], v197 offset:8960
    ds_read_b64_tr_b16 v[194:195], v197 offset:11136
    s_waitcnt lgkmcnt(10)
    v_mfma_f32_32x32x16_bf16 v[152:167], a[32:35], v[172:175], v[152:167]
    ds_read_b64_tr_b16 v[168:169], v197 offset:8992
    ds_read_b64_tr_b16 v[170:171], v197 offset:11168
    s_waitcnt lgkmcnt(10)
    v_mfma_f32_32x32x16_bf16 v[40:55], a[36:39], v[176:179], v[40:55]
    ds_read_b64_tr_b16 v[172:173], v197 offset:9024
    ds_read_b64_tr_b16 v[174:175], v197 offset:11200
    s_waitcnt lgkmcnt(10)
    v_mfma_f32_32x32x16_bf16 v[56:71], a[36:39], v[180:183], v[56:71]
    ds_read_b64_tr_b16 v[176:177], v197 offset:9056
    ds_read_b64_tr_b16 v[178:179], v197 offset:11232
    s_waitcnt lgkmcnt(10)
    v_mfma_f32_32x32x16_bf16 v[72:87], a[36:39], v[184:187], v[72:87]
    s_waitcnt vmcnt(24)
    s_barrier
    s_mov_b32 s37, 1310720
    buffer_load_dwordx4 a[80:83], v5, s[16:19], s37 offen
    s_mov_b32 s37, 1376256
    buffer_load_dwordx4 a[84:87], v5, s[16:19], s37 offen
    s_mov_b32 s44, 983040
    s_cmp_ge_u32 s14, 1
    s_cbranch_scc1 L_k1_v_dskip10
    s_mov_b32 m0, 51200
    s_nop 1
    buffer_load_dwordx4 v203, s[20:23], s44 offen lds
L_k1_v_dskip10:
    s_nop 0
    s_add_u32 m0, s38, 34816
    s_nop 0
    buffer_load_dwordx4 v199, s[20:23], s44 offen lds
    s_add_u32 m0, s38, 38912
    s_nop 0
    buffer_load_dwordx4 v200, s[20:23], s44 offen lds
    s_add_u32 m0, s38, 43008
    s_nop 0
    buffer_load_dwordx4 v201, s[20:23], s44 offen lds
    s_add_u32 m0, s38, 47104
    s_nop 0
    buffer_load_dwordx4 v202, s[20:23], s44 offen lds
    v_add_u32 v198, 87040, v196
    ds_read_b64_tr_b16 v[180:181], v198 offset:0
    ds_read_b64_tr_b16 v[182:183], v198 offset:2176
    s_waitcnt lgkmcnt(10)
    v_mfma_f32_32x32x16_bf16 v[88:103], a[36:39], v[188:191], v[88:103]
    ds_read_b64_tr_b16 v[184:185], v198 offset:32
    ds_read_b64_tr_b16 v[186:187], v198 offset:2208
    s_waitcnt lgkmcnt(10)
    v_mfma_f32_32x32x16_bf16 v[104:119], a[36:39], v[192:195], v[104:119]
    ds_read_b64_tr_b16 v[188:189], v198 offset:64
    ds_read_b64_tr_b16 v[190:191], v198 offset:2240
    s_waitcnt lgkmcnt(10)
    v_mfma_f32_32x32x16_bf16 v[120:135], a[36:39], v[168:171], v[120:135]
    ds_read_b64_tr_b16 v[192:193], v198 offset:96
    ds_read_b64_tr_b16 v[194:195], v198 offset:2272
    s_waitcnt lgkmcnt(10)
    v_mfma_f32_32x32x16_bf16 v[136:151], a[36:39], v[172:175], v[136:151]
    ds_read_b64_tr_b16 v[168:169], v198 offset:256
    ds_read_b64_tr_b16 v[170:171], v198 offset:2432
    s_waitcnt lgkmcnt(10)
    v_mfma_f32_32x32x16_bf16 v[152:167], a[36:39], v[176:179], v[152:167]
    ds_read_b64_tr_b16 v[172:173], v198 offset:288
    ds_read_b64_tr_b16 v[174:175], v198 offset:2464
    s_waitcnt lgkmcnt(10)
    v_mfma_f32_32x32x16_bf16 v[40:55], a[40:43], v[180:183], v[40:55]
    ds_read_b64_tr_b16 v[176:177], v198 offset:320
    ds_read_b64_tr_b16 v[178:179], v198 offset:2496
    s_waitcnt lgkmcnt(10)
    v_mfma_f32_32x32x16_bf16 v[56:71], a[40:43], v[184:187], v[56:71]
    ds_read_b64_tr_b16 v[180:181], v198 offset:352
    ds_read_b64_tr_b16 v[182:183], v198 offset:2528
    s_waitcnt lgkmcnt(10)
    v_mfma_f32_32x32x16_bf16 v[72:87], a[40:43], v[188:191], v[72:87]
    ds_read_b64_tr_b16 v[184:185], v198 offset:8704
    ds_read_b64_tr_b16 v[186:187], v198 offset:10880
    s_waitcnt lgkmcnt(10)
    v_mfma_f32_32x32x16_bf16 v[88:103], a[40:43], v[192:195], v[88:103]
    ds_read_b64_tr_b16 v[188:189], v198 offset:8736
    ds_read_b64_tr_b16 v[190:191], v198 offset:10912
    s_waitcnt lgkmcnt(10)
    v_mfma_f32_32x32x16_bf16 v[104:119], a[40:43], v[168:171], v[104:119]
    ds_read_b64_tr_b16 v[192:193], v198 offset:8768
    ds_read_b64_tr_b16 v[194:195], v198 offset:10944
    s_waitcnt lgkmcnt(10)
    v_mfma_f32_32x32x16_bf16 v[120:135], a[40:43], v[172:175], v[120:135]
    ds_read_b64_tr_b16 v[168:169], v198 offset:8800
    ds_read_b64_tr_b16 v[170:171], v198 offset:10976
    s_waitcnt lgkmcnt(10)
    v_mfma_f32_32x32x16_bf16 v[136:151], a[40:43], v[176:179], v[136:151]
    ds_read_b64_tr_b16 v[172:173], v198 offset:8960
    ds_read_b64_tr_b16 v[174:175], v198 offset:11136
    s_waitcnt lgkmcnt(10)
    v_mfma_f32_32x32x16_bf16 v[152:167], a[40:43], v[180:183], v[152:167]
    ds_read_b64_tr_b16 v[176:177], v198 offset:8992
    ds_read_b64_tr_b16 v[178:179], v198 offset:11168
    s_waitcnt lgkmcnt(10)
    v_mfma_f32_32x32x16_bf16 v[40:55], a[44:47], v[184:187], v[40:55]
    ds_read_b64_tr_b16 v[180:181], v198 offset:9024
    ds_read_b64_tr_b16 v[182:183], v198 offset:11200
    s_waitcnt lgkmcnt(10)
    v_mfma_f32_32x32x16_bf16 v[56:71], a[44:47], v[188:191], v[56:71]
    ds_read_b64_tr_b16 v[184:185], v198 offset:9056
    ds_read_b64_tr_b16 v[186:187], v198 offset:11232
    s_waitcnt lgkmcnt(10)
    v_mfma_f32_32x32x16_bf16 v[72:87], a[44:47], v[192:195], v[72:87]
    s_waitcnt vmcnt(24)
    s_barrier
    s_mov_b32 s37, 1441792
    buffer_load_dwordx4 a[88:91], v5, s[16:19], s37 offen
    s_mov_b32 s37, 1507328
    buffer_load_dwordx4 a[92:95], v5, s[16:19], s37 offen
    s_mov_b32 s44, 1081344
    s_cmp_ge_u32 s14, 1
    s_cbranch_scc1 L_k1_v_dskip11
    s_mov_b32 m0, 68608
    s_nop 1
    buffer_load_dwordx4 v203, s[20:23], s44 offen lds
L_k1_v_dskip11:
    s_nop 0
    s_add_u32 m0, s38, 52224
    s_nop 0
    buffer_load_dwordx4 v199, s[20:23], s44 offen lds
    s_add_u32 m0, s38, 56320
    s_nop 0
    buffer_load_dwordx4 v200, s[20:23], s44 offen lds
    s_add_u32 m0, s38, 60416
    s_nop 0
    buffer_load_dwordx4 v201, s[20:23], s44 offen lds
    s_add_u32 m0, s38, 64512
    s_nop 0
    buffer_load_dwordx4 v202, s[20:23], s44 offen lds
    v_add_u32 v197, 104448, v196
    ds_read_b64_tr_b16 v[188:189], v197 offset:0
    ds_read_b64_tr_b16 v[190:191], v197 offset:2176
    s_waitcnt lgkmcnt(10)
    v_mfma_f32_32x32x16_bf16 v[88:103], a[44:47], v[168:171], v[88:103]
    ds_read_b64_tr_b16 v[192:193], v197 offset:32
    ds_read_b64_tr_b16 v[194:195], v197 offset:2208
    s_waitcnt lgkmcnt(10)
    v_mfma_f32_32x32x16_bf16 v[104:119], a[44:47], v[172:175], v[104:119]
    ds_read_b64_tr_b16 v[168:169], v197 offset:64
    ds_read_b64_tr_b16 v[170:171], v197 offset:2240
    s_waitcnt lgkmcnt(10)
    v_mfma_f32_32x32x16_bf16 v[120:135], a[44:47], v[176:179], v[120:135]
    ds_read_b64_tr_b16 v[172:173], v197 offset:96
    ds_read_b64_tr_b16 v[174:175], v197 offset:2272
    s_waitcnt lgkmcnt(10)
    v_mfma_f32_32x32x16_bf16 v[136:151], a[44:47], v[180:183], v[136:151]
    ds_read_b64_tr_b16 v[176:177], v197 offset:256
    ds_read_b64_tr_b16 v[178:179], v197 offset:2432
    s_waitcnt lgkmcnt(10)
    v_mfma_f32_32x32x16_bf16 v[152:167], a[44:47], v[184:187], v[152:167]
    ds_read_b64_tr_b16 v[180:181], v197 offset:288
    ds_read_b64_tr_b16 v[182:183], v197 offset:2464
    s_waitcnt lgkmcnt(10)
    v_mfma_f32_32x32x16_bf16 v[40:55], a[48:51], v[188:191], v[40:55]
    ds_read_b64_tr_b16 v[184:185], v197 offset:320
    ds_read_b64_tr_b16 v[186:187], v197 offset:2496
    s_waitcnt lgkmcnt(10)
    v_mfma_f32_32x32x16_bf16 v[56:71], a[48:51], v[192:195], v[56:71]
    ds_read_b64_tr_b16 v[188:189], v197 offset:352
    ds_read_b64_tr_b16 v[190:191], v197 offset:2528
    s_waitcnt lgkmcnt(10)
    v_mfma_f32_32x32x16_bf16 v[72:87], a[48:51], v[168:171], v[72:87]
    ds_read_b64_tr_b16 v[192:193], v197 offset:8704
    ds_read_b64_tr_b16 v[194:195], v197 offset:10880
    s_waitcnt lgkmcnt(10)
    v_mfma_f32_32x32x16_bf16 v[88:103], a[48:51], v[172:175], v[88:103]
    ds_read_b64_tr_b16 v[168:169], v197 offset:8736
    ds_read_b64_tr_b16 v[170:171], v197 offset:10912
    s_waitcnt lgkmcnt(10)
    v_mfma_f32_32x32x16_bf16 v[104:119], a[48:51], v[176:179], v[104:119]
    ds_read_b64_tr_b16 v[172:173], v197 offset:8768
    ds_read_b64_tr_b16 v[174:175], v197 offset:10944
    s_waitcnt lgkmcnt(10)
    v_mfma_f32_32x32x16_bf16 v[120:135], a[48:51], v[180:183], v[120:135]
    ds_read_b64_tr_b16 v[176:177], v197 offset:8800
    ds_read_b64_tr_b16 v[178:179], v197 offset:10976
    s_waitcnt lgkmcnt(10)
    v_mfma_f32_32x32x16_bf16 v[136:151], a[48:51], v[184:187], v[136:151]
    ds_read_b64_tr_b16 v[180:181], v197 offset:8960
    ds_read_b64_tr_b16 v[182:183], v197 offset:11136
    s_waitcnt lgkmcnt(10)
    v_mfma_f32_32x32x16_bf16 v[152:167], a[48:51], v[188:191], v[152:167]
    ds_read_b64_tr_b16 v[184:185], v197 offset:8992
    ds_read_b64_tr_b16 v[186:187], v197 offset:11168
    s_waitcnt lgkmcnt(10)
    v_mfma_f32_32x32x16_bf16 v[40:55], a[52:55], v[192:195], v[40:55]
    ds_read_b64_tr_b16 v[188:189], v197 offset:9024
    ds_read_b64_tr_b16 v[190:191], v197 offset:11200
    s_waitcnt lgkmcnt(10)
    v_mfma_f32_32x32x16_bf16 v[56:71], a[52:55], v[168:171], v[56:71]
    ds_read_b64_tr_b16 v[192:193], v197 offset:9056
    ds_read_b64_tr_b16 v[194:195], v197 offset:11232
    s_waitcnt lgkmcnt(10)
    v_mfma_f32_32x32x16_bf16 v[72:87], a[52:55], v[172:175], v[72:87]
    s_waitcnt vmcnt(24)
    s_barrier
    s_mov_b32 s37, 1572864
    buffer_load_dwordx4 a[96:99], v5, s[16:19], s37 offen
    s_mov_b32 s37, 1638400
    buffer_load_dwordx4 a[100:103], v5, s[16:19], s37 offen
    s_mov_b32 s44, 1179648
    s_cmp_ge_u32 s14, 1
    s_cbranch_scc1 L_k1_v_dskip12
    s_mov_b32 m0, 86016
    s_nop 1
    buffer_load_dwordx4 v203, s[20:23], s44 offen lds
L_k1_v_dskip12:
    s_nop 0
    s_add_u32 m0, s38, 69632
    s_nop 0
    buffer_load_dwordx4 v199, s[20:23], s44 offen lds
    s_add_u32 m0, s38, 73728
    s_nop 0
    buffer_load_dwordx4 v200, s[20:23], s44 offen lds
    s_add_u32 m0, s38, 77824
    s_nop 0
    buffer_load_dwordx4 v201, s[20:23], s44 offen lds
    s_add_u32 m0, s38, 81920
    s_nop 0
    buffer_load_dwordx4 v202, s[20:23], s44 offen lds
    v_add_u32 v198, 121856, v196
    ds_read_b64_tr_b16 v[168:169], v198 offset:0
    ds_read_b64_tr_b16 v[170:171], v198 offset:2176
    s_waitcnt lgkmcnt(10)
    v_mfma_f32_32x32x16_bf16 v[88:103], a[52:55], v[176:179], v[88:103]
    ds_read_b64_tr_b16 v[172:173], v198 offset:32
    ds_read_b64_tr_b16 v[174:175], v198 offset:2208
    s_waitcnt lgkmcnt(10)
    v_mfma_f32_32x32x16_bf16 v[104:119], a[52:55], v[180:183], v[104:119]
    ds_read_b64_tr_b16 v[176:177], v198 offset:64
    ds_read_b64_tr_b16 v[178:179], v198 offset:2240
    s_waitcnt lgkmcnt(10)
    v_mfma_f32_32x32x16_bf16 v[120:135], a[52:55], v[184:187], v[120:135]
    ds_read_b64_tr_b16 v[180:181], v198 offset:96
    ds_read_b64_tr_b16 v[182:183], v198 offset:2272
    s_waitcnt lgkmcnt(10)
    v_mfma_f32_32x32x16_bf16 v[136:151], a[52:55], v[188:191], v[136:151]
    ds_read_b64_tr_b16 v[184:185], v198 offset:256
    ds_read_b64_tr_b16 v[186:187], v198 offset:2432
    s_waitcnt lgkmcnt(10)
    v_mfma_f32_32x32x16_bf16 v[152:167], a[52:55], v[192:195], v[152:167]
    ds_read_b64_tr_b16 v[188:189], v198 offset:288
    ds_read_b64_tr_b16 v[190:191], v198 offset:2464
    s_waitcnt lgkmcnt(10)
    v_mfma_f32_32x32x16_bf16 v[40:55], a[56:59], v[168:171], v[40:55]
    ds_read_b64_tr_b16 v[192:193], v198 offset:320
    ds_read_b64_tr_b16 v[194:195], v198 offset:2496
    s_waitcnt lgkmcnt(10)
    v_mfma_f32_32x32x16_bf16 v[56:71], a[56:59], v[172:175], v[56:71]
    ds_read_b64_tr_b16 v[168:169], v198 offset:352
    ds_read_b64_tr_b16 v[170:171], v198 offset:2528
    s_waitcnt lgkmcnt(10)
    v_mfma_f32_32x32x16_bf16 v[72:87], a[56:59], v[176:179], v[72:87]
    ds_read_b64_tr_b16 v[172:173], v198 offset:8704
    ds_read_b64_tr_b16 v[174:175], v198 offset:10880
    s_waitcnt lgkmcnt(10)
    v_mfma_f32_32x32x16_bf16 v[88:103], a[56:59], v[180:183], v[88:103]
    ds_read_b64_tr_b16 v[176:177], v198 offset:8736
    ds_read_b64_tr_b16 v[178:179], v198 offset:10912
    s_waitcnt lgkmcnt(10)
    v_mfma_f32_32x32x16_bf16 v[104:119], a[56:59], v[184:187], v[104:119]
    ds_read_b64_tr_b16 v[180:181], v198 offset:8768
    ds_read_b64_tr_b16 v[182:183], v198 offset:10944
    s_waitcnt lgkmcnt(10)
    v_mfma_f32_32x32x16_bf16 v[120:135], a[56:59], v[188:191], v[120:135]
    ds_read_b64_tr_b16 v[184:185], v198 offset:8800
    ds_read_b64_tr_b16 v[186:187], v198 offset:10976
    s_waitcnt lgkmcnt(10)
    v_mfma_f32_32x32x16_bf16 v[136:151], a[56:59], v[192:195], v[136:151]
    ds_read_b64_tr_b16 v[188:189], v198 offset:8960
    ds_read_b64_tr_b16 v[190:191], v198 offset:11136
    s_waitcnt lgkmcnt(10)
    v_mfma_f32_32x32x16_bf16 v[152:167], a[56:59], v[168:171], v[152:167]
    ds_read_b64_tr_b16 v[192:193], v198 offset:8992
    ds_read_b64_tr_b16 v[194:195], v198 offset:11168
    s_waitcnt lgkmcnt(10)
    v_mfma_f32_32x32x16_bf16 v[40:55], a[60:63], v[172:175], v[40:55]
    ds_read_b64_tr_b16 v[168:169], v198 offset:9024
    ds_read_b64_tr_b16 v[170:171], v198 offset:11200
    s_waitcnt lgkmcnt(10)
    v_mfma_f32_32x32x16_bf16 v[56:71], a[60:63], v[176:179], v[56:71]
    ds_read_b64_tr_b16 v[172:173], v198 offset:9056
    ds_read_b64_tr_b16 v[174:175], v198 offset:11232
    s_waitcnt lgkmcnt(10)
    v_mfma_f32_32x32x16_bf16 v[72:87], a[60:63], v[180:183], v[72:87]
    s_waitcnt vmcnt(24)
    s_barrier
    s_mov_b32 s37, 1703936
    buffer_load_dwordx4 a[104:107], v5, s[16:19], s37 offen
    s_mov_b32 s37, 1769472
    buffer_load_dwordx4 a[108:111], v5, s[16:19], s37 offen
    s_mov_b32 s44, 1277952
    s_cmp_ge_u32 s14, 1
    s_cbranch_scc1 L_k1_v_dskip13
    s_mov_b32 m0, 103424
    s_nop 1
    buffer_load_dwordx4 v203, s[20:23], s44 offen lds
L_k1_v_dskip13:
    s_nop 0
    s_add_u32 m0, s38, 87040
    s_nop 0
    buffer_load_dwordx4 v199, s[20:23], s44 offen lds
    s_add_u32 m0, s38, 91136
    s_nop 0
    buffer_load_dwordx4 v200, s[20:23], s44 offen lds
    s_add_u32 m0, s38, 95232
    s_nop 0
    buffer_load_dwordx4 v201, s[20:23], s44 offen lds
    s_add_u32 m0, s38, 99328
    s_nop 0
    buffer_load_dwordx4 v202, s[20:23], s44 offen lds
    v_add_u32 v197, 0, v196
    ds_read_b64_tr_b16 v[176:177], v197 offset:0
    ds_read_b64_tr_b16 v[178:179], v197 offset:2176
    s_waitcnt lgkmcnt(10)
    v_mfma_f32_32x32x16_bf16 v[88:103], a[60:63], v[184:187], v[88:103]
    ds_read_b64_tr_b16 v[180:181], v197 offset:32
    ds_read_b64_tr_b16 v[182:183], v197 offset:2208
    s_waitcnt lgkmcnt(10)
    v_mfma_f32_32x32x16_bf16 v[104:119], a[60:63], v[188:191], v[104:119]
    ds_read_b64_tr_b16 v[184:185], v197 offset:64
    ds_read_b64_tr_b16 v[186:187], v197 offset:2240
    s_waitcnt lgkmcnt(10)
    v_mfma_f32_32x32x16_bf16 v[120:135], a[60:63], v[192:195], v[120:135]
    ds_read_b64_tr_b16 v[188:189], v197 offset:96
    ds_read_b64_tr_b16 v[190:191], v197 offset:2272
    s_waitcnt lgkmcnt(10)
    v_mfma_f32_32x32x16_bf16 v[136:151], a[60:63], v[168:171], v[136:151]
    ds_read_b64_tr_b16 v[192:193], v197 offset:256
    ds_read_b64_tr_b16 v[194:195], v197 offset:2432
    s_waitcnt lgkmcnt(10)
    v_mfma_f32_32x32x16_bf16 v[152:167], a[60:63], v[172:175], v[152:167]
    ds_read_b64_tr_b16 v[168:169], v197 offset:288
    ds_read_b64_tr_b16 v[170:171], v197 offset:2464
    s_waitcnt lgkmcnt(10)
    v_mfma_f32_32x32x16_bf16 v[40:55], a[64:67], v[176:179], v[40:55]
    ds_read_b64_tr_b16 v[172:173], v197 offset:320
    ds_read_b64_tr_b16 v[174:175], v197 offset:2496
    s_waitcnt lgkmcnt(10)
    v_mfma_f32_32x32x16_bf16 v[56:71], a[64:67], v[180:183], v[56:71]
    ds_read_b64_tr_b16 v[176:177], v197 offset:352
    ds_read_b64_tr_b16 v[178:179], v197 offset:2528
    s_waitcnt lgkmcnt(10)
    v_mfma_f32_32x32x16_bf16 v[72:87], a[64:67], v[184:187], v[72:87]
    ds_read_b64_tr_b16 v[180:181], v197 offset:8704
    ds_read_b64_tr_b16 v[182:183], v197 offset:10880
    s_waitcnt lgkmcnt(10)
    v_mfma_f32_32x32x16_bf16 v[88:103], a[64:67], v[188:191], v[88:103]
    ds_read_b64_tr_b16 v[184:185], v197 offset:8736
    ds_read_b64_tr_b16 v[186:187], v197 offset:10912
    s_waitcnt lgkmcnt(10)
    v_mfma_f32_32x32x16_bf16 v[104:119], a[64:67], v[192:195], v[104:119]
    ds_read_b64_tr_b16 v[188:189], v197 offset:8768
    ds_read_b64_tr_b16 v[190:191], v197 offset:10944
    s_waitcnt lgkmcnt(10)
    v_mfma_f32_32x32x16_bf16 v[120:135], a[64:67], v[168:171], v[120:135]
    ds_read_b64_tr_b16 v[192:193], v197 offset:8800
    ds_read_b64_tr_b16 v[194:195], v197 offset:10976
    s_waitcnt lgkmcnt(10)
    v_mfma_f32_32x32x16_bf16 v[136:151], a[64:67], v[172:175], v[136:151]
    ds_read_b64_tr_b16 v[168:169], v197 offset:8960
    ds_read_b64_tr_b16 v[170:171], v197 offset:11136
    s_waitcnt lgkmcnt(10)
    v_mfma_f32_32x32x16_bf16 v[152:167], a[64:67], v[176:179], v[152:167]
    ds_read_b64_tr_b16 v[172:173], v197 offset:8992
    ds_read_b64_tr_b16 v[174:175], v197 offset:11168
    s_waitcnt lgkmcnt(10)
    v_mfma_f32_32x32x16_bf16 v[40:55], a[68:71], v[180:183], v[40:55]
    ds_read_b64_tr_b16 v[176:177], v197 offset:9024
    ds_read_b64_tr_b16 v[178:179], v197 offset:11200
    s_waitcnt lgkmcnt(10)
    v_mfma_f32_32x32x16_bf16 v[56:71], a[68:71], v[184:187], v[56:71]
    ds_read_b64_tr_b16 v[180:181], v197 offset:9056
    ds_read_b64_tr_b16 v[182:183], v197 offset:11232
    s_waitcnt lgkmcnt(10)
    v_mfma_f32_32x32x16_bf16 v[72:87], a[68:71], v[188:191], v[72:87]
    s_waitcnt vmcnt(24)
    s_barrier
    s_mov_b32 s37, 1835008
    buffer_load_dwordx4 a[112:115], v5, s[16:19], s37 offen
    s_mov_b32 s37, 1900544
    buffer_load_dwordx4 a[116:119], v5, s[16:19], s37 offen
    s_mov_b32 s44, 1376256
    s_cmp_ge_u32 s14, 1
    s_cbranch_scc1 L_k1_v_dskip14
    s_mov_b32 m0, 120832
    s_nop 1
    buffer_load_dwordx4 v203, s[20:23], s44 offen lds
L_k1_v_dskip14:
    s_nop 0
    s_add_u32 m0, s38, 104448
    s_nop 0
    buffer_load_dwordx4 v199, s[20:23], s44 offen lds
    s_add_u32 m0, s38, 108544
    s_nop 0
    buffer_load_dwordx4 v200, s[20:23], s44 offen lds
    s_add_u32 m0, s38, 112640
    s_nop 0
    buffer_load_dwordx4 v201, s[20:23], s44 offen lds
    s_add_u32 m0, s38, 116736
    s_nop 0
    buffer_load_dwordx4 v202, s[20:23], s44 offen lds
    v_add_u32 v198, 17408, v196
    ds_read_b64_tr_b16 v[184:185], v198 offset:0
    ds_read_b64_tr_b16 v[186:187], v198 offset:2176
    s_waitcnt lgkmcnt(10)
    v_mfma_f32_32x32x16_bf16 v[88:103], a[68:71], v[192:195], v[88:103]
    ds_read_b64_tr_b16 v[188:189], v198 offset:32
    ds_read_b64_tr_b16 v[190:191], v198 offset:2208
    s_waitcnt lgkmcnt(10)
    v_mfma_f32_32x32x16_bf16 v[104:119], a[68:71], v[168:171], v[104:119]
    ds_read_b64_tr_b16 v[192:193], v198 offset:64
    ds_read_b64_tr_b16 v[194:195], v198 offset:2240
    s_waitcnt lgkmcnt(10)
    v_mfma_f32_32x32x16_bf16 v[120:135], a[68:71], v[172:175], v[120:135]
    ds_read_b64_tr_b16 v[168:169], v198 offset:96
    ds_read_b64_tr_b16 v[170:171], v198 offset:2272
    s_waitcnt lgkmcnt(10)
    v_mfma_f32_32x32x16_bf16 v[136:151], a[68:71], v[176:179], v[136:151]
    ds_read_b64_tr_b16 v[172:173], v198 offset:256
    ds_read_b64_tr_b16 v[174:175], v198 offset:2432
    s_waitcnt lgkmcnt(10)
    v_mfma_f32_32x32x16_bf16 v[152:167], a[68:71], v[180:183], v[152:167]
    ds_read_b64_tr_b16 v[176:177], v198 offset:288
    ds_read_b64_tr_b16 v[178:179], v198 offset:2464
    s_waitcnt lgkmcnt(10)
    v_mfma_f32_32x32x16_bf16 v[40:55], a[72:75], v[184:187], v[40:55]
    ds_read_b64_tr_b16 v[180:181], v198 offset:320
    ds_read_b64_tr_b16 v[182:183], v198 offset:2496
    s_waitcnt lgkmcnt(10)
    v_mfma_f32_32x32x16_bf16 v[56:71], a[72:75], v[188:191], v[56:71]
    ds_read_b64_tr_b16 v[184:185], v198 offset:352
    ds_read_b64_tr_b16 v[186:187], v198 offset:2528
    s_waitcnt lgkmcnt(10)
    v_mfma_f32_32x32x16_bf16 v[72:87], a[72:75], v[192:195], v[72:87]
    ds_read_b64_tr_b16 v[188:189], v198 offset:8704
    ds_read_b64_tr_b16 v[190:191], v198 offset:10880
    s_waitcnt lgkmcnt(10)
    v_mfma_f32_32x32x16_bf16 v[88:103], a[72:75], v[168:171], v[88:103]
    ds_read_b64_tr_b16 v[192:193], v198 offset:8736
    ds_read_b64_tr_b16 v[194:195], v198 offset:10912
    s_waitcnt lgkmcnt(10)
    v_mfma_f32_32x32x16_bf16 v[104:119], a[72:75], v[172:175], v[104:119]
    ds_read_b64_tr_b16 v[168:169], v198 offset:8768
    ds_read_b64_tr_b16 v[170:171], v198 offset:10944
    s_waitcnt lgkmcnt(10)
    v_mfma_f32_32x32x16_bf16 v[120:135], a[72:75], v[176:179], v[120:135]
    ds_read_b64_tr_b16 v[172:173], v198 offset:8800
    ds_read_b64_tr_b16 v[174:175], v198 offset:10976
    s_waitcnt lgkmcnt(10)
    v_mfma_f32_32x32x16_bf16 v[136:151], a[72:75], v[180:183], v[136:151]
    ds_read_b64_tr_b16 v[176:177], v198 offset:8960
    ds_read_b64_tr_b16 v[178:179], v198 offset:11136
    s_waitcnt lgkmcnt(10)
    v_mfma_f32_32x32x16_bf16 v[152:167], a[72:75], v[184:187], v[152:167]
    ds_read_b64_tr_b16 v[180:181], v198 offset:8992
    ds_read_b64_tr_b16 v[182:183], v198 offset:11168
    s_waitcnt lgkmcnt(10)
    v_mfma_f32_32x32x16_bf16 v[40:55], a[76:79], v[188:191], v[40:55]
    ds_read_b64_tr_b16 v[184:185], v198 offset:9024
    ds_read_b64_tr_b16 v[186:187], v198 offset:11200
    s_waitcnt lgkmcnt(10)
    v_mfma_f32_32x32x16_bf16 v[56:71], a[76:79], v[192:195], v[56:71]
    ds_read_b64_tr_b16 v[188:189], v198 offset:9056
    ds_read_b64_tr_b16 v[190:191], v198 offset:11232
    s_waitcnt lgkmcnt(10)
    v_mfma_f32_32x32x16_bf16 v[72:87], a[76:79], v[168:171], v[72:87]
    s_waitcnt vmcnt(24)
    s_barrier
    s_mov_b32 s37, 1966080
    buffer_load_dwordx4 a[120:123], v5, s[16:19], s37 offen
    s_mov_b32 s37, 2031616
    buffer_load_dwordx4 a[124:127], v5, s[16:19], s37 offen
    s_mov_b32 s44, 1474560
    s_cmp_ge_u32 s14, 1
    s_cbranch_scc1 L_k1_v_dskip15
    s_mov_b32 m0, 138240
    s_nop 1
    buffer_load_dwordx4 v203, s[20:23], s44 offen lds
L_k1_v_dskip15:
    s_nop 0
    s_add_u32 m0, s38, 121856
    s_nop 0
    buffer_load_dwordx4 v199, s[20:23], s44 offen lds
    s_add_u32 m0, s38, 125952
    s_nop 0
    buffer_load_dwordx4 v200, s[20:23], s44 offen lds
    s_add_u32 m0, s38, 130048
    s_nop 0
    buffer_load_dwordx4 v201, s[20:23], s44 offen lds
    s_add_u32 m0, s38, 134144
    s_nop 0
    buffer_load_dwordx4 v202, s[20:23], s44 offen lds
    v_add_u32 v197, 34816, v196
    ds_read_b64_tr_b16 v[192:193], v197 offset:0
    ds_read_b64_tr_b16 v[194:195], v197 offset:2176
    s_waitcnt lgkmcnt(10)
    v_mfma_f32_32x32x16_bf16 v[88:103], a[76:79], v[172:175], v[88:103]
    ds_read_b64_tr_b16 v[168:169], v197 offset:32
    ds_read_b64_tr_b16 v[170:171], v197 offset:2208
    s_waitcnt lgkmcnt(10)
    v_mfma_f32_32x32x16_bf16 v[104:119], a[76:79], v[176:179], v[104:119]
    ds_read_b64_tr_b16 v[172:173], v197 offset:64
    ds_read_b64_tr_b16 v[174:175], v197 offset:2240
    s_waitcnt lgkmcnt(10)
    v_mfma_f32_32x32x16_bf16 v[120:135], a[76:79], v[180:183], v[120:135]
    ds_read_b64_tr_b16 v[176:177], v197 offset:96
    ds_read_b64_tr_b16 v[178:179], v197 offset:2272
    s_waitcnt lgkmcnt(10)
    v_mfma_f32_32x32x16_bf16 v[136:151], a[76:79], v[184:187], v[136:151]
    ds_read_b64_tr_b16 v[180:181], v197 offset:256
    ds_read_b64_tr_b16 v[182:183], v197 offset:2432
    s_waitcnt lgkmcnt(10)
    v_mfma_f32_32x32x16_bf16 v[152:167], a[76:79], v[188:191], v[152:167]
    ds_read_b64_tr_b16 v[184:185], v197 offset:288
    ds_read_b64_tr_b16 v[186:187], v197 offset:2464
    s_waitcnt lgkmcnt(10)
    v_mfma_f32_32x32x16_bf16 v[40:55], a[80:83], v[192:195], v[40:55]
    ds_read_b64_tr_b16 v[188:189], v197 offset:320
    ds_read_b64_tr_b16 v[190:191], v197 offset:2496
    s_waitcnt lgkmcnt(10)
    v_mfma_f32_32x32x16_bf16 v[56:71], a[80:83], v[168:171], v[56:71]
    ds_read_b64_tr_b16 v[192:193], v197 offset:352
    ds_read_b64_tr_b16 v[194:195], v197 offset:2528
    s_waitcnt lgkmcnt(10)
    v_mfma_f32_32x32x16_bf16 v[72:87], a[80:83], v[172:175], v[72:87]
    ds_read_b64_tr_b16 v[168:169], v197 offset:8704
    ds_read_b64_tr_b16 v[170:171], v197 offset:10880
    s_waitcnt lgkmcnt(10)
    v_mfma_f32_32x32x16_bf16 v[88:103], a[80:83], v[176:179], v[88:103]
    ds_read_b64_tr_b16 v[172:173], v197 offset:8736
    ds_read_b64_tr_b16 v[174:175], v197 offset:10912
    s_waitcnt lgkmcnt(10)
    v_mfma_f32_32x32x16_bf16 v[104:119], a[80:83], v[180:183], v[104:119]
    ds_read_b64_tr_b16 v[176:177], v197 offset:8768
    ds_read_b64_tr_b16 v[178:179], v197 offset:10944
    s_waitcnt lgkmcnt(10)
    v_mfma_f32_32x32x16_bf16 v[120:135], a[80:83], v[184:187], v[120:135]
    ds_read_b64_tr_b16 v[180:181], v197 offset:8800
    ds_read_b64_tr_b16 v[182:183], v197 offset:10976
    s_waitcnt lgkmcnt(10)
    v_mfma_f32_32x32x16_bf16 v[136:151], a[80:83], v[188:191], v[136:151]
    ds_read_b64_tr_b16 v[184:185], v197 offset:8960
    ds_read_b64_tr_b16 v[186:187], v197 offset:11136
    s_waitcnt lgkmcnt(10)
    v_mfma_f32_32x32x16_bf16 v[152:167], a[80:83], v[192:195], v[152:167]
    ds_read_b64_tr_b16 v[188:189], v197 offset:8992
    ds_read_b64_tr_b16 v[190:191], v197 offset:11168
    s_waitcnt lgkmcnt(10)
    v_mfma_f32_32x32x16_bf16 v[40:55], a[84:87], v[168:171], v[40:55]
    ds_read_b64_tr_b16 v[192:193], v197 offset:9024
    ds_read_b64_tr_b16 v[194:195], v197 offset:11200
    s_waitcnt lgkmcnt(10)
    v_mfma_f32_32x32x16_bf16 v[56:71], a[84:87], v[172:175], v[56:71]
    ds_read_b64_tr_b16 v[168:169], v197 offset:9056
    ds_read_b64_tr_b16 v[170:171], v197 offset:11232
    s_waitcnt lgkmcnt(10)
    v_mfma_f32_32x32x16_bf16 v[72:87], a[84:87], v[176:179], v[72:87]
    s_waitcnt vmcnt(24)
    s_barrier
    v_add_u32 v198, 52224, v196
    ds_read_b64_tr_b16 v[172:173], v198 offset:0
    ds_read_b64_tr_b16 v[174:175], v198 offset:2176
    s_waitcnt lgkmcnt(10)
    v_mfma_f32_32x32x16_bf16 v[88:103], a[84:87], v[180:183], v[88:103]
    ds_read_b64_tr_b16 v[176:177], v198 offset:32
    ds_read_b64_tr_b16 v[178:179], v198 offset:2208
    s_waitcnt lgkmcnt(10)
    v_mfma_f32_32x32x16_bf16 v[104:119], a[84:87], v[184:187], v[104:119]
    ds_read_b64_tr_b16 v[180:181], v198 offset:64
    ds_read_b64_tr_b16 v[182:183], v198 offset:2240
    s_waitcnt lgkmcnt(10)
    v_mfma_f32_32x32x16_bf16 v[120:135], a[84:87], v[188:191], v[120:135]
    ds_read_b64_tr_b16 v[184:185], v198 offset:96
    ds_read_b64_tr_b16 v[186:187], v198 offset:2272
    s_waitcnt lgkmcnt(10)
    v_mfma_f32_32x32x16_bf16 v[136:151], a[84:87], v[192:195], v[136:151]
    ds_read_b64_tr_b16 v[188:189], v198 offset:256
    ds_read_b64_tr_b16 v[190:191], v198 offset:2432
    s_waitcnt lgkmcnt(10)
    v_mfma_f32_32x32x16_bf16 v[152:167], a[84:87], v[168:171], v[152:167]
    ds_read_b64_tr_b16 v[192:193], v198 offset:288
    ds_read_b64_tr_b16 v[194:195], v198 offset:2464
    s_waitcnt lgkmcnt(10)
    v_mfma_f32_32x32x16_bf16 v[40:55], a[88:91], v[172:175], v[40:55]
    ds_read_b64_tr_b16 v[168:169], v198 offset:320
    ds_read_b64_tr_b16 v[170:171], v198 offset:2496
    s_waitcnt lgkmcnt(10)
    v_mfma_f32_32x32x16_bf16 v[56:71], a[88:91], v[176:179], v[56:71]
    ds_read_b64_tr_b16 v[172:173], v198 offset:352
    ds_read_b64_tr_b16 v[174:175], v198 offset:2528
    s_waitcnt lgkmcnt(10)
    v_mfma_f32_32x32x16_bf16 v[72:87], a[88:91], v[180:183], v[72:87]
    ds_read_b64_tr_b16 v[176:177], v198 offset:8704
    ds_read_b64_tr_b16 v[178:179], v198 offset:10880
    s_waitcnt lgkmcnt(10)
    v_mfma_f32_32x32x16_bf16 v[88:103], a[88:91], v[184:187], v[88:103]
    ds_read_b64_tr_b16 v[180:181], v198 offset:8736
    ds_read_b64_tr_b16 v[182:183], v198 offset:10912
    s_waitcnt lgkmcnt(10)
    v_mfma_f32_32x32x16_bf16 v[104:119], a[88:91], v[188:191], v[104:119]
    ds_read_b64_tr_b16 v[184:185], v198 offset:8768
    ds_read_b64_tr_b16 v[186:187], v198 offset:10944
    s_waitcnt lgkmcnt(10)
    v_mfma_f32_32x32x16_bf16 v[120:135], a[88:91], v[192:195], v[120:135]
    ds_read_b64_tr_b16 v[188:189], v198 offset:8800
    ds_read_b64_tr_b16 v[190:191], v198 offset:10976
    s_waitcnt lgkmcnt(10)
    v_mfma_f32_32x32x16_bf16 v[136:151], a[88:91], v[168:171], v[136:151]
    ds_read_b64_tr_b16 v[192:193], v198 offset:8960
    ds_read_b64_tr_b16 v[194:195], v198 offset:11136
    s_waitcnt lgkmcnt(10)
    v_mfma_f32_32x32x16_bf16 v[152:167], a[88:91], v[172:175], v[152:167]
    ds_read_b64_tr_b16 v[168:169], v198 offset:8992
    ds_read_b64_tr_b16 v[170:171], v198 offset:11168
    s_waitcnt lgkmcnt(10)
    v_mfma_f32_32x32x16_bf16 v[40:55], a[92:95], v[176:179], v[40:55]
    ds_read_b64_tr_b16 v[172:173], v198 offset:9024
    ds_read_b64_tr_b16 v[174:175], v198 offset:11200
    s_waitcnt lgkmcnt(10)
    v_mfma_f32_32x32x16_bf16 v[56:71], a[92:95], v[180:183], v[56:71]
    ds_read_b64_tr_b16 v[176:177], v198 offset:9056
    ds_read_b64_tr_b16 v[178:179], v198 offset:11232
    s_waitcnt lgkmcnt(10)
    v_mfma_f32_32x32x16_bf16 v[72:87], a[92:95], v[184:187], v[72:87]
    s_waitcnt vmcnt(18)
    s_barrier
    v_add_u32 v197, 69632, v196
    ds_read_b64_tr_b16 v[180:181], v197 offset:0
    ds_read_b64_tr_b16 v[182:183], v197 offset:2176
    s_waitcnt lgkmcnt(10)
    v_mfma_f32_32x32x16_bf16 v[88:103], a[92:95], v[188:191], v[88:103]
    ds_read_b64_tr_b16 v[184:185], v197 offset:32
    ds_read_b64_tr_b16 v[186:187], v197 offset:2208
    s_waitcnt lgkmcnt(10)
    v_mfma_f32_32x32x16_bf16 v[104:119], a[92:95], v[192:195], v[104:119]
    ds_read_b64_tr_b16 v[188:189], v197 offset:64
    ds_read_b64_tr_b16 v[190:191], v197 offset:2240
    s_waitcnt lgkmcnt(10)
    v_mfma_f32_32x32x16_bf16 v[120:135], a[92:95], v[168:171], v[120:135]
    ds_read_b64_tr_b16 v[192:193], v197 offset:96
    ds_read_b64_tr_b16 v[194:195], v197 offset:2272
    s_waitcnt lgkmcnt(10)
    v_mfma_f32_32x32x16_bf16 v[136:151], a[92:95], v[172:175], v[136:151]
    ds_read_b64_tr_b16 v[168:169], v197 offset:256
    ds_read_b64_tr_b16 v[170:171], v197 offset:2432
    s_waitcnt lgkmcnt(10)
    v_mfma_f32_32x32x16_bf16 v[152:167], a[92:95], v[176:179], v[152:167]
    ds_read_b64_tr_b16 v[172:173], v197 offset:288
    ds_read_b64_tr_b16 v[174:175], v197 offset:2464
    s_waitcnt lgkmcnt(10)
    v_mfma_f32_32x32x16_bf16 v[40:55], a[96:99], v[180:183], v[40:55]
    ds_read_b64_tr_b16 v[176:177], v197 offset:320
    ds_read_b64_tr_b16 v[178:179], v197 offset:2496
    s_waitcnt lgkmcnt(10)
    v_mfma_f32_32x32x16_bf16 v[56:71], a[96:99], v[184:187], v[56:71]
    ds_read_b64_tr_b16 v[180:181], v197 offset:352
    ds_read_b64_tr_b16 v[182:183], v197 offset:2528
    s_waitcnt lgkmcnt(10)
    v_mfma_f32_32x32x16_bf16 v[72:87], a[96:99], v[188:191], v[72:87]
    ds_read_b64_tr_b16 v[184:185], v197 offset:8704
    ds_read_b64_tr_b16 v[186:187], v197 offset:10880
    s_waitcnt lgkmcnt(10)
    v_mfma_f32_32x32x16_bf16 v[88:103], a[96:99], v[192:195], v[88:103]
    ds_read_b64_tr_b16 v[188:189], v197 offset:8736
    ds_read_b64_tr_b16 v[190:191], v197 offset:10912
    s_waitcnt lgkmcnt(10)
    v_mfma_f32_32x32x16_bf16 v[104:119], a[96:99], v[168:171], v[104:119]
    ds_read_b64_tr_b16 v[192:193], v197 offset:8768
    ds_read_b64_tr_b16 v[194:195], v197 offset:10944
    s_waitcnt lgkmcnt(10)
    v_mfma_f32_32x32x16_bf16 v[120:135], a[96:99], v[172:175], v[120:135]
    ds_read_b64_tr_b16 v[168:169], v197 offset:8800
    ds_read_b64_tr_b16 v[170:171], v197 offset:10976
    s_waitcnt lgkmcnt(10)
    v_mfma_f32_32x32x16_bf16 v[136:151], a[96:99], v[176:179], v[136:151]
    ds_read_b64_tr_b16 v[172:173], v197 offset:8960
    ds_read_b64_tr_b16 v[174:175], v197 offset:11136
    s_waitcnt lgkmcnt(10)
    v_mfma_f32_32x32x16_bf16 v[152:167], a[96:99], v[180:183], v[152:167]
    ds_read_b64_tr_b16 v[176:177], v197 offset:8992
    ds_read_b64_tr_b16 v[178:179], v197 offset:11168
    s_waitcnt lgkmcnt(10)
    v_mfma_f32_32x32x16_bf16 v[40:55], a[100:103], v[184:187], v[40:55]
    ds_read_b64_tr_b16 v[180:181], v197 offset:9024
    ds_read_b64_tr_b16 v[182:183], v197 offset:11200
    s_waitcnt lgkmcnt(10)
    v_mfma_f32_32x32x16_bf16 v[56:71], a[100:103], v[188:191], v[56:71]
    ds_read_b64_tr_b16 v[184:185], v197 offset:9056
    ds_read_b64_tr_b16 v[186:187], v197 offset:11232
    s_waitcnt lgkmcnt(10)
    v_mfma_f32_32x32x16_bf16 v[72:87], a[100:103], v[192:195], v[72:87]
    s_waitcnt vmcnt(12)
    s_barrier
    v_add_u32 v198, 87040, v196
    ds_read_b64_tr_b16 v[188:189], v198 offset:0
    ds_read_b64_tr_b16 v[190:191], v198 offset:2176
    s_waitcnt lgkmcnt(10)
    v_mfma_f32_32x32x16_bf16 v[88:103], a[100:103], v[168:171], v[88:103]
    ds_read_b64_tr_b16 v[192:193], v198 offset:32
    ds_read_b64_tr_b16 v[194:195], v198 offset:2208
    s_waitcnt lgkmcnt(10)
    v_mfma_f32_32x32x16_bf16 v[104:119], a[100:103], v[172:175], v[104:119]
    ds_read_b64_tr_b16 v[168:169], v198 offset:64
    ds_read_b64_tr_b16 v[170:171], v198 offset:2240
    s_waitcnt lgkmcnt(10)
    v_mfma_f32_32x32x16_bf16 v[120:135], a[100:103], v[176:179], v[120:135]
    ds_read_b64_tr_b16 v[172:173], v198 offset:96
    ds_read_b64_tr_b16 v[174:175], v198 offset:2272
    s_waitcnt lgkmcnt(10)
    v_mfma_f32_32x32x16_bf16 v[136:151], a[100:103], v[180:183], v[136:151]
    ds_read_b64_tr_b16 v[176:177], v198 offset:256
    ds_read_b64_tr_b16 v[178:179], v198 offset:2432
    s_waitcnt lgkmcnt(10)
    v_mfma_f32_32x32x16_bf16 v[152:167], a[100:103], v[184:187], v[152:167]
    ds_read_b64_tr_b16 v[180:181], v198 offset:288
    ds_read_b64_tr_b16 v[182:183], v198 offset:2464
    s_waitcnt lgkmcnt(10)
    v_mfma_f32_32x32x16_bf16 v[40:55], a[104:107], v[188:191], v[40:55]
    ds_read_b64_tr_b16 v[184:185], v198 offset:320
    ds_read_b64_tr_b16 v[186:187], v198 offset:2496
    s_waitcnt lgkmcnt(10)
    v_mfma_f32_32x32x16_bf16 v[56:71], a[104:107], v[192:195], v[56:71]
    ds_read_b64_tr_b16 v[188:189], v198 offset:352
    ds_read_b64_tr_b16 v[190:191], v198 offset:2528
    s_waitcnt lgkmcnt(10)
    v_mfma_f32_32x32x16_bf16 v[72:87], a[104:107], v[168:171], v[72:87]
    ds_read_b64_tr_b16 v[192:193], v198 offset:8704
    ds_read_b64_tr_b16 v[194:195], v198 offset:10880
    s_waitcnt lgkmcnt(10)
    v_mfma_f32_32x32x16_bf16 v[88:103], a[104:107], v[172:175], v[88:103]
    ds_read_b64_tr_b16 v[168:169], v198 offset:8736
    ds_read_b64_tr_b16 v[170:171], v198 offset:10912
    s_waitcnt lgkmcnt(10)
    v_mfma_f32_32x32x16_bf16 v[104:119], a[104:107], v[176:179], v[104:119]
    ds_read_b64_tr_b16 v[172:173], v198 offset:8768
    ds_read_b64_tr_b16 v[174:175], v198 offset:10944
    s_waitcnt lgkmcnt(10)
    v_mfma_f32_32x32x16_bf16 v[120:135], a[104:107], v[180:183], v[120:135]
    ds_read_b64_tr_b16 v[176:177], v198 offset:8800
    ds_read_b64_tr_b16 v[178:179], v198 offset:10976
    s_waitcnt lgkmcnt(10)
    v_mfma_f32_32x32x16_bf16 v[136:151], a[104:107], v[184:187], v[136:151]
    ds_read_b64_tr_b16 v[180:181], v198 offset:8960
    ds_read_b64_tr_b16 v[182:183], v198 offset:11136
    s_waitcnt lgkmcnt(10)
    v_mfma_f32_32x32x16_bf16 v[152:167], a[104:107], v[188:191], v[152:167]
    ds_read_b64_tr_b16 v[184:185], v198 offset:8992
    ds_read_b64_tr_b16 v[186:187], v198 offset:11168
    s_waitcnt lgkmcnt(10)
    v_mfma_f32_32x32x16_bf16 v[40:55], a[108:111], v[192:195], v[40:55]
    ds_read_b64_tr_b16 v[188:189], v198 offset:9024
    ds_read_b64_tr_b16 v[190:191], v198 offset:11200
    s_waitcnt lgkmcnt(10)
    v_mfma_f32_32x32x16_bf16 v[56:71], a[108:111], v[168:171], v[56:71]
    ds_read_b64_tr_b16 v[192:193], v198 offset:9056
    ds_read_b64_tr_b16 v[194:195], v198 offset:11232
    s_waitcnt lgkmcnt(10)
    v_mfma_f32_32x32x16_bf16 v[72:87], a[108:111], v[172:175], v[72:87]
    s_waitcnt vmcnt(6)
    s_barrier
    v_add_u32 v197, 104448, v196
    ds_read_b64_tr_b16 v[168:169], v197 offset:0
    ds_read_b64_tr_b16 v[170:171], v197 offset:2176
    s_waitcnt lgkmcnt(10)
    v_mfma_f32_32x32x16_bf16 v[88:103], a[108:111], v[176:179], v[88:103]
    ds_read_b64_tr_b16 v[172:173], v197 offset:32
    ds_read_b64_tr_b16 v[174:175], v197 offset:2208
    s_waitcnt lgkmcnt(10)
    v_mfma_f32_32x32x16_bf16 v[104:119], a[108:111], v[180:183], v[104:119]
    ds_read_b64_tr_b16 v[176:177], v197 offset:64
    ds_read_b64_tr_b16 v[178:179], v197 offset:2240
    s_waitcnt lgkmcnt(10)
    v_mfma_f32_32x32x16_bf16 v[120:135], a[108:111], v[184:187], v[120:135]
    ds_read_b64_tr_b16 v[180:181], v197 offset:96
    ds_read_b64_tr_b16 v[182:183], v197 offset:2272
    s_waitcnt lgkmcnt(10)
    v_mfma_f32_32x32x16_bf16 v[136:151], a[108:111], v[188:191], v[136:151]
    ds_read_b64_tr_b16 v[184:185], v197 offset:256
    ds_read_b64_tr_b16 v[186:187], v197 offset:2432
    s_waitcnt lgkmcnt(10)
    v_mfma_f32_32x32x16_bf16 v[152:167], a[108:111], v[192:195], v[152:167]
    ds_read_b64_tr_b16 v[188:189], v197 offset:288
    ds_read_b64_tr_b16 v[190:191], v197 offset:2464
    s_waitcnt lgkmcnt(10)
    v_mfma_f32_32x32x16_bf16 v[40:55], a[112:115], v[168:171], v[40:55]
    ds_read_b64_tr_b16 v[192:193], v197 offset:320
    ds_read_b64_tr_b16 v[194:195], v197 offset:2496
    s_waitcnt lgkmcnt(10)
    v_mfma_f32_32x32x16_bf16 v[56:71], a[112:115], v[172:175], v[56:71]
    ds_read_b64_tr_b16 v[168:169], v197 offset:352
    ds_read_b64_tr_b16 v[170:171], v197 offset:2528
    s_waitcnt lgkmcnt(10)
    v_mfma_f32_32x32x16_bf16 v[72:87], a[112:115], v[176:179], v[72:87]
    ds_read_b64_tr_b16 v[172:173], v197 offset:8704
    ds_read_b64_tr_b16 v[174:175], v197 offset:10880
    s_waitcnt lgkmcnt(10)
    v_mfma_f32_32x32x16_bf16 v[88:103], a[112:115], v[180:183], v[88:103]
    ds_read_b64_tr_b16 v[176:177], v197 offset:8736
    ds_read_b64_tr_b16 v[178:179], v197 offset:10912
    s_waitcnt lgkmcnt(10)
    v_mfma_f32_32x32x16_bf16 v[104:119], a[112:115], v[184:187], v[104:119]
    ds_read_b64_tr_b16 v[180:181], v197 offset:8768
    ds_read_b64_tr_b16 v[182:183], v197 offset:10944
    s_waitcnt lgkmcnt(10)
    v_mfma_f32_32x32x16_bf16 v[120:135], a[112:115], v[188:191], v[120:135]
    ds_read_b64_tr_b16 v[184:185], v197 offset:8800
    ds_read_b64_tr_b16 v[186:187], v197 offset:10976
    s_waitcnt lgkmcnt(10)
    v_mfma_f32_32x32x16_bf16 v[136:151], a[112:115], v[192:195], v[136:151]
    ds_read_b64_tr_b16 v[188:189], v197 offset:8960
    ds_read_b64_tr_b16 v[190:191], v197 offset:11136
    s_waitcnt lgkmcnt(10)
    v_mfma_f32_32x32x16_bf16 v[152:167], a[112:115], v[168:171], v[152:167]
    ds_read_b64_tr_b16 v[192:193], v197 offset:8992
    ds_read_b64_tr_b16 v[194:195], v197 offset:11168
    s_waitcnt lgkmcnt(10)
    v_mfma_f32_32x32x16_bf16 v[40:55], a[116:119], v[172:175], v[40:55]
    ds_read_b64_tr_b16 v[168:169], v197 offset:9024
    ds_read_b64_tr_b16 v[170:171], v197 offset:11200
    s_waitcnt lgkmcnt(10)
    v_mfma_f32_32x32x16_bf16 v[56:71], a[116:119], v[176:179], v[56:71]
    ds_read_b64_tr_b16 v[172:173], v197 offset:9056
    ds_read_b64_tr_b16 v[174:175], v197 offset:11232
    s_waitcnt lgkmcnt(10)
    v_mfma_f32_32x32x16_bf16 v[72:87], a[116:119], v[180:183], v[72:87]
    s_waitcnt vmcnt(0)
    s_barrier
    v_add_u32 v198, 121856, v196
    ds_read_b64_tr_b16 v[176:177], v198 offset:0
    ds_read_b64_tr_b16 v[178:179], v198 offset:2176
    s_waitcnt lgkmcnt(10)
    v_mfma_f32_32x32x16_bf16 v[88:103], a[116:119], v[184:187], v[88:103]
    ds_read_b64_tr_b16 v[180:181], v198 offset:32
    ds_read_b64_tr_b16 v[182:183], v198 offset:2208
    s_waitcnt lgkmcnt(10)
    v_mfma_f32_32x32x16_bf16 v[104:119], a[116:119], v[188:191], v[104:119]
    ds_read_b64_tr_b16 v[184:185], v198 offset:64
    ds_read_b64_tr_b16 v[186:187], v198 offset:2240
    s_waitcnt lgkmcnt(10)
    v_mfma_f32_32x32x16_bf16 v[120:135], a[116:119], v[192:195], v[120:135]
    ds_read_b64_tr_b16 v[188:189], v198 offset:96
    ds_read_b64_tr_b16 v[190:191], v198 offset:2272
    s_waitcnt lgkmcnt(10)
    v_mfma_f32_32x32x16_bf16 v[136:151], a[116:119], v[168:171], v[136:151]
    ds_read_b64_tr_b16 v[192:193], v198 offset:256
    ds_read_b64_tr_b16 v[194:195], v198 offset:2432
    s_waitcnt lgkmcnt(10)
    v_mfma_f32_32x32x16_bf16 v[152:167], a[116:119], v[172:175], v[152:167]
    ds_read_b64_tr_b16 v[168:169], v198 offset:288
    ds_read_b64_tr_b16 v[170:171], v198 offset:2464
    s_waitcnt lgkmcnt(10)
    v_mfma_f32_32x32x16_bf16 v[40:55], a[120:123], v[176:179], v[40:55]
    ds_read_b64_tr_b16 v[172:173], v198 offset:320
    ds_read_b64_tr_b16 v[174:175], v198 offset:2496
    s_waitcnt lgkmcnt(10)
    v_mfma_f32_32x32x16_bf16 v[56:71], a[120:123], v[180:183], v[56:71]
    ds_read_b64_tr_b16 v[176:177], v198 offset:352
    ds_read_b64_tr_b16 v[178:179], v198 offset:2528
    s_waitcnt lgkmcnt(10)
    v_mfma_f32_32x32x16_bf16 v[72:87], a[120:123], v[184:187], v[72:87]
    ds_read_b64_tr_b16 v[180:181], v198 offset:8704
    ds_read_b64_tr_b16 v[182:183], v198 offset:10880
    s_waitcnt lgkmcnt(10)
    v_mfma_f32_32x32x16_bf16 v[88:103], a[120:123], v[188:191], v[88:103]
    ds_read_b64_tr_b16 v[184:185], v198 offset:8736
    ds_read_b64_tr_b16 v[186:187], v198 offset:10912
    s_waitcnt lgkmcnt(10)
    v_mfma_f32_32x32x16_bf16 v[104:119], a[120:123], v[192:195], v[104:119]
    ds_read_b64_tr_b16 v[188:189], v198 offset:8768
    ds_read_b64_tr_b16 v[190:191], v198 offset:10944
    s_waitcnt lgkmcnt(10)
    v_mfma_f32_32x32x16_bf16 v[120:135], a[120:123], v[168:171], v[120:135]
    ds_read_b64_tr_b16 v[192:193], v198 offset:8800
    ds_read_b64_tr_b16 v[194:195], v198 offset:10976
    s_waitcnt lgkmcnt(10)
    v_mfma_f32_32x32x16_bf16 v[136:151], a[120:123], v[172:175], v[136:151]
    ds_read_b64_tr_b16 v[168:169], v198 offset:8960
    ds_read_b64_tr_b16 v[170:171], v198 offset:11136
    s_waitcnt lgkmcnt(10)
    v_mfma_f32_32x32x16_bf16 v[152:167], a[120:123], v[176:179], v[152:167]
    ds_read_b64_tr_b16 v[172:173], v198 offset:8992
    ds_read_b64_tr_b16 v[174:175], v198 offset:11168
    s_waitcnt lgkmcnt(10)
    v_mfma_f32_32x32x16_bf16 v[40:55], a[124:127], v[180:183], v[40:55]
    ds_read_b64_tr_b16 v[176:177], v198 offset:9024
    ds_read_b64_tr_b16 v[178:179], v198 offset:11200
    s_waitcnt lgkmcnt(10)
    v_mfma_f32_32x32x16_bf16 v[56:71], a[124:127], v[184:187], v[56:71]
    ds_read_b64_tr_b16 v[180:181], v198 offset:9056
    ds_read_b64_tr_b16 v[182:183], v198 offset:11232
    s_waitcnt lgkmcnt(10)
    v_mfma_f32_32x32x16_bf16 v[72:87], a[124:127], v[188:191], v[72:87]
    s_waitcnt lgkmcnt(8)
    v_mfma_f32_32x32x16_bf16 v[88:103], a[124:127], v[192:195], v[88:103]
    s_waitcnt lgkmcnt(6)
    v_mfma_f32_32x32x16_bf16 v[104:119], a[124:127], v[168:171], v[104:119]
    s_waitcnt lgkmcnt(4)
    v_mfma_f32_32x32x16_bf16 v[120:135], a[124:127], v[172:175], v[120:135]
    s_waitcnt lgkmcnt(2)
    v_mfma_f32_32x32x16_bf16 v[136:151], a[124:127], v[176:179], v[136:151]
    s_waitcnt lgkmcnt(0)
    v_mfma_f32_32x32x16_bf16 v[152:167], a[124:127], v[180:183], v[152:167]
    s_add_u32 s32, s10, 6291456
    s_addc_u32 s33, s11, 0
    s_mov_b32 s34, 2097152
    s_mov_b32 s35, 0x00020000
    v_and_b32 v212, 15, v1
    v_lshlrev_b32 v212, 6, v212
    v_lshl_add_u32 v212, v4, 5, v212
    v_lshl_add_u32 v212, v6, 18, v212
    s_and_b32 s39, s12, 1
    s_lshl_b32 s45, s39, 20
    s_lshl_b32 s46, s13, 2
    s_add_u32 s46, s46, s14
    s_lshl_b32 s46, s46, 10
    s_add_u32 s45, s45, s46
    v_cvt_pk_bf16_f32 v204, v40, v41
    v_cvt_pk_bf16_f32 v205, v42, v43
    v_cvt_pk_bf16_f32 v206, v44, v45
    v_cvt_pk_bf16_f32 v207, v46, v47
    v_cvt_pk_bf16_f32 v208, v48, v49
    v_cvt_pk_bf16_f32 v209, v50, v51
    v_cvt_pk_bf16_f32 v210, v52, v53
    v_cvt_pk_bf16_f32 v211, v54, v55
    s_add_u32 s46, s45, 0
    buffer_store_dwordx4 v[204:207], v212, s[32:35], s46 offen
    buffer_store_dwordx4 v[208:211], v212, s[32:35], s46 offen offset:16
    s_nop 0
    v_cvt_pk_bf16_f32 v204, v56, v57
    v_cvt_pk_bf16_f32 v205, v58, v59
    v_cvt_pk_bf16_f32 v206, v60, v61
    v_cvt_pk_bf16_f32 v207, v62, v63
    v_cvt_pk_bf16_f32 v208, v64, v65
    v_cvt_pk_bf16_f32 v209, v66, v67
    v_cvt_pk_bf16_f32 v210, v68, v69
    v_cvt_pk_bf16_f32 v211, v70, v71
    s_add_u32 s46, s45, 65536
    buffer_store_dwordx4 v[204:207], v212, s[32:35], s46 offen
    buffer_store_dwordx4 v[208:211], v212, s[32:35], s46 offen offset:16
    s_nop 0
    v_cvt_pk_bf16_f32 v204, v72, v73
    v_cvt_pk_bf16_f32 v205, v74, v75
    v_cvt_pk_bf16_f32 v206, v76, v77
    v_cvt_pk_bf16_f32 v207, v78, v79
    v_cvt_pk_bf16_f32 v208, v80, v81
    v_cvt_pk_bf16_f32 v209, v82, v83
    v_cvt_pk_bf16_f32 v210, v84, v85
    v_cvt_pk_bf16_f32 v211, v86, v87
    s_add_u32 s46, s45, 131072
    buffer_store_dwordx4 v[204:207], v212, s[32:35], s46 offen
    buffer_store_dwordx4 v[208:211], v212, s[32:35], s46 offen offset:16
    s_nop 0
    v_cvt_pk_bf16_f32 v204, v88, v89
    v_cvt_pk_bf16_f32 v205, v90, v91
    v_cvt_pk_bf16_f32 v206, v92, v93
    v_cvt_pk_bf16_f32 v207, v94, v95
    v_cvt_pk_bf16_f32 v208, v96, v97
    v_cvt_pk_bf16_f32 v209, v98, v99
    v_cvt_pk_bf16_f32 v210, v100, v101
    v_cvt_pk_bf16_f32 v211, v102, v103
    s_add_u32 s46, s45, 196608
    buffer_store_dwordx4 v[204:207], v212, s[32:35], s46 offen
    buffer_store_dwordx4 v[208:211], v212, s[32:35], s46 offen offset:16
    s_nop 0
    v_cvt_pk_bf16_f32 v204, v104, v105
    v_cvt_pk_bf16_f32 v205, v106, v107
    v_cvt_pk_bf16_f32 v206, v108, v109
    v_cvt_pk_bf16_f32 v207, v110, v111
    v_cvt_pk_bf16_f32 v208, v112, v113
    v_cvt_pk_bf16_f32 v209, v114, v115
    v_cvt_pk_bf16_f32 v210, v116, v117
    v_cvt_pk_bf16_f32 v211, v118, v119
    s_add_u32 s46, s45, 524288
    buffer_store_dwordx4 v[204:207], v212, s[32:35], s46 offen
    buffer_store_dwordx4 v[208:211], v212, s[32:35], s46 offen offset:16
    s_nop 0
    v_cvt_pk_bf16_f32 v204, v120, v121
    v_cvt_pk_bf16_f32 v205, v122, v123
    v_cvt_pk_bf16_f32 v206, v124, v125
    v_cvt_pk_bf16_f32 v207, v126, v127
    v_cvt_pk_bf16_f32 v208, v128, v129
    v_cvt_pk_bf16_f32 v209, v130, v131
    v_cvt_pk_bf16_f32 v210, v132, v133
    v_cvt_pk_bf16_f32 v211, v134, v135
    s_add_u32 s46, s45, 589824
    buffer_store_dwordx4 v[204:207], v212, s[32:35], s46 offen
    buffer_store_dwordx4 v[208:211], v212, s[32:35], s46 offen offset:16
    s_nop 0
    v_cvt_pk_bf16_f32 v204, v136, v137
    v_cvt_pk_bf16_f32 v205, v138, v139
    v_cvt_pk_bf16_f32 v206, v140, v141
    v_cvt_pk_bf16_f32 v207, v142, v143
    v_cvt_pk_bf16_f32 v208, v144, v145
    v_cvt_pk_bf16_f32 v209, v146, v147
    v_cvt_pk_bf16_f32 v210, v148, v149
    v_cvt_pk_bf16_f32 v211, v150, v151
    s_add_u32 s46, s45, 655360
    buffer_store_dwordx4 v[204:207], v212, s[32:35], s46 offen
    buffer_store_dwordx4 v[208:211], v212, s[32:35], s46 offen offset:16
    s_nop 0
    v_cvt_pk_bf16_f32 v204, v152, v153
    v_cvt_pk_bf16_f32 v205, v154, v155
    v_cvt_pk_bf16_f32 v206, v156, v157
    v_cvt_pk_bf16_f32 v207, v158, v159
    v_cvt_pk_bf16_f32 v208, v160, v161
    v_cvt_pk_bf16_f32 v209, v162, v163
    v_cvt_pk_bf16_f32 v210, v164, v165
    v_cvt_pk_bf16_f32 v211, v166, v167
    s_add_u32 s46, s45, 720896
    buffer_store_dwordx4 v[204:207], v212, s[32:35], s46 offen
    buffer_store_dwordx4 v[208:211], v212, s[32:35], s46 offen offset:16
    s_nop 1
    s_branch L_k1_end
L_k1_f:
    s_sub_u32 s39, s12, 6
    s_mul_i32 s40, s39, 9
    s_lshl_b32 s41, s39, 3
    s_add_u32 s41, s41, 6
    s_cmp_lt_u32 s39, 6
    s_cselect_b32 s40, s40, s41
    s_cselect_b32 s41, 9, 8
    s_lshl_b32 s42, s40, 5
    s_mov_b32 s20, s6
    s_mov_b32 s21, s7
    s_mov_b32 s22, 1409024
    s_mov_b32 s23, 0x00020000
    s_mov_b32 s24, s8
    s_mov_b32 s25, s9
    s_mov_b32 s26, 1409024
    s_mov_b32 s27, 0x00020000
    s_cmp_eq_u32 s14, 0
    s_cselect_b32 s28, s20, s24
    s_cselect_b32 s29, s21, s25
    s_mov_b32 s30, s22
    s_mov_b32 s31, 0x00020000
    s_mov_b32 s47, 17536
    s_cselect_b32 s43, 8192, s47
    v_lshl_add_u32 v220, s14, 6, v1
    v_mul_u32_u24 v221, 3641, v220
    v_lshrrev_b32 v221, 16, v221
    v_mul_u32_u24 v222, 18, v221
    v_sub_u32 v222, v220, v222
    v_mul_u32_u24 v221, 2752, v221
    v_lshl_add_u32 v221, v222, 4, v221
    v_add_u32 v215, s42, v221
    v_lshl_add_u32 v220, s14, 6, v1
    v_add_u32 v220, 256, v220
    v_mul_u32_u24 v221, 3641, v220
    v_lshrrev_b32 v221, 16, v221
    v_mul_u32_u24 v222, 18, v221
    v_sub_u32 v222, v220, v222
    v_mul_u32_u24 v221, 2752, v221
    v_lshl_add_u32 v221, v222, 4, v221
    v_add_u32 v216, s42, v221
    v_add_u32 v220, 512, v1
    v_mul_u32_u24 v221, 3641, v220
    v_lshrrev_b32 v221, 16, v221
    v_mul_u32_u24 v222, 18, v221
    v_sub_u32 v222, v220, v222
    v_mul_u32_u24 v221, 2752, v221
    v_lshl_add_u32 v221, v222, 4, v221
    v_add_u32 v217, s42, v221
    v_mul_u32_u24 v212, 288, v10
    v_lshl_add_u32 v212, v9, 3, v212
    v_mul_u32_u24 v220, 9344, v6
    v_add_u32 v212, v212, v220
    s_mov_b32 s37, 0
    buffer_load_dwordx4 a[0:3], v5, s[16:19], s37 offen
    s_mov_b32 s37, 65536
    buffer_load_dwordx4 a[4:7], v5, s[16:19], s37 offen
    s_mov_b32 s44, 0
    s_cmp_ge_u32 s14, 2
    s_cbranch_scc1 L_k1_f_dskip0
    s_add_u32 m0, s43, 0
    s_nop 1
    buffer_load_dwordx4 v217, s[28:31], s44 offen lds
L_k1_f_dskip0:
    s_nop 0
    s_add_u32 m0, s38, 0
    s_nop 0
    buffer_load_dwordx4 v215, s[20:23], s44 offen lds
    s_add_u32 m0, s38, 4096
    s_nop 0
    buffer_load_dwordx4 v216, s[20:23], s44 offen lds
    s_add_u32 m0, s38, 9344
    s_nop 0
    buffer_load_dwordx4 v215, s[24:27], s44 offen lds
    s_add_u32 m0, s38, 13440
    s_nop 0
    buffer_load_dwordx4 v216, s[24:27], s44 offen lds
    s_mov_b32 s37, 131072
    buffer_load_dwordx4 a[8:11], v5, s[16:19], s37 offen
    s_mov_b32 s37, 196608
    buffer_load_dwordx4 a[12:15], v5, s[16:19], s37 offen
    s_mov_b32 s44, 88064
    s_cmp_ge_u32 s14, 2
    s_cbranch_scc1 L_k1_f_dskip1
    s_add_u32 m0, s43, 18560
    s_nop 1
    buffer_load_dwordx4 v217, s[28:31], s44 offen lds
L_k1_f_dskip1:
    s_nop 0
    s_add_u32 m0, s38, 18560
    s_nop 0
    buffer_load_dwordx4 v215, s[20:23], s44 offen lds
    s_add_u32 m0, s38, 22656
    s_nop 0
    buffer_load_dwordx4 v216, s[20:23], s44 offen lds
    s_add_u32 m0, s38, 27904
    s_nop 0
    buffer_load_dwordx4 v215, s[24:27], s44 offen lds
    s_add_u32 m0, s38, 32000
    s_nop 0
    buffer_load_dwordx4 v216, s[24:27], s44 offen lds
    s_waitcnt vmcnt(6)
    s_barrier
    s_mov_b32 s37, 262144
    buffer_load_dwordx4 a[16:19], v5, s[16:19], s37 offen
    s_mov_b32 s37, 327680
    buffer_load_dwordx4 a[20:23], v5, s[16:19], s37 offen
    s_mov_b32 s44, 176128
    s_cmp_ge_u32 s14, 2
    s_cbranch_scc1 L_k1_f_dskip2
    s_add_u32 m0, s43, 37120
    s_nop 1
    buffer_load_dwordx4 v217, s[28:31], s44 offen lds
L_k1_f_dskip2:
    s_nop 0
    s_add_u32 m0, s38, 37120
    s_nop 0
    buffer_load_dwordx4 v215, s[20:23], s44 offen lds
    s_add_u32 m0, s38, 41216
    s_nop 0
    buffer_load_dwordx4 v216, s[20:23], s44 offen lds
    s_add_u32 m0, s38, 46464
    s_nop 0
    buffer_load_dwordx4 v215, s[24:27], s44 offen lds
    s_add_u32 m0, s38, 50560
    s_nop 0
    buffer_load_dwordx4 v216, s[24:27], s44 offen lds
    s_mov_b32 s37, 393216
    buffer_load_dwordx4 a[24:27], v5, s[16:19], s37 offen
    s_mov_b32 s37, 458752
    buffer_load_dwordx4 a[28:31], v5, s[16:19], s37 offen
    s_mov_b32 s44, 264192
    s_cmp_ge_u32 s14, 2
    s_cbranch_scc1 L_k1_f_dskip3
    s_add_u32 m0, s43, 55680
    s_nop 1
    buffer_load_dwordx4 v217, s[28:31], s44 offen lds
L_k1_f_dskip3:
    s_nop 0
    s_add_u32 m0, s38, 55680
    s_nop 0
    buffer_load_dwordx4 v215, s[20:23], s44 offen lds
    s_add_u32 m0, s38, 59776
    s_nop 0
    buffer_load_dwordx4 v216, s[20:23], s44 offen lds
    s_add_u32 m0, s38, 65024
    s_nop 0
    buffer_load_dwordx4 v215, s[24:27], s44 offen lds
    s_add_u32 m0, s38, 69120
    s_nop 0
    buffer_load_dwordx4 v216, s[24:27], s44 offen lds
    v_add_u32 v213, 0, v212
    ds_read_b64_tr_b16 v[184:185], v213 offset:0
    ds_read_b64_tr_b16 v[186:187], v213 offset:1152
    ds_read_b64_tr_b16 v[188:189], v213 offset:32
    ds_read_b64_tr_b16 v[190:191], v213 offset:1184
    ds_read_b64_tr_b16 v[192:193], v213 offset:64
    ds_read_b64_tr_b16 v[194:195], v213 offset:1216
    ds_read_b64_tr_b16 v[196:197], v213 offset:96
    ds_read_b64_tr_b16 v[198:199], v213 offset:1248
    ds_read_b64_tr_b16 v[200:201], v213 offset:128
    ds_read_b64_tr_b16 v[202:203], v213 offset:1280
    ds_read_b64_tr_b16 v[204:205], v213 offset:160
    ds_read_b64_tr_b16 v[206:207], v213 offset:1312
    s_waitcnt lgkmcnt(10)
    v_mfma_f32_32x32x16_bf16 v[40:55], v[184:187], a[0:3], 0
    ds_read_b64_tr_b16 v[208:209], v213 offset:192
    ds_read_b64_tr_b16 v[210:211], v213 offset:1344
    s_waitcnt lgkmcnt(10)
    v_mfma_f32_32x32x16_bf16 v[56:71], v[188:191], a[0:3], 0
    ds_read_b64_tr_b16 v[184:185], v213 offset:224
    ds_read_b64_tr_b16 v[186:187], v213 offset:1376
    s_waitcnt lgkmcnt(10)
    v_mfma_f32_32x32x16_bf16 v[72:87], v[192:195], a[0:3], 0
    ds_read_b64_tr_b16 v[188:189], v213 offset:256
    ds_read_b64_tr_b16 v[190:191], v213 offset:1408
    s_waitcnt lgkmcnt(10)
    v_mfma_f32_32x32x16_bf16 v[88:103], v[196:199], a[0:3], 0
    ds_read_b64_tr_b16 v[192:193], v213 offset:4608
    ds_read_b64_tr_b16 v[194:195], v213 offset:5760
    s_waitcnt lgkmcnt(10)
    v_mfma_f32_32x32x16_bf16 v[104:119], v[200:203], a[0:3], 0
    ds_read_b64_tr_b16 v[196:197], v213 offset:4640
    ds_read_b64_tr_b16 v[198:199], v213 offset:5792
    s_waitcnt lgkmcnt(10)
    v_mfma_f32_32x32x16_bf16 v[120:135], v[204:207], a[0:3], 0
    ds_read_b64_tr_b16 v[200:201], v213 offset:4672
    ds_read_b64_tr_b16 v[202:203], v213 offset:5824
    s_waitcnt lgkmcnt(10)
    v_mfma_f32_32x32x16_bf16 v[136:151], v[208:211], a[0:3], 0
    ds_read_b64_tr_b16 v[204:205], v213 offset:4704
    ds_read_b64_tr_b16 v[206:207], v213 offset:5856
    s_waitcnt lgkmcnt(10)
    v_mfma_f32_32x32x16_bf16 v[152:167], v[184:187], a[0:3], 0
    ds_read_b64_tr_b16 v[208:209], v213 offset:4736
    ds_read_b64_tr_b16 v[210:211], v213 offset:5888
    s_waitcnt lgkmcnt(10)
    v_mfma_f32_32x32x16_bf16 v[168:183], v[188:191], a[0:3], 0
    ds_read_b64_tr_b16 v[184:185], v213 offset:4768
    ds_read_b64_tr_b16 v[186:187], v213 offset:5920
    s_waitcnt lgkmcnt(10)
    v_mfma_f32_32x32x16_bf16 v[40:55], v[192:195], a[4:7], v[40:55]
    ds_read_b64_tr_b16 v[188:189], v213 offset:4800
    ds_read_b64_tr_b16 v[190:191], v213 offset:5952
    s_waitcnt lgkmcnt(10)
    v_mfma_f32_32x32x16_bf16 v[56:71], v[196:199], a[4:7], v[56:71]
    ds_read_b64_tr_b16 v[192:193], v213 offset:4832
    ds_read_b64_tr_b16 v[194:195], v213 offset:5984
    s_waitcnt lgkmcnt(10)
    v_mfma_f32_32x32x16_bf16 v[72:87], v[200:203], a[4:7], v[72:87]
    ds_read_b64_tr_b16 v[196:197], v213 offset:4864
    ds_read_b64_tr_b16 v[198:199], v213 offset:6016
    s_waitcnt lgkmcnt(10)
    v_mfma_f32_32x32x16_bf16 v[88:103], v[204:207], a[4:7], v[88:103]
    s_waitcnt vmcnt(12)
    s_barrier
    s_mov_b32 s37, 524288
    buffer_load_dwordx4 a[32:35], v5, s[16:19], s37 offen
    s_mov_b32 s37, 589824
    buffer_load_dwordx4 a[36:39], v5, s[16:19], s37 offen
    s_mov_b32 s44, 352256
    s_cmp_ge_u32 s14, 2
    s_cbranch_scc1 L_k1_f_dskip4
    s_add_u32 m0, s43, 74240
    s_nop 1
    buffer_load_dwordx4 v217, s[28:31], s44 offen lds
L_k1_f_dskip4:
    s_nop 0
    s_add_u32 m0, s38, 74240
    s_nop 0
    buffer_load_dwordx4 v215, s[20:23], s44 offen lds
    s_add_u32 m0, s38, 78336
    s_nop 0
    buffer_load_dwordx4 v216, s[20:23], s44 offen lds
    s_add_u32 m0, s38, 83584
    s_nop 0
    buffer_load_dwordx4 v215, s[24:27], s44 offen lds
    s_add_u32 m0, s38, 87680
    s_nop 0
    buffer_load_dwordx4 v216, s[24:27], s44 offen lds
    s_mov_b32 s37, 655360
    buffer_load_dwordx4 a[40:43], v5, s[16:19], s37 offen
    s_mov_b32 s37, 720896
    buffer_load_dwordx4 a[44:47], v5, s[16:19], s37 offen
    s_mov_b32 s44, 440320
    s_cmp_ge_u32 s14, 2
    s_cbranch_scc1 L_k1_f_dskip5
    s_add_u32 m0, s43, 92800
    s_nop 1
    buffer_load_dwordx4 v217, s[28:31], s44 offen lds
L_k1_f_dskip5:
    s_nop 0
    s_add_u32 m0, s38, 92800
    s_nop 0
    buffer_load_dwordx4 v215, s[20:23], s44 offen lds
    s_add_u32 m0, s38, 96896
    s_nop 0
    buffer_load_dwordx4 v216, s[20:23], s44 offen lds
    s_add_u32 m0, s38, 102144
    s_nop 0
    buffer_load_dwordx4 v215, s[24:27], s44 offen lds
    s_add_u32 m0, s38, 106240
    s_nop 0
    buffer_load_dwordx4 v216, s[24:27], s44 offen lds
    v_add_u32 v214, 18560, v212
    ds_read_b64_tr_b16 v[200:201], v214 offset:0
    ds_read_b64_tr_b16 v[202:203], v214 offset:1152
    s_waitcnt lgkmcnt(10)
    v_mfma_f32_32x32x16_bf16 v[104:119], v[208:211], a[4:7], v[104:119]
    ds_read_b64_tr_b16 v[204:205], v214 offset:32
    ds_read_b64_tr_b16 v[206:207], v214 offset:1184
    s_waitcnt lgkmcnt(10)
    v_mfma_f32_32x32x16_bf16 v[120:135], v[184:187], a[4:7], v[120:135]
    ds_read_b64_tr_b16 v[208:209], v214 offset:64
    ds_read_b64_tr_b16 v[210:211], v214 offset:1216
    s_waitcnt lgkmcnt(10)
    v_mfma_f32_32x32x16_bf16 v[136:151], v[188:191], a[4:7], v[136:151]
    ds_read_b64_tr_b16 v[184:185], v214 offset:96
    ds_read_b64_tr_b16 v[186:187], v214 offset:1248
    s_waitcnt lgkmcnt(10)
    v_mfma_f32_32x32x16_bf16 v[152:167], v[192:195], a[4:7], v[152:167]
    ds_read_b64_tr_b16 v[188:189], v214 offset:128
    ds_read_b64_tr_b16 v[190:191], v214 offset:1280
    s_waitcnt lgkmcnt(10)
    v_mfma_f32_32x32x16_bf16 v[168:183], v[196:199], a[4:7], v[168:183]
    ds_read_b64_tr_b16 v[192:193], v214 offset:160
    ds_read_b64_tr_b16 v[194:195], v214 offset:1312
    s_waitcnt lgkmcnt(10)
    v_mfma_f32_32x32x16_bf16 v[40:55], v[200:203], a[8:11], v[40:55]
    ds_read_b64_tr_b16 v[196:197], v214 offset:192
    ds_read_b64_tr_b16 v[198:199], v214 offset:1344
    s_waitcnt lgkmcnt(10)
    v_mfma_f32_32x32x16_bf16 v[56:71], v[204:207], a[8:11], v[56:71]
    ds_read_b64_tr_b16 v[200:201], v214 offset:224
    ds_read_b64_tr_b16 v[202:203], v214 offset:1376
    s_waitcnt lgkmcnt(10)
    v_mfma_f32_32x32x16_bf16 v[72:87], v[208:211], a[8:11], v[72:87]
    ds_read_b64_tr_b16 v[204:205], v214 offset:256
    ds_read_b64_tr_b16 v[206:207], v214 offset:1408
    s_waitcnt lgkmcnt(10)
    v_mfma_f32_32x32x16_bf16 v[88:103], v[184:187], a[8:11], v[88:103]
    ds_read_b64_tr_b16 v[208:209], v214 offset:4608
    ds_read_b64_tr_b16 v[210:211], v214 offset:5760
    s_waitcnt lgkmcnt(10)
    v_mfma_f32_32x32x16_bf16 v[104:119], v[188:191], a[8:11], v[104:119]
    ds_read_b64_tr_b16 v[184:185], v214 offset:4640
    ds_read_b64_tr_b16 v[186:187], v214 offset:5792
    s_waitcnt lgkmcnt(10)
    v_mfma_f32_32x32x16_bf16 v[120:135], v[192:195], a[8:11], v[120:135]
    ds_read_b64_tr_b16 v[188:189], v214 offset:4672
    ds_read_b64_tr_b16 v[190:191], v214 offset:5824
    s_waitcnt lgkmcnt(10)
    v_mfma_f32_32x32x16_bf16 v[136:151], v[196:199], a[8:11], v[136:151]
    ds_read_b64_tr_b16 v[192:193], v214 offset:4704
    ds_read_b64_tr_b16 v[194:195], v214 offset:5856
    s_waitcnt lgkmcnt(10)
    v_mfma_f32_32x32x16_bf16 v[152:167], v[200:203], a[8:11], v[152:167]
    ds_read_b64_tr_b16 v[196:197], v214 offset:4736
    ds_read_b64_tr_b16 v[198:199], v214 offset:5888
    s_waitcnt lgkmcnt(10)
    v_mfma_f32_32x32x16_bf16 v[168:183], v[204:207], a[8:11], v[168:183]
    ds_read_b64_tr_b16 v[200:201], v214 offset:4768
    ds_read_b64_tr_b16 v[202:203], v214 offset:5920
    s_waitcnt lgkmcnt(10)
    v_mfma_f32_32x32x16_bf16 v[40:55], v[208:211], a[12:15], v[40:55]
    ds_read_b64_tr_b16 v[204:205], v214 offset:4800
    ds_read_b64_tr_b16 v[206:207], v214 offset:5952
    s_waitcnt lgkmcnt(10)
    v_mfma_f32_32x32x16_bf16 v[56:71], v[184:187], a[12:15], v[56:71]
    ds_read_b64_tr_b16 v[208:209], v214 offset:4832
    ds_read_b64_tr_b16 v[210:211], v214 offset:5984
    s_waitcnt lgkmcnt(10)
    v_mfma_f32_32x32x16_bf16 v[72:87], v[188:191], a[12:15], v[72:87]
    ds_read_b64_tr_b16 v[184:185], v214 offset:4864
    ds_read_b64_tr_b16 v[186:187], v214 offset:6016
    s_waitcnt lgkmcnt(10)
    v_mfma_f32_32x32x16_bf16 v[88:103], v[192:195], a[12:15], v[88:103]
    s_waitcnt vmcnt(18)
    s_barrier
    s_mov_b32 s37, 786432
    buffer_load_dwordx4 a[48:51], v5, s[16:19], s37 offen
    s_mov_b32 s37, 851968
    buffer_load_dwordx4 a[52:55], v5, s[16:19], s37 offen
    s_mov_b32 s44, 528384
    s_cmp_ge_u32 s14, 2
    s_cbranch_scc1 L_k1_f_dskip6
    s_add_u32 m0, s43, 111360
    s_nop 1
    buffer_load_dwordx4 v217, s[28:31], s44 offen lds
L_k1_f_dskip6:
    s_nop 0
    s_add_u32 m0, s38, 111360
    s_nop 0
    buffer_load_dwordx4 v215, s[20:23], s44 offen lds
    s_add_u32 m0, s38, 115456
    s_nop 0
    buffer_load_dwordx4 v216, s[20:23], s44 offen lds
    s_add_u32 m0, s38, 120704
    s_nop 0
    buffer_load_dwordx4 v215, s[24:27], s44 offen lds
    s_add_u32 m0, s38, 124800
    s_nop 0
    buffer_load_dwordx4 v216, s[24:27], s44 offen lds
    s_mov_b32 s37, 917504
    buffer_load_dwordx4 a[56:59], v5, s[16:19], s37 offen
    s_mov_b32 s37, 983040
    buffer_load_dwordx4 a[60:63], v5, s[16:19], s37 offen
    s_mov_b32 s44, 616448
    s_cmp_ge_u32 s14, 2
    s_cbranch_scc1 L_k1_f_dskip7
    s_add_u32 m0, s43, 129920
    s_nop 1
    buffer_load_dwordx4 v217, s[28:31], s44 offen lds
L_k1_f_dskip7:
    s_nop 0
    s_add_u32 m0, s38, 129920
    s_nop 0
    buffer_load_dwordx4 v215, s[20:23], s44 offen lds
    s_add_u32 m0, s38, 134016
    s_nop 0
    buffer_load_dwordx4 v216, s[20:23], s44 offen lds
    s_add_u32 m0, s38, 139264
    s_nop 0
    buffer_load_dwordx4 v215, s[24:27], s44 offen lds
    s_add_u32 m0, s38, 143360
    s_nop 0
    buffer_load_dwordx4 v216, s[24:27], s44 offen lds
    v_add_u32 v213, 37120, v212
    ds_read_b64_tr_b16 v[188:189], v213 offset:0
    ds_read_b64_tr_b16 v[190:191], v213 offset:1152
    s_waitcnt lgkmcnt(10)
    v_mfma_f32_32x32x16_bf16 v[104:119], v[196:199], a[12:15], v[104:119]
    ds_read_b64_tr_b16 v[192:193], v213 offset:32
    ds_read_b64_tr_b16 v[194:195], v213 offset:1184
    s_waitcnt lgkmcnt(10)
    v_mfma_f32_32x32x16_bf16 v[120:135], v[200:203], a[12:15], v[120:135]
    ds_read_b64_tr_b16 v[196:197], v213 offset:64
    ds_read_b64_tr_b16 v[198:199], v213 offset:1216
    s_waitcnt lgkmcnt(10)
    v_mfma_f32_32x32x16_bf16 v[136:151], v[204:207], a[12:15], v[136:151]
    ds_read_b64_tr_b16 v[200:201], v213 offset:96
    ds_read_b64_tr_b16 v[202:203], v213 offset:1248
    s_waitcnt lgkmcnt(10)
    v_mfma_f32_32x32x16_bf16 v[152:167], v[208:211], a[12:15], v[152:167]
    ds_read_b64_tr_b16 v[204:205], v213 offset:128
    ds_read_b64_tr_b16 v[206:207], v213 offset:1280
    s_waitcnt lgkmcnt(10)
    v_mfma_f32_32x32x16_bf16 v[168:183], v[184:187], a[12:15], v[168:183]
    ds_read_b64_tr_b16 v[208:209], v213 offset:160
    ds_read_b64_tr_b16 v[210:211], v213 offset:1312
    s_waitcnt lgkmcnt(10)
    v_mfma_f32_32x32x16_bf16 v[40:55], v[188:191], a[16:19], v[40:55]
    ds_read_b64_tr_b16 v[184:185], v213 offset:192
    ds_read_b64_tr_b16 v[186:187], v213 offset:1344
    s_waitcnt lgkmcnt(10)
    v_mfma_f32_32x32x16_bf16 v[56:71], v[192:195], a[16:19], v[56:71]
    ds_read_b64_tr_b16 v[188:189], v213 offset:224
    ds_read_b64_tr_b16 v[190:191], v213 offset:1376
    s_waitcnt lgkmcnt(10)
    v_mfma_f32_32x32x16_bf16 v[72:87], v[196:199], a[16:19], v[72:87]
    ds_read_b64_tr_b16 v[192:193], v213 offset:256
    ds_read_b64_tr_b16 v[194:195], v213 offset:1408
    s_waitcnt lgkmcnt(10)
    v_mfma_f32_32x32x16_bf16 v[88:103], v[200:203], a[16:19], v[88:103]
    ds_read_b64_tr_b16 v[196:197], v213 offset:4608
    ds_read_b64_tr_b16 v[198:199], v213 offset:5760
    s_waitcnt lgkmcnt(10)
    v_mfma_f32_32x32x16_bf16 v[104:119], v[204:207], a[16:19], v[104:119]
    ds_read_b64_tr_b16 v[200:201], v213 offset:4640
    ds_read_b64_tr_b16 v[202:203], v213 offset:5792
    s_waitcnt lgkmcnt(10)
    v_mfma_f32_32x32x16_bf16 v[120:135], v[208:211], a[16:19], v[120:135]
    ds_read_b64_tr_b16 v[204:205], v213 offset:4672
    ds_read_b64_tr_b16 v[206:207], v213 offset:5824
    s_waitcnt lgkmcnt(10)
    v_mfma_f32_32x32x16_bf16 v[136:151], v[184:187], a[16:19], v[136:151]
    ds_read_b64_tr_b16 v[208:209], v213 offset:4704
    ds_read_b64_tr_b16 v[210:211], v213 offset:5856
    s_waitcnt lgkmcnt(10)
    v_mfma_f32_32x32x16_bf16 v[152:167], v[188:191], a[16:19], v[152:167]
    ds_read_b64_tr_b16 v[184:185], v213 offset:4736
    ds_read_b64_tr_b16 v[186:187], v213 offset:5888
    s_waitcnt lgkmcnt(10)
    v_mfma_f32_32x32x16_bf16 v[168:183], v[192:195], a[16:19], v[168:183]
    ds_read_b64_tr_b16 v[188:189], v213 offset:4768
    ds_read_b64_tr_b16 v[190:191], v213 offset:5920
    s_waitcnt lgkmcnt(10)
    v_mfma_f32_32x32x16_bf16 v[40:55], v[196:199], a[20:23], v[40:55]
    ds_read_b64_tr_b16 v[192:193], v213 offset:4800
    ds_read_b64_tr_b16 v[194:195], v213 offset:5952
    s_waitcnt lgkmcnt(10)
    v_mfma_f32_32x32x16_bf16 v[56:71], v[200:203], a[20:23], v[56:71]
    ds_read_b64_tr_b16 v[196:197], v213 offset:4832
    ds_read_b64_tr_b16 v[198:199], v213 offset:5984
    s_waitcnt lgkmcnt(10)
    v_mfma_f32_32x32x16_bf16 v[72:87], v[204:207], a[20:23], v[72:87]
    ds_read_b64_tr_b16 v[200:201], v213 offset:4864
    ds_read_b64_tr_b16 v[202:203], v213 offset:6016
    s_waitcnt lgkmcnt(10)
    v_mfma_f32_32x32x16_bf16 v[88:103], v[208:211], a[20:23], v[88:103]
    s_waitcnt vmcnt(24)
    s_barrier
    s_mov_b32 s37, 1048576
    buffer_load_dwordx4 a[64:67], v5, s[16:19], s37 offen
    s_mov_b32 s37, 1114112
    buffer_load_dwordx4 a[68:71], v5, s[16:19], s37 offen
    s_mov_b32 s44, 704512
    s_cmp_ge_u32 s14, 2
    s_cbranch_scc1 L_k1_f_dskip8
    s_add_u32 m0, s43, 0
    s_nop 1
    buffer_load_dwordx4 v217, s[28:31], s44 offen lds
L_k1_f_dskip8:
    s_nop 0
    s_add_u32 m0, s38, 0
    s_nop 0
    buffer_load_dwordx4 v215, s[20:23], s44 offen lds
    s_add_u32 m0, s38, 4096
    s_nop 0
    buffer_load_dwordx4 v216, s[20:23], s44 offen lds
    s_add_u32 m0, s38, 9344
    s_nop 0
    buffer_load_dwordx4 v215, s[24:27], s44 offen lds
    s_add_u32 m0, s38, 13440
    s_nop 0
    buffer_load_dwordx4 v216, s[24:27], s44 offen lds
    v_add_u32 v214, 55680, v212
    ds_read_b64_tr_b16 v[204:205], v214 offset:0
    ds_read_b64_tr_b16 v[206:207], v214 offset:1152
    s_waitcnt lgkmcnt(10)
    v_mfma_f32_32x32x16_bf16 v[104:119], v[184:187], a[20:23], v[104:119]
    ds_read_b64_tr_b16 v[208:209], v214 offset:32
    ds_read_b64_tr_b16 v[210:211], v214 offset:1184
    s_waitcnt lgkmcnt(10)
    v_mfma_f32_32x32x16_bf16 v[120:135], v[188:191], a[20:23], v[120:135]
    ds_read_b64_tr_b16 v[184:185], v214 offset:64
    ds_read_b64_tr_b16 v[186:187], v214 offset:1216
    s_waitcnt lgkmcnt(10)
    v_mfma_f32_32x32x16_bf16 v[136:151], v[192:195], a[20:23], v[136:151]
    ds_read_b64_tr_b16 v[188:189], v214 offset:96
    ds_read_b64_tr_b16 v[190:191], v214 offset:1248
    s_waitcnt lgkmcnt(10)
    v_mfma_f32_32x32x16_bf16 v[152:167], v[196:199], a[20:23], v[152:167]
    ds_read_b64_tr_b16 v[192:193], v214 offset:128
    ds_read_b64_tr_b16 v[194:195], v214 offset:1280
    s_waitcnt lgkmcnt(10)
    v_mfma_f32_32x32x16_bf16 v[168:183], v[200:203], a[20:23], v[168:183]
    ds_read_b64_tr_b16 v[196:197], v214 offset:160
    ds_read_b64_tr_b16 v[198:199], v214 offset:1312
    s_waitcnt lgkmcnt(10)
    v_mfma_f32_32x32x16_bf16 v[40:55], v[204:207], a[24:27], v[40:55]
    ds_read_b64_tr_b16 v[200:201], v214 offset:192
    ds_read_b64_tr_b16 v[202:203], v214 offset:1344
    s_waitcnt lgkmcnt(10)
    v_mfma_f32_32x32x16_bf16 v[56:71], v[208:211], a[24:27], v[56:71]
    ds_read_b64_tr_b16 v[204:205], v214 offset:224
    ds_read_b64_tr_b16 v[206:207], v214 offset:1376
    s_waitcnt lgkmcnt(10)
    v_mfma_f32_32x32x16_bf16 v[72:87], v[184:187], a[24:27], v[72:87]
    ds_read_b64_tr_b16 v[208:209], v214 offset:256
    ds_read_b64_tr_b16 v[210:211], v214 offset:1408
    s_waitcnt lgkmcnt(10)
    v_mfma_f32_32x32x16_bf16 v[88:103], v[188:191], a[24:27], v[88:103]
    ds_read_b64_tr_b16 v[184:185], v214 offset:4608
    ds_read_b64_tr_b16 v[186:187], v214 offset:5760
    s_waitcnt lgkmcnt(10)
    v_mfma_f32_32x32x16_bf16 v[104:119], v[192:195], a[24:27], v[104:119]
    ds_read_b64_tr_b16 v[188:189], v214 offset:4640
    ds_read_b64_tr_b16 v[190:191], v214 offset:5792
    s_waitcnt lgkmcnt(10)
    v_mfma_f32_32x32x16_bf16 v[120:135], v[196:199], a[24:27], v[120:135]
    ds_read_b64_tr_b16 v[192:193], v214 offset:4672
    ds_read_b64_tr_b16 v[194:195], v214 offset:5824
    s_waitcnt lgkmcnt(10)
    v_mfma_f32_32x32x16_bf16 v[136:151], v[200:203], a[24:27], v[136:151]
    ds_read_b64_tr_b16 v[196:197], v214 offset:4704
    ds_read_b64_tr_b16 v[198:199], v214 offset:5856
    s_waitcnt lgkmcnt(10)
    v_mfma_f32_32x32x16_bf16 v[152:167], v[204:207], a[24:27], v[152:167]
    ds_read_b64_tr_b16 v[200:201], v214 offset:4736
    ds_read_b64_tr_b16 v[202:203], v214 offset:5888
    s_waitcnt lgkmcnt(10)
    v_mfma_f32_32x32x16_bf16 v[168:183], v[208:211], a[24:27], v[168:183]
    ds_read_b64_tr_b16 v[204:205], v214 offset:4768
    ds_read_b64_tr_b16 v[206:207], v214 offset:5920
    s_waitcnt lgkmcnt(10)
    v_mfma_f32_32x32x16_bf16 v[40:55], v[184:187], a[28:31], v[40:55]
    ds_read_b64_tr_b16 v[208:209], v214 offset:4800
    ds_read_b64_tr_b16 v[210:211], v214 offset:5952
    s_waitcnt lgkmcnt(10)
    v_mfma_f32_32x32x16_bf16 v[56:71], v[188:191], a[28:31], v[56:71]
    ds_read_b64_tr_b16 v[184:185], v214 offset:4832
    ds_read_b64_tr_b16 v[186:187], v214 offset:5984
    s_waitcnt lgkmcnt(10)
    v_mfma_f32_32x32x16_bf16 v[72:87], v[192:195], a[28:31], v[72:87]
    ds_read_b64_tr_b16 v[188:189], v214 offset:4864
    ds_read_b64_tr_b16 v[190:191], v214 offset:6016
    s_waitcnt lgkmcnt(10)
    v_mfma_f32_32x32x16_bf16 v[88:103], v[196:199], a[28:31], v[88:103]
    s_waitcnt vmcnt(24)
    s_barrier
    s_mov_b32 s37, 1179648
    buffer_load_dwordx4 a[72:75], v5, s[16:19], s37 offen
    s_mov_b32 s37, 1245184
    buffer_load_dwordx4 a[76:79], v5, s[16:19], s37 offen
    s_mov_b32 s44, 792576
    s_cmp_ge_u32 s14, 2
    s_cbranch_scc1 L_k1_f_dskip9
    s_add_u32 m0, s43, 18560
    s_nop 1
    buffer_load_dwordx4 v217, s[28:31], s44 offen lds
L_k1_f_dskip9:
    s_nop 0
    s_add_u32 m0, s38, 18560
    s_nop 0
    buffer_load_dwordx4 v215, s[20:23], s44 offen lds
    s_add_u32 m0, s38, 22656
    s_nop 0
    buffer_load_dwordx4 v216, s[20:23], s44 offen lds
    s_add_u32 m0, s38, 27904
    s_nop 0
    buffer_load_dwordx4 v215, s[24:27], s44 offen lds
    s_add_u32 m0, s38, 32000
    s_nop 0
    buffer_load_dwordx4 v216, s[24:27], s44 offen lds
    v_add_u32 v213, 74240, v212
    ds_read_b64_tr_b16 v[192:193], v213 offset:0
    ds_read_b64_tr_b16 v[194:195], v213 offset:1152
    s_waitcnt lgkmcnt(10)
    v_mfma_f32_32x32x16_bf16 v[104:119], v[200:203], a[28:31], v[104:119]
    ds_read_b64_tr_b16 v[196:197], v213 offset:32
    ds_read_b64_tr_b16 v[198:199], v213 offset:1184
    s_waitcnt lgkmcnt(10)
    v_mfma_f32_32x32x16_bf16 v[120:135], v[204:207], a[28:31], v[120:135]
    ds_read_b64_tr_b16 v[200:201], v213 offset:64
    ds_read_b64_tr_b16 v[202:203], v213 offset:1216
    s_waitcnt lgkmcnt(10)
    v_mfma_f32_32x32x16_bf16 v[136:151], v[208:211], a[28:31], v[136:151]
    ds_read_b64_tr_b16 v[204:205], v213 offset:96
    ds_read_b64_tr_b16 v[206:207], v213 offset:1248
    s_waitcnt lgkmcnt(10)
    v_mfma_f32_32x32x16_bf16 v[152:167], v[184:187], a[28:31], v[152:167]
    ds_read_b64_tr_b16 v[208:209], v213 offset:128
    ds_read_b64_tr_b16 v[210:211], v213 offset:1280
    s_waitcnt lgkmcnt(10)
    v_mfma_f32_32x32x16_bf16 v[168:183], v[188:191], a[28:31], v[168:183]
    ds_read_b64_tr_b16 v[184:185], v213 offset:160
    ds_read_b64_tr_b16 v[186:187], v213 offset:1312
    s_waitcnt lgkmcnt(10)
    v_mfma_f32_32x32x16_bf16 v[40:55], v[192:195], a[32:35], v[40:55]
    ds_read_b64_tr_b16 v[188:189], v213 offset:192
    ds_read_b64_tr_b16 v[190:191], v213 offset:1344
    s_waitcnt lgkmcnt(10)
    v_mfma_f32_32x32x16_bf16 v[56:71], v[196:199], a[32:35], v[56:71]
    ds_read_b64_tr_b16 v[192:193], v213 offset:224
    ds_read_b64_tr_b16 v[194:195], v213 offset:1376
    s_waitcnt lgkmcnt(10)
    v_mfma_f32_32x32x16_bf16 v[72:87], v[200:203], a[32:35], v[72:87]
    ds_read_b64_tr_b16 v[196:197], v213 offset:256
    ds_read_b64_tr_b16 v[198:199], v213 offset:1408
    s_waitcnt lgkmcnt(10)
    v_mfma_f32_32x32x16_bf16 v[88:103], v[204:207], a[32:35], v[88:103]
    ds_read_b64_tr_b16 v[200:201], v213 offset:4608
    ds_read_b64_tr_b16 v[202:203], v213 offset:5760
    s_waitcnt lgkmcnt(10)
    v_mfma_f32_32x32x16_bf16 v[104:119], v[208:211], a[32:35], v[104:119]
    ds_read_b64_tr_b16 v[204:205], v213 offset:4640
    ds_read_b64_tr_b16 v[206:207], v213 offset:5792
    s_waitcnt lgkmcnt(10)
    v_mfma_f32_32x32x16_bf16 v[120:135], v[184:187], a[32:35], v[120:135]
    ds_read_b64_tr_b16 v[208:209], v213 offset:4672
    ds_read_b64_tr_b16 v[210:211], v213 offset:5824
    s_waitcnt lgkmcnt(10)
    v_mfma_f32_32x32x16_bf16 v[136:151], v[188:191], a[32:35], v[136:151]
    ds_read_b64_tr_b16 v[184:185], v213 offset:4704
    ds_read_b64_tr_b16 v[186:187], v213 offset:5856
    s_waitcnt lgkmcnt(10)
    v_mfma_f32_32x32x16_bf16 v[152:167], v[192:195], a[32:35], v[152:167]
    ds_read_b64_tr_b16 v[188:189], v213 offset:4736
    ds_read_b64_tr_b16 v[190:191], v213 offset:5888
    s_waitcnt lgkmcnt(10)
    v_mfma_f32_32x32x16_bf16 v[168:183], v[196:199], a[32:35], v[168:183]
    ds_read_b64_tr_b16 v[192:193], v213 offset:4768
    ds_read_b64_tr_b16 v[194:195], v213 offset:5920
    s_waitcnt lgkmcnt(10)
    v_mfma_f32_32x32x16_bf16 v[40:55], v[200:203], a[36:39], v[40:55]
    ds_read_b64_tr_b16 v[196:197], v213 offset:4800
    ds_read_b64_tr_b16 v[198:199], v213 offset:5952
    s_waitcnt lgkmcnt(10)
    v_mfma_f32_32x32x16_bf16 v[56:71], v[204:207], a[36:39], v[56:71]
    ds_read_b64_tr_b16 v[200:201], v213 offset:4832
    ds_read_b64_tr_b16 v[202:203], v213 offset:5984
    s_waitcnt lgkmcnt(10)
    v_mfma_f32_32x32x16_bf16 v[72:87], v[208:211], a[36:39], v[72:87]
    ds_read_b64_tr_b16 v[204:205], v213 offset:4864
    ds_read_b64_tr_b16 v[206:207], v213 offset:6016
    s_waitcnt lgkmcnt(10)
    v_mfma_f32_32x32x16_bf16 v[88:103], v[184:187], a[36:39], v[88:103]
    s_waitcnt vmcnt(24)
    s_barrier
    s_mov_b32 s37, 1310720
    buffer_load_dwordx4 a[80:83], v5, s[16:19], s37 offen
    s_mov_b32 s37, 1376256
    buffer_load_dwordx4 a[84:87], v5, s[16:19], s37 offen
    s_mov_b32 s44, 880640
    s_cmp_ge_u32 s14, 2
    s_cbranch_scc1 L_k1_f_dskip10
    s_add_u32 m0, s43, 37120
    s_nop 1
    buffer_load_dwordx4 v217, s[28:31], s44 offen lds
L_k1_f_dskip10:
    s_nop 0
    s_add_u32 m0, s38, 37120
    s_nop 0
    buffer_load_dwordx4 v215, s[20:23], s44 offen lds
    s_add_u32 m0, s38, 41216
    s_nop 0
    buffer_load_dwordx4 v216, s[20:23], s44 offen lds
    s_add_u32 m0, s38, 46464
    s_nop 0
    buffer_load_dwordx4 v215, s[24:27], s44 offen lds
    s_add_u32 m0, s38, 50560
    s_nop 0
    buffer_load_dwordx4 v216, s[24:27], s44 offen lds
    v_add_u32 v214, 92800, v212
    ds_read_b64_tr_b16 v[208:209], v214 offset:0
    ds_read_b64_tr_b16 v[210:211], v214 offset:1152
    s_waitcnt lgkmcnt(10)
    v_mfma_f32_32x32x16_bf16 v[104:119], v[188:191], a[36:39], v[104:119]
    ds_read_b64_tr_b16 v[184:185], v214 offset:32
    ds_read_b64_tr_b16 v[186:187], v214 offset:1184
    s_waitcnt lgkmcnt(10)
    v_mfma_f32_32x32x16_bf16 v[120:135], v[192:195], a[36:39], v[120:135]
    ds_read_b64_tr_b16 v[188:189], v214 offset:64
    ds_read_b64_tr_b16 v[190:191], v214 offset:1216
    s_waitcnt lgkmcnt(10)
    v_mfma_f32_32x32x16_bf16 v[136:151], v[196:199], a[36:39], v[136:151]
    ds_read_b64_tr_b16 v[192:193], v214 offset:96
    ds_read_b64_tr_b16 v[194:195], v214 offset:1248
    s_waitcnt lgkmcnt(10)
    v_mfma_f32_32x32x16_bf16 v[152:167], v[200:203], a[36:39], v[152:167]
    ds_read_b64_tr_b16 v[196:197], v214 offset:128
    ds_read_b64_tr_b16 v[198:199], v214 offset:1280
    s_waitcnt lgkmcnt(10)
    v_mfma_f32_32x32x16_bf16 v[168:183], v[204:207], a[36:39], v[168:183]
    ds_read_b64_tr_b16 v[200:201], v214 offset:160
    ds_read_b64_tr_b16 v[202:203], v214 offset:1312
    s_waitcnt lgkmcnt(10)
    v_mfma_f32_32x32x16_bf16 v[40:55], v[208:211], a[40:43], v[40:55]
    ds_read_b64_tr_b16 v[204:205], v214 offset:192
    ds_read_b64_tr_b16 v[206:207], v214 offset:1344
    s_waitcnt lgkmcnt(10)
    v_mfma_f32_32x32x16_bf16 v[56:71], v[184:187], a[40:43], v[56:71]
    ds_read_b64_tr_b16 v[208:209], v214 offset:224
    ds_read_b64_tr_b16 v[210:211], v214 offset:1376
    s_waitcnt lgkmcnt(10)
    v_mfma_f32_32x32x16_bf16 v[72:87], v[188:191], a[40:43], v[72:87]
    ds_read_b64_tr_b16 v[184:185], v214 offset:256
    ds_read_b64_tr_b16 v[186:187], v214 offset:1408
    s_waitcnt lgkmcnt(10)
    v_mfma_f32_32x32x16_bf16 v[88:103], v[192:195], a[40:43], v[88:103]
    ds_read_b64_tr_b16 v[188:189], v214 offset:4608
    ds_read_b64_tr_b16 v[190:191], v214 offset:5760
    s_waitcnt lgkmcnt(10)
    v_mfma_f32_32x32x16_bf16 v[104:119], v[196:199], a[40:43], v[104:119]
    ds_read_b64_tr_b16 v[192:193], v214 offset:4640
    ds_read_b64_tr_b16 v[194:195], v214 offset:5792
    s_waitcnt lgkmcnt(10)
    v_mfma_f32_32x32x16_bf16 v[120:135], v[200:203], a[40:43], v[120:135]
    ds_read_b64_tr_b16 v[196:197], v214 offset:4672
    ds_read_b64_tr_b16 v[198:199], v214 offset:5824
    s_waitcnt lgkmcnt(10)
    v_mfma_f32_32x32x16_bf16 v[136:151], v[204:207], a[40:43], v[136:151]
    ds_read_b64_tr_b16 v[200:201], v214 offset:4704
    ds_read_b64_tr_b16 v[202:203], v214 offset:5856
    s_waitcnt lgkmcnt(10)
    v_mfma_f32_32x32x16_bf16 v[152:167], v[208:211], a[40:43], v[152:167]
    ds_read_b64_tr_b16 v[204:205], v214 offset:4736
    ds_read_b64_tr_b16 v[206:207], v214 offset:5888
    s_waitcnt lgkmcnt(10)
    v_mfma_f32_32x32x16_bf16 v[168:183], v[184:187], a[40:43], v[168:183]
    ds_read_b64_tr_b16 v[208:209], v214 offset:4768
    ds_read_b64_tr_b16 v[210:211], v214 offset:5920
    s_waitcnt lgkmcnt(10)
    v_mfma_f32_32x32x16_bf16 v[40:55], v[188:191], a[44:47], v[40:55]
    ds_read_b64_tr_b16 v[184:185], v214 offset:4800
    ds_read_b64_tr_b16 v[186:187], v214 offset:5952
    s_waitcnt lgkmcnt(10)
    v_mfma_f32_32x32x16_bf16 v[56:71], v[192:195], a[44:47], v[56:71]
    ds_read_b64_tr_b16 v[188:189], v214 offset:4832
    ds_read_b64_tr_b16 v[190:191], v214 offset:5984
    s_waitcnt lgkmcnt(10)
    v_mfma_f32_32x32x16_bf16 v[72:87], v[196:199], a[44:47], v[72:87]
    ds_read_b64_tr_b16 v[192:193], v214 offset:4864
    ds_read_b64_tr_b16 v[194:195], v214 offset:6016
    s_waitcnt lgkmcnt(10)
    v_mfma_f32_32x32x16_bf16 v[88:103], v[200:203], a[44:47], v[88:103]
    s_waitcnt vmcnt(24)
    s_barrier
    s_mov_b32 s37, 1441792
    buffer_load_dwordx4 a[88:91], v5, s[16:19], s37 offen
    s_mov_b32 s37, 1507328
    buffer_load_dwordx4 a[92:95], v5, s[16:19], s37 offen
    s_mov_b32 s44, 968704
    s_cmp_ge_u32 s14, 2
    s_cbranch_scc1 L_k1_f_dskip11
    s_add_u32 m0, s43, 55680
    s_nop 1
    buffer_load_dwordx4 v217, s[28:31], s44 offen lds
L_k1_f_dskip11:
    s_nop 0
    s_add_u32 m0, s38, 55680
    s_nop 0
    buffer_load_dwordx4 v215, s[20:23], s44 offen lds
    s_add_u32 m0, s38, 59776
    s_nop 0
    buffer_load_dwordx4 v216, s[20:23], s44 offen lds
    s_add_u32 m0, s38, 65024
    s_nop 0
    buffer_load_dwordx4 v215, s[24:27], s44 offen lds
    s_add_u32 m0, s38, 69120
    s_nop 0
    buffer_load_dwordx4 v216, s[24:27], s44 offen lds
    v_add_u32 v213, 111360, v212
    ds_read_b64_tr_b16 v[196:197], v213 offset:0
    ds_read_b64_tr_b16 v[198:199], v213 offset:1152
    s_waitcnt lgkmcnt(10)
    v_mfma_f32_32x32x16_bf16 v[104:119], v[204:207], a[44:47], v[104:119]
    ds_read_b64_tr_b16 v[200:201], v213 offset:32
    ds_read_b64_tr_b16 v[202:203], v213 offset:1184
    s_waitcnt lgkmcnt(10)
    v_mfma_f32_32x32x16_bf16 v[120:135], v[208:211], a[44:47], v[120:135]
    ds_read_b64_tr_b16 v[204:205], v213 offset:64
    ds_read_b64_tr_b16 v[206:207], v213 offset:1216
    s_waitcnt lgkmcnt(10)
    v_mfma_f32_32x32x16_bf16 v[136:151], v[184:187], a[44:47], v[136:151]
    ds_read_b64_tr_b16 v[208:209], v213 offset:96
    ds_read_b64_tr_b16 v[210:211], v213 offset:1248
    s_waitcnt lgkmcnt(10)
    v_mfma_f32_32x32x16_bf16 v[152:167], v[188:191], a[44:47], v[152:167]
    ds_read_b64_tr_b16 v[184:185], v213 offset:128
    ds_read_b64_tr_b16 v[186:187], v213 offset:1280
    s_waitcnt lgkmcnt(10)
    v_mfma_f32_32x32x16_bf16 v[168:183], v[192:195], a[44:47], v[168:183]
    ds_read_b64_tr_b16 v[188:189], v213 offset:160
    ds_read_b64_tr_b16 v[190:191], v213 offset:1312
    s_waitcnt lgkmcnt(10)
    v_mfma_f32_32x32x16_bf16 v[40:55], v[196:199], a[48:51], v[40:55]
    ds_read_b64_tr_b16 v[192:193], v213 offset:192
    ds_read_b64_tr_b16 v[194:195], v213 offset:1344
    s_waitcnt lgkmcnt(10)
    v_mfma_f32_32x32x16_bf16 v[56:71], v[200:203], a[48:51], v[56:71]
    ds_read_b64_tr_b16 v[196:197], v213 offset:224
    ds_read_b64_tr_b16 v[198:199], v213 offset:1376
    s_waitcnt lgkmcnt(10)
    v_mfma_f32_32x32x16_bf16 v[72:87], v[204:207], a[48:51], v[72:87]
    ds_read_b64_tr_b16 v[200:201], v213 offset:256
    ds_read_b64_tr_b16 v[202:203], v213 offset:1408
    s_waitcnt lgkmcnt(10)
    v_mfma_f32_32x32x16_bf16 v[88:103], v[208:211], a[48:51], v[88:103]
    ds_read_b64_tr_b16 v[204:205], v213 offset:4608
    ds_read_b64_tr_b16 v[206:207], v213 offset:5760
    s_waitcnt lgkmcnt(10)
    v_mfma_f32_32x32x16_bf16 v[104:119], v[184:187], a[48:51], v[104:119]
    ds_read_b64_tr_b16 v[208:209], v213 offset:4640
    ds_read_b64_tr_b16 v[210:211], v213 offset:5792
    s_waitcnt lgkmcnt(10)
    v_mfma_f32_32x32x16_bf16 v[120:135], v[188:191], a[48:51], v[120:135]
    ds_read_b64_tr_b16 v[184:185], v213 offset:4672
    ds_read_b64_tr_b16 v[186:187], v213 offset:5824
    s_waitcnt lgkmcnt(10)
    v_mfma_f32_32x32x16_bf16 v[136:151], v[192:195], a[48:51], v[136:151]
    ds_read_b64_tr_b16 v[188:189], v213 offset:4704
    ds_read_b64_tr_b16 v[190:191], v213 offset:5856
    s_waitcnt lgkmcnt(10)
    v_mfma_f32_32x32x16_bf16 v[152:167], v[196:199], a[48:51], v[152:167]
    ds_read_b64_tr_b16 v[192:193], v213 offset:4736
    ds_read_b64_tr_b16 v[194:195], v213 offset:5888
    s_waitcnt lgkmcnt(10)
    v_mfma_f32_32x32x16_bf16 v[168:183], v[200:203], a[48:51], v[168:183]
    ds_read_b64_tr_b16 v[196:197], v213 offset:4768
    ds_read_b64_tr_b16 v[198:199], v213 offset:5920
    s_waitcnt lgkmcnt(10)
    v_mfma_f32_32x32x16_bf16 v[40:55], v[204:207], a[52:55], v[40:55]
    ds_read_b64_tr_b16 v[200:201], v213 offset:4800
    ds_read_b64_tr_b16 v[202:203], v213 offset:5952
    s_waitcnt lgkmcnt(10)
    v_mfma_f32_32x32x16_bf16 v[56:71], v[208:211], a[52:55], v[56:71]
    ds_read_b64_tr_b16 v[204:205], v213 offset:4832
    ds_read_b64_tr_b16 v[206:207], v213 offset:5984
    s_waitcnt lgkmcnt(10)
    v_mfma_f32_32x32x16_bf16 v[72:87], v[184:187], a[52:55], v[72:87]
    ds_read_b64_tr_b16 v[208:209], v213 offset:4864
    ds_read_b64_tr_b16 v[210:211], v213 offset:6016
    s_waitcnt lgkmcnt(10)
    v_mfma_f32_32x32x16_bf16 v[88:103], v[188:191], a[52:55], v[88:103]
    s_waitcnt vmcnt(24)
    s_barrier
    s_mov_b32 s37, 1572864
    buffer_load_dwordx4 a[96:99], v5, s[16:19], s37 offen
    s_mov_b32 s37, 1638400
    buffer_load_dwordx4 a[100:103], v5, s[16:19], s37 offen
    s_mov_b32 s44, 1056768
    s_cmp_ge_u32 s14, 2
    s_cbranch_scc1 L_k1_f_dskip12
    s_add_u32 m0, s43, 74240
    s_nop 1
    buffer_load_dwordx4 v217, s[28:31], s44 offen lds
L_k1_f_dskip12:
    s_nop 0
    s_add_u32 m0, s38, 74240
    s_nop 0
    buffer_load_dwordx4 v215, s[20:23], s44 offen lds
    s_add_u32 m0, s38, 78336
    s_nop 0
    buffer_load_dwordx4 v216, s[20:23], s44 offen lds
    s_add_u32 m0, s38, 83584
    s_nop 0
    buffer_load_dwordx4 v215, s[24:27], s44 offen lds
    s_add_u32 m0, s38, 87680
    s_nop 0
    buffer_load_dwordx4 v216, s[24:27], s44 offen lds
    v_add_u32 v214, 129920, v212
    ds_read_b64_tr_b16 v[184:185], v214 offset:0
    ds_read_b64_tr_b16 v[186:187], v214 offset:1152
    s_waitcnt lgkmcnt(10)
    v_mfma_f32_32x32x16_bf16 v[104:119], v[192:195], a[52:55], v[104:119]
    ds_read_b64_tr_b16 v[188:189], v214 offset:32
    ds_read_b64_tr_b16 v[190:191], v214 offset:1184
    s_waitcnt lgkmcnt(10)
    v_mfma_f32_32x32x16_bf16 v[120:135], v[196:199], a[52:55], v[120:135]
    ds_read_b64_tr_b16 v[192:193], v214 offset:64
    ds_read_b64_tr_b16 v[194:195], v214 offset:1216
    s_waitcnt lgkmcnt(10)
    v_mfma_f32_32x32x16_bf16 v[136:151], v[200:203], a[52:55], v[136:151]
    ds_read_b64_tr_b16 v[196:197], v214 offset:96
    ds_read_b64_tr_b16 v[198:199], v214 offset:1248
    s_waitcnt lgkmcnt(10)
    v_mfma_f32_32x32x16_bf16 v[152:167], v[204:207], a[52:55], v[152:167]
    ds_read_b64_tr_b16 v[200:201], v214 offset:128
    ds_read_b64_tr_b16 v[202:203], v214 offset:1280
    s_waitcnt lgkmcnt(10)
    v_mfma_f32_32x32x16_bf16 v[168:183], v[208:211], a[52:55], v[168:183]
    ds_read_b64_tr_b16 v[204:205], v214 offset:160
    ds_read_b64_tr_b16 v[206:207], v214 offset:1312
    s_waitcnt lgkmcnt(10)
    v_mfma_f32_32x32x16_bf16 v[40:55], v[184:187], a[56:59], v[40:55]
    ds_read_b64_tr_b16 v[208:209], v214 offset:192
    ds_read_b64_tr_b16 v[210:211], v214 offset:1344
    s_waitcnt lgkmcnt(10)
    v_mfma_f32_32x32x16_bf16 v[56:71], v[188:191], a[56:59], v[56:71]
    ds_read_b64_tr_b16 v[184:185], v214 offset:224
    ds_read_b64_tr_b16 v[186:187], v214 offset:1376
    s_waitcnt lgkmcnt(10)
    v_mfma_f32_32x32x16_bf16 v[72:87], v[192:195], a[56:59], v[72:87]
    ds_read_b64_tr_b16 v[188:189], v214 offset:256
    ds_read_b64_tr_b16 v[190:191], v214 offset:1408
    s_waitcnt lgkmcnt(10)
    v_mfma_f32_32x32x16_bf16 v[88:103], v[196:199], a[56:59], v[88:103]
    ds_read_b64_tr_b16 v[192:193], v214 offset:4608
    ds_read_b64_tr_b16 v[194:195], v214 offset:5760
    s_waitcnt lgkmcnt(10)
    v_mfma_f32_32x32x16_bf16 v[104:119], v[200:203], a[56:59], v[104:119]
    ds_read_b64_tr_b16 v[196:197], v214 offset:4640
    ds_read_b64_tr_b16 v[198:199], v214 offset:5792
    s_waitcnt lgkmcnt(10)
    v_mfma_f32_32x32x16_bf16 v[120:135], v[204:207], a[56:59], v[120:135]
    ds_read_b64_tr_b16 v[200:201], v214 offset:4672
    ds_read_b64_tr_b16 v[202:203], v214 offset:5824
    s_waitcnt lgkmcnt(10)
    v_mfma_f32_32x32x16_bf16 v[136:151], v[208:211], a[56:59], v[136:151]
    ds_read_b64_tr_b16 v[204:205], v214 offset:4704
    ds_read_b64_tr_b16 v[206:207], v214 offset:5856
    s_waitcnt lgkmcnt(10)
    v_mfma_f32_32x32x16_bf16 v[152:167], v[184:187], a[56:59], v[152:167]
    ds_read_b64_tr_b16 v[208:209], v214 offset:4736
    ds_read_b64_tr_b16 v[210:211], v214 offset:5888
    s_waitcnt lgkmcnt(10)
    v_mfma_f32_32x32x16_bf16 v[168:183], v[188:191], a[56:59], v[168:183]
    ds_read_b64_tr_b16 v[184:185], v214 offset:4768
    ds_read_b64_tr_b16 v[186:187], v214 offset:5920
    s_waitcnt lgkmcnt(10)
    v_mfma_f32_32x32x16_bf16 v[40:55], v[192:195], a[60:63], v[40:55]
    ds_read_b64_tr_b16 v[188:189], v214 offset:4800
    ds_read_b64_tr_b16 v[190:191], v214 offset:5952
    s_waitcnt lgkmcnt(10)
    v_mfma_f32_32x32x16_bf16 v[56:71], v[196:199], a[60:63], v[56:71]
    ds_read_b64_tr_b16 v[192:193], v214 offset:4832
    ds_read_b64_tr_b16 v[194:195], v214 offset:5984
    s_waitcnt lgkmcnt(10)
    v_mfma_f32_32x32x16_bf16 v[72:87], v[200:203], a[60:63], v[72:87]
    ds_read_b64_tr_b16 v[196:197], v214 offset:4864
    ds_read_b64_tr_b16 v[198:199], v214 offset:6016
    s_waitcnt lgkmcnt(10)
    v_mfma_f32_32x32x16_bf16 v[88:103], v[204:207], a[60:63], v[88:103]
    s_waitcnt vmcnt(24)
    s_barrier
    s_mov_b32 s37, 1703936
    buffer_load_dwordx4 a[104:107], v5, s[16:19], s37 offen
    s_mov_b32 s37, 1769472
    buffer_load_dwordx4 a[108:111], v5, s[16:19], s37 offen
    s_mov_b32 s44, 1144832
    s_cmp_ge_u32 s14, 2
    s_cbranch_scc1 L_k1_f_dskip13
    s_add_u32 m0, s43, 92800
    s_nop 1
    buffer_load_dwordx4 v217, s[28:31], s44 offen lds
L_k1_f_dskip13:
    s_nop 0
    s_add_u32 m0, s38, 92800
    s_nop 0
    buffer_load_dwordx4 v215, s[20:23], s44 offen lds
    s_add_u32 m0, s38, 96896
    s_nop 0
    buffer_load_dwordx4 v216, s[20:23], s44 offen lds
    s_add_u32 m0, s38, 102144
    s_nop 0
    buffer_load_dwordx4 v215, s[24:27], s44 offen lds
    s_add_u32 m0, s38, 106240
    s_nop 0
    buffer_load_dwordx4 v216, s[24:27], s44 offen lds
    v_add_u32 v213, 0, v212
    ds_read_b64_tr_b16 v[200:201], v213 offset:0
    ds_read_b64_tr_b16 v[202:203], v213 offset:1152
    s_waitcnt lgkmcnt(10)
    v_mfma_f32_32x32x16_bf16 v[104:119], v[208:211], a[60:63], v[104:119]
    ds_read_b64_tr_b16 v[204:205], v213 offset:32
    ds_read_b64_tr_b16 v[206:207], v213 offset:1184
    s_waitcnt lgkmcnt(10)
    v_mfma_f32_32x32x16_bf16 v[120:135], v[184:187], a[60:63], v[120:135]
    ds_read_b64_tr_b16 v[208:209], v213 offset:64
    ds_read_b64_tr_b16 v[210:211], v213 offset:1216
    s_waitcnt lgkmcnt(10)
    v_mfma_f32_32x32x16_bf16 v[136:151], v[188:191], a[60:63], v[136:151]
    ds_read_b64_tr_b16 v[184:185], v213 offset:96
    ds_read_b64_tr_b16 v[186:187], v213 offset:1248
    s_waitcnt lgkmcnt(10)
    v_mfma_f32_32x32x16_bf16 v[152:167], v[192:195], a[60:63], v[152:167]
    ds_read_b64_tr_b16 v[188:189], v213 offset:128
    ds_read_b64_tr_b16 v[190:191], v213 offset:1280
    s_waitcnt lgkmcnt(10)
    v_mfma_f32_32x32x16_bf16 v[168:183], v[196:199], a[60:63], v[168:183]
    ds_read_b64_tr_b16 v[192:193], v213 offset:160
    ds_read_b64_tr_b16 v[194:195], v213 offset:1312
    s_waitcnt lgkmcnt(10)
    v_mfma_f32_32x32x16_bf16 v[40:55], v[200:203], a[64:67], v[40:55]
    ds_read_b64_tr_b16 v[196:197], v213 offset:192
    ds_read_b64_tr_b16 v[198:199], v213 offset:1344
    s_waitcnt lgkmcnt(10)
    v_mfma_f32_32x32x16_bf16 v[56:71], v[204:207], a[64:67], v[56:71]
    ds_read_b64_tr_b16 v[200:201], v213 offset:224
    ds_read_b64_tr_b16 v[202:203], v213 offset:1376
    s_waitcnt lgkmcnt(10)
    v_mfma_f32_32x32x16_bf16 v[72:87], v[208:211], a[64:67], v[72:87]
    ds_read_b64_tr_b16 v[204:205], v213 offset:256
    ds_read_b64_tr_b16 v[206:207], v213 offset:1408
    s_waitcnt lgkmcnt(10)
    v_mfma_f32_32x32x16_bf16 v[88:103], v[184:187], a[64:67], v[88:103]
    ds_read_b64_tr_b16 v[208:209], v213 offset:4608
    ds_read_b64_tr_b16 v[210:211], v213 offset:5760
    s_waitcnt lgkmcnt(10)
    v_mfma_f32_32x32x16_bf16 v[104:119], v[188:191], a[64:67], v[104:119]
    ds_read_b64_tr_b16 v[184:185], v213 offset:4640
    ds_read_b64_tr_b16 v[186:187], v213 offset:5792
    s_waitcnt lgkmcnt(10)
    v_mfma_f32_32x32x16_bf16 v[120:135], v[192:195], a[64:67], v[120:135]
    ds_read_b64_tr_b16 v[188:189], v213 offset:4672
    ds_read_b64_tr_b16 v[190:191], v213 offset:5824
    s_waitcnt lgkmcnt(10)
    v_mfma_f32_32x32x16_bf16 v[136:151], v[196:199], a[64:67], v[136:151]
    ds_read_b64_tr_b16 v[192:193], v213 offset:4704
    ds_read_b64_tr_b16 v[194:195], v213 offset:5856
    s_waitcnt lgkmcnt(10)
    v_mfma_f32_32x32x16_bf16 v[152:167], v[200:203], a[64:67], v[152:167]
    ds_read_b64_tr_b16 v[196:197], v213 offset:4736
    ds_read_b64_tr_b16 v[198:199], v213 offset:5888
    s_waitcnt lgkmcnt(10)
    v_mfma_f32_32x32x16_bf16 v[168:183], v[204:207], a[64:67], v[168:183]
    ds_read_b64_tr_b16 v[200:201], v213 offset:4768
    ds_read_b64_tr_b16 v[202:203], v213 offset:5920
    s_waitcnt lgkmcnt(10)
    v_mfma_f32_32x32x16_bf16 v[40:55], v[208:211], a[68:71], v[40:55]
    ds_read_b64_tr_b16 v[204:205], v213 offset:4800
    ds_read_b64_tr_b16 v[206:207], v213 offset:5952
    s_waitcnt lgkmcnt(10)
    v_mfma_f32_32x32x16_bf16 v[56:71], v[184:187], a[68:71], v[56:71]
    ds_read_b64_tr_b16 v[208:209], v213 offset:4832
    ds_read_b64_tr_b16 v[210:211], v213 offset:5984
    s_waitcnt lgkmcnt(10)
    v_mfma_f32_32x32x16_bf16 v[72:87], v[188:191], a[68:71], v[72:87]
    ds_read_b64_tr_b16 v[184:185], v213 offset:4864
    ds_read_b64_tr_b16 v[186:187], v213 offset:6016
    s_waitcnt lgkmcnt(10)
    v_mfma_f32_32x32x16_bf16 v[88:103], v[192:195], a[68:71], v[88:103]
    s_waitcnt vmcnt(24)
    s_barrier
    s_mov_b32 s37, 1835008
    buffer_load_dwordx4 a[112:115], v5, s[16:19], s37 offen
    s_mov_b32 s37, 1900544
    buffer_load_dwordx4 a[116:119], v5, s[16:19], s37 offen
    s_mov_b32 s44, 1232896
    s_cmp_ge_u32 s14, 2
    s_cbranch_scc1 L_k1_f_dskip14
    s_add_u32 m0, s43, 111360
    s_nop 1
    buffer_load_dwordx4 v217, s[28:31], s44 offen lds
L_k1_f_dskip14:
    s_nop 0
    s_add_u32 m0, s38, 111360
    s_nop 0
    buffer_load_dwordx4 v215, s[20:23], s44 offen lds
    s_add_u32 m0, s38, 115456
    s_nop 0
    buffer_load_dwordx4 v216, s[20:23], s44 offen lds
    s_add_u32 m0, s38, 120704
    s_nop 0
    buffer_load_dwordx4 v215, s[24:27], s44 offen lds
    s_add_u32 m0, s38, 124800
    s_nop 0
    buffer_load_dwordx4 v216, s[24:27], s44 offen lds
    v_add_u32 v214, 18560, v212
    ds_read_b64_tr_b16 v[188:189], v214 offset:0
    ds_read_b64_tr_b16 v[190:191], v214 offset:1152
    s_waitcnt lgkmcnt(10)
    v_mfma_f32_32x32x16_bf16 v[104:119], v[196:199], a[68:71], v[104:119]
    ds_read_b64_tr_b16 v[192:193], v214 offset:32
    ds_read_b64_tr_b16 v[194:195], v214 offset:1184
    s_waitcnt lgkmcnt(10)
    v_mfma_f32_32x32x16_bf16 v[120:135], v[200:203], a[68:71], v[120:135]
    ds_read_b64_tr_b16 v[196:197], v214 offset:64
    ds_read_b64_tr_b16 v[198:199], v214 offset:1216
    s_waitcnt lgkmcnt(10)
    v_mfma_f32_32x32x16_bf16 v[136:151], v[204:207], a[68:71], v[136:151]
    ds_read_b64_tr_b16 v[200:201], v214 offset:96
    ds_read_b64_tr_b16 v[202:203], v214 offset:1248
    s_waitcnt lgkmcnt(10)
    v_mfma_f32_32x32x16_bf16 v[152:167], v[208:211], a[68:71], v[152:167]
    ds_read_b64_tr_b16 v[204:205], v214 offset:128
    ds_read_b64_tr_b16 v[206:207], v214 offset:1280
    s_waitcnt lgkmcnt(10)
    v_mfma_f32_32x32x16_bf16 v[168:183], v[184:187], a[68:71], v[168:183]
    ds_read_b64_tr_b16 v[208:209], v214 offset:160
    ds_read_b64_tr_b16 v[210:211], v214 offset:1312
    s_waitcnt lgkmcnt(10)
    v_mfma_f32_32x32x16_bf16 v[40:55], v[188:191], a[72:75], v[40:55]
    ds_read_b64_tr_b16 v[184:185], v214 offset:192
    ds_read_b64_tr_b16 v[186:187], v214 offset:1344
    s_waitcnt lgkmcnt(10)
    v_mfma_f32_32x32x16_bf16 v[56:71], v[192:195], a[72:75], v[56:71]
    ds_read_b64_tr_b16 v[188:189], v214 offset:224
    ds_read_b64_tr_b16 v[190:191], v214 offset:1376
    s_waitcnt lgkmcnt(10)
    v_mfma_f32_32x32x16_bf16 v[72:87], v[196:199], a[72:75], v[72:87]
    ds_read_b64_tr_b16 v[192:193], v214 offset:256
    ds_read_b64_tr_b16 v[194:195], v214 offset:1408
    s_waitcnt lgkmcnt(10)
    v_mfma_f32_32x32x16_bf16 v[88:103], v[200:203], a[72:75], v[88:103]
    ds_read_b64_tr_b16 v[196:197], v214 offset:4608
    ds_read_b64_tr_b16 v[198:199], v214 offset:5760
    s_waitcnt lgkmcnt(10)
    v_mfma_f32_32x32x16_bf16 v[104:119], v[204:207], a[72:75], v[104:119]
    ds_read_b64_tr_b16 v[200:201], v214 offset:4640
    ds_read_b64_tr_b16 v[202:203], v214 offset:5792
    s_waitcnt lgkmcnt(10)
    v_mfma_f32_32x32x16_bf16 v[120:135], v[208:211], a[72:75], v[120:135]
    ds_read_b64_tr_b16 v[204:205], v214 offset:4672
    ds_read_b64_tr_b16 v[206:207], v214 offset:5824
    s_waitcnt lgkmcnt(10)
    v_mfma_f32_32x32x16_bf16 v[136:151], v[184:187], a[72:75], v[136:151]
    ds_read_b64_tr_b16 v[208:209], v214 offset:4704
    ds_read_b64_tr_b16 v[210:211], v214 offset:5856
    s_waitcnt lgkmcnt(10)
    v_mfma_f32_32x32x16_bf16 v[152:167], v[188:191], a[72:75], v[152:167]
    ds_read_b64_tr_b16 v[184:185], v214 offset:4736
    ds_read_b64_tr_b16 v[186:187], v214 offset:5888
    s_waitcnt lgkmcnt(10)
    v_mfma_f32_32x32x16_bf16 v[168:183], v[192:195], a[72:75], v[168:183]
    ds_read_b64_tr_b16 v[188:189], v214 offset:4768
    ds_read_b64_tr_b16 v[190:191], v214 offset:5920
    s_waitcnt lgkmcnt(10)
    v_mfma_f32_32x32x16_bf16 v[40:55], v[196:199], a[76:79], v[40:55]
    ds_read_b64_tr_b16 v[192:193], v214 offset:4800
    ds_read_b64_tr_b16 v[194:195], v214 offset:5952
    s_waitcnt lgkmcnt(10)
    v_mfma_f32_32x32x16_bf16 v[56:71], v[200:203], a[76:79], v[56:71]
    ds_read_b64_tr_b16 v[196:197], v214 offset:4832
    ds_read_b64_tr_b16 v[198:199], v214 offset:5984
    s_waitcnt lgkmcnt(10)
    v_mfma_f32_32x32x16_bf16 v[72:87], v[204:207], a[76:79], v[72:87]
    ds_read_b64_tr_b16 v[200:201], v214 offset:4864
    ds_read_b64_tr_b16 v[202:203], v214 offset:6016
    s_waitcnt lgkmcnt(10)
    v_mfma_f32_32x32x16_bf16 v[88:103], v[208:211], a[76:79], v[88:103]
    s_waitcnt vmcnt(24)
    s_barrier
    s_mov_b32 s37, 1966080
    buffer_load_dwordx4 a[120:123], v5, s[16:19], s37 offen
    s_mov_b32 s37, 2031616
    buffer_load_dwordx4 a[124:127], v5, s[16:19], s37 offen
    s_mov_b32 s44, 1320960
    s_cmp_ge_u32 s14, 2
    s_cbranch_scc1 L_k1_f_dskip15
    s_add_u32 m0, s43, 129920
    s_nop 1
    buffer_load_dwordx4 v217, s[28:31], s44 offen lds
L_k1_f_dskip15:
    s_nop 0
    s_add_u32 m0, s38, 129920
    s_nop 0
    buffer_load_dwordx4 v215, s[20:23], s44 offen lds
    s_add_u32 m0, s38, 134016
    s_nop 0
    buffer_load_dwordx4 v216, s[20:23], s44 offen lds
    s_add_u32 m0, s38, 139264
    s_nop 0
    buffer_load_dwordx4 v215, s[24:27], s44 offen lds
    s_add_u32 m0, s38, 143360
    s_nop 0
    buffer_load_dwordx4 v216, s[24:27], s44 offen lds
    v_add_u32 v213, 37120, v212
    ds_read_b64_tr_b16 v[204:205], v213 offset:0
    ds_read_b64_tr_b16 v[206:207], v213 offset:1152
    s_waitcnt lgkmcnt(10)
    v_mfma_f32_32x32x16_bf16 v[104:119], v[184:187], a[76:79], v[104:119]
    ds_read_b64_tr_b16 v[208:209], v213 offset:32
    ds_read_b64_tr_b16 v[210:211], v213 offset:1184
    s_waitcnt lgkmcnt(10)
    v_mfma_f32_32x32x16_bf16 v[120:135], v[188:191], a[76:79], v[120:135]
    ds_read_b64_tr_b16 v[184:185], v213 offset:64
    ds_read_b64_tr_b16 v[186:187], v213 offset:1216
    s_waitcnt lgkmcnt(10)
    v_mfma_f32_32x32x16_bf16 v[136:151], v[192:195], a[76:79], v[136:151]
    ds_read_b64_tr_b16 v[188:189], v213 offset:96
    ds_read_b64_tr_b16 v[190:191], v213 offset:1248
    s_waitcnt lgkmcnt(10)
    v_mfma_f32_32x32x16_bf16 v[152:167], v[196:199], a[76:79], v[152:167]
    ds_read_b64_tr_b16 v[192:193], v213 offset:128
    ds_read_b64_tr_b16 v[194:195], v213 offset:1280
    s_waitcnt lgkmcnt(10)
    v_mfma_f32_32x32x16_bf16 v[168:183], v[200:203], a[76:79], v[168:183]
    ds_read_b64_tr_b16 v[196:197], v213 offset:160
    ds_read_b64_tr_b16 v[198:199], v213 offset:1312
    s_waitcnt lgkmcnt(10)
    v_mfma_f32_32x32x16_bf16 v[40:55], v[204:207], a[80:83], v[40:55]
    ds_read_b64_tr_b16 v[200:201], v213 offset:192
    ds_read_b64_tr_b16 v[202:203], v213 offset:1344
    s_waitcnt lgkmcnt(10)
    v_mfma_f32_32x32x16_bf16 v[56:71], v[208:211], a[80:83], v[56:71]
    ds_read_b64_tr_b16 v[204:205], v213 offset:224
    ds_read_b64_tr_b16 v[206:207], v213 offset:1376
    s_waitcnt lgkmcnt(10)
    v_mfma_f32_32x32x16_bf16 v[72:87], v[184:187], a[80:83], v[72:87]
    ds_read_b64_tr_b16 v[208:209], v213 offset:256
    ds_read_b64_tr_b16 v[210:211], v213 offset:1408
    s_waitcnt lgkmcnt(10)
    v_mfma_f32_32x32x16_bf16 v[88:103], v[188:191], a[80:83], v[88:103]
    ds_read_b64_tr_b16 v[184:185], v213 offset:4608
    ds_read_b64_tr_b16 v[186:187], v213 offset:5760
    s_waitcnt lgkmcnt(10)
    v_mfma_f32_32x32x16_bf16 v[104:119], v[192:195], a[80:83], v[104:119]
    ds_read_b64_tr_b16 v[188:189], v213 offset:4640
    ds_read_b64_tr_b16 v[190:191], v213 offset:5792
    s_waitcnt lgkmcnt(10)
    v_mfma_f32_32x32x16_bf16 v[120:135], v[196:199], a[80:83], v[120:135]
    ds_read_b64_tr_b16 v[192:193], v213 offset:4672
    ds_read_b64_tr_b16 v[194:195], v213 offset:5824
    s_waitcnt lgkmcnt(10)
    v_mfma_f32_32x32x16_bf16 v[136:151], v[200:203], a[80:83], v[136:151]
    ds_read_b64_tr_b16 v[196:197], v213 offset:4704
    ds_read_b64_tr_b16 v[198:199], v213 offset:5856
    s_waitcnt lgkmcnt(10)
    v_mfma_f32_32x32x16_bf16 v[152:167], v[204:207], a[80:83], v[152:167]
    ds_read_b64_tr_b16 v[200:201], v213 offset:4736
    ds_read_b64_tr_b16 v[202:203], v213 offset:5888
    s_waitcnt lgkmcnt(10)
    v_mfma_f32_32x32x16_bf16 v[168:183], v[208:211], a[80:83], v[168:183]
    ds_read_b64_tr_b16 v[204:205], v213 offset:4768
    ds_read_b64_tr_b16 v[206:207], v213 offset:5920
    s_waitcnt lgkmcnt(10)
    v_mfma_f32_32x32x16_bf16 v[40:55], v[184:187], a[84:87], v[40:55]
    ds_read_b64_tr_b16 v[208:209], v213 offset:4800
    ds_read_b64_tr_b16 v[210:211], v213 offset:5952
    s_waitcnt lgkmcnt(10)
    v_mfma_f32_32x32x16_bf16 v[56:71], v[188:191], a[84:87], v[56:71]
    ds_read_b64_tr_b16 v[184:185], v213 offset:4832
    ds_read_b64_tr_b16 v[186:187], v213 offset:5984
    s_waitcnt lgkmcnt(10)
    v_mfma_f32_32x32x16_bf16 v[72:87], v[192:195], a[84:87], v[72:87]
    ds_read_b64_tr_b16 v[188:189], v213 offset:4864
    ds_read_b64_tr_b16 v[190:191], v213 offset:6016
    s_waitcnt lgkmcnt(10)
    v_mfma_f32_32x32x16_bf16 v[88:103], v[196:199], a[84:87], v[88:103]
    s_waitcnt vmcnt(24)
    s_barrier
    v_add_u32 v214, 55680, v212
    ds_read_b64_tr_b16 v[192:193], v214 offset:0
    ds_read_b64_tr_b16 v[194:195], v214 offset:1152
    s_waitcnt lgkmcnt(10)
    v_mfma_f32_32x32x16_bf16 v[104:119], v[200:203], a[84:87], v[104:119]
    ds_read_b64_tr_b16 v[196:197], v214 offset:32
    ds_read_b64_tr_b16 v[198:199], v214 offset:1184
    s_waitcnt lgkmcnt(10)
    v_mfma_f32_32x32x16_bf16 v[120:135], v[204:207], a[84:87], v[120:135]
    ds_read_b64_tr_b16 v[200:201], v214 offset:64
    ds_read_b64_tr_b16 v[202:203], v214 offset:1216
    s_waitcnt lgkmcnt(10)
    v_mfma_f32_32x32x16_bf16 v[136:151], v[208:211], a[84:87], v[136:151]
    ds_read_b64_tr_b16 v[204:205], v214 offset:96
    ds_read_b64_tr_b16 v[206:207], v214 offset:1248
    s_waitcnt lgkmcnt(10)
    v_mfma_f32_32x32x16_bf16 v[152:167], v[184:187], a[84:87], v[152:167]
    ds_read_b64_tr_b16 v[208:209], v214 offset:128
    ds_read_b64_tr_b16 v[210:211], v214 offset:1280
    s_waitcnt lgkmcnt(10)
    v_mfma_f32_32x32x16_bf16 v[168:183], v[188:191], a[84:87], v[168:183]
    ds_read_b64_tr_b16 v[184:185], v214 offset:160
    ds_read_b64_tr_b16 v[186:187], v214 offset:1312
    s_waitcnt lgkmcnt(10)
    v_mfma_f32_32x32x16_bf16 v[40:55], v[192:195], a[88:91], v[40:55]
    ds_read_b64_tr_b16 v[188:189], v214 offset:192
    ds_read_b64_tr_b16 v[190:191], v214 offset:1344
    s_waitcnt lgkmcnt(10)
    v_mfma_f32_32x32x16_bf16 v[56:71], v[196:199], a[88:91], v[56:71]
    ds_read_b64_tr_b16 v[192:193], v214 offset:224
    ds_read_b64_tr_b16 v[194:195], v214 offset:1376
    s_waitcnt lgkmcnt(10)
    v_mfma_f32_32x32x16_bf16 v[72:87], v[200:203], a[88:91], v[72:87]
    ds_read_b64_tr_b16 v[196:197], v214 offset:256
    ds_read_b64_tr_b16 v[198:199], v214 offset:1408
    s_waitcnt lgkmcnt(10)
    v_mfma_f32_32x32x16_bf16 v[88:103], v[204:207], a[88:91], v[88:103]
    ds_read_b64_tr_b16 v[200:201], v214 offset:4608
    ds_read_b64_tr_b16 v[202:203], v214 offset:5760
    s_waitcnt lgkmcnt(10)
    v_mfma_f32_32x32x16_bf16 v[104:119], v[208:211], a[88:91], v[104:119]
    ds_read_b64_tr_b16 v[204:205], v214 offset:4640
    ds_read_b64_tr_b16 v[206:207], v214 offset:5792
    s_waitcnt lgkmcnt(10)
    v_mfma_f32_32x32x16_bf16 v[120:135], v[184:187], a[88:91], v[120:135]
    ds_read_b64_tr_b16 v[208:209], v214 offset:4672
    ds_read_b64_tr_b16 v[210:211], v214 offset:5824
    s_waitcnt lgkmcnt(10)
    v_mfma_f32_32x32x16_bf16 v[136:151], v[188:191], a[88:91], v[136:151]
    ds_read_b64_tr_b16 v[184:185], v214 offset:4704
    ds_read_b64_tr_b16 v[186:187], v214 offset:5856
    s_waitcnt lgkmcnt(10)
    v_mfma_f32_32x32x16_bf16 v[152:167], v[192:195], a[88:91], v[152:167]
    ds_read_b64_tr_b16 v[188:189], v214 offset:4736
    ds_read_b64_tr_b16 v[190:191], v214 offset:5888
    s_waitcnt lgkmcnt(10)
    v_mfma_f32_32x32x16_bf16 v[168:183], v[196:199], a[88:91], v[168:183]
    ds_read_b64_tr_b16 v[192:193], v214 offset:4768
    ds_read_b64_tr_b16 v[194:195], v214 offset:5920
    s_waitcnt lgkmcnt(10)
    v_mfma_f32_32x32x16_bf16 v[40:55], v[200:203], a[92:95], v[40:55]
    ds_read_b64_tr_b16 v[196:197], v214 offset:4800
    ds_read_b64_tr_b16 v[198:199], v214 offset:5952
    s_waitcnt lgkmcnt(10)
    v_mfma_f32_32x32x16_bf16 v[56:71], v[204:207], a[92:95], v[56:71]
    ds_read_b64_tr_b16 v[200:201], v214 offset:4832
    ds_read_b64_tr_b16 v[202:203], v214 offset:5984
    s_waitcnt lgkmcnt(10)
    v_mfma_f32_32x32x16_bf16 v[72:87], v[208:211], a[92:95], v[72:87]
    ds_read_b64_tr_b16 v[204:205], v214 offset:4864
    ds_read_b64_tr_b16 v[206:207], v214 offset:6016
    s_waitcnt lgkmcnt(10)
    v_mfma_f32_32x32x16_bf16 v[88:103], v[184:187], a[92:95], v[88:103]
    s_waitcnt vmcnt(18)
    s_barrier
    v_add_u32 v213, 74240, v212
    ds_read_b64_tr_b16 v[208:209], v213 offset:0
    ds_read_b64_tr_b16 v[210:211], v213 offset:1152
    s_waitcnt lgkmcnt(10)
    v_mfma_f32_32x32x16_bf16 v[104:119], v[188:191], a[92:95], v[104:119]
    ds_read_b64_tr_b16 v[184:185], v213 offset:32
    ds_read_b64_tr_b16 v[186:187], v213 offset:1184
    s_waitcnt lgkmcnt(10)
    v_mfma_f32_32x32x16_bf16 v[120:135], v[192:195], a[92:95], v[120:135]
    ds_read_b64_tr_b16 v[188:189], v213 offset:64
    ds_read_b64_tr_b16 v[190:191], v213 offset:1216
    s_waitcnt lgkmcnt(10)
    v_mfma_f32_32x32x16_bf16 v[136:151], v[196:199], a[92:95], v[136:151]
    ds_read_b64_tr_b16 v[192:193], v213 offset:96
    ds_read_b64_tr_b16 v[194:195], v213 offset:1248
    s_waitcnt lgkmcnt(10)
    v_mfma_f32_32x32x16_bf16 v[152:167], v[200:203], a[92:95], v[152:167]
    ds_read_b64_tr_b16 v[196:197], v213 offset:128
    ds_read_b64_tr_b16 v[198:199], v213 offset:1280
    s_waitcnt lgkmcnt(10)
    v_mfma_f32_32x32x16_bf16 v[168:183], v[204:207], a[92:95], v[168:183]
    ds_read_b64_tr_b16 v[200:201], v213 offset:160
    ds_read_b64_tr_b16 v[202:203], v213 offset:1312
    s_waitcnt lgkmcnt(10)
    v_mfma_f32_32x32x16_bf16 v[40:55], v[208:211], a[96:99], v[40:55]
    ds_read_b64_tr_b16 v[204:205], v213 offset:192
    ds_read_b64_tr_b16 v[206:207], v213 offset:1344
    s_waitcnt lgkmcnt(10)
    v_mfma_f32_32x32x16_bf16 v[56:71], v[184:187], a[96:99], v[56:71]
    ds_read_b64_tr_b16 v[208:209], v213 offset:224
    ds_read_b64_tr_b16 v[210:211], v213 offset:1376
    s_waitcnt lgkmcnt(10)
    v_mfma_f32_32x32x16_bf16 v[72:87], v[188:191], a[96:99], v[72:87]
    ds_read_b64_tr_b16 v[184:185], v213 offset:256
    ds_read_b64_tr_b16 v[186:187], v213 offset:1408
    s_waitcnt lgkmcnt(10)
    v_mfma_f32_32x32x16_bf16 v[88:103], v[192:195], a[96:99], v[88:103]
    ds_read_b64_tr_b16 v[188:189], v213 offset:4608
    ds_read_b64_tr_b16 v[190:191], v213 offset:5760
    s_waitcnt lgkmcnt(10)
    v_mfma_f32_32x32x16_bf16 v[104:119], v[196:199], a[96:99], v[104:119]
    ds_read_b64_tr_b16 v[192:193], v213 offset:4640
    ds_read_b64_tr_b16 v[194:195], v213 offset:5792
    s_waitcnt lgkmcnt(10)
    v_mfma_f32_32x32x16_bf16 v[120:135], v[200:203], a[96:99], v[120:135]
    ds_read_b64_tr_b16 v[196:197], v213 offset:4672
    ds_read_b64_tr_b16 v[198:199], v213 offset:5824
    s_waitcnt lgkmcnt(10)
    v_mfma_f32_32x32x16_bf16 v[136:151], v[204:207], a[96:99], v[136:151]
    ds_read_b64_tr_b16 v[200:201], v213 offset:4704
    ds_read_b64_tr_b16 v[202:203], v213 offset:5856
    s_waitcnt lgkmcnt(10)
    v_mfma_f32_32x32x16_bf16 v[152:167], v[208:211], a[96:99], v[152:167]
    ds_read_b64_tr_b16 v[204:205], v213 offset:4736
    ds_read_b64_tr_b16 v[206:207], v213 offset:5888
    s_waitcnt lgkmcnt(10)
    v_mfma_f32_32x32x16_bf16 v[168:183], v[184:187], a[96:99], v[168:183]
    ds_read_b64_tr_b16 v[208:209], v213 offset:4768
    ds_read_b64_tr_b16 v[210:211], v213 offset:5920
    s_waitcnt lgkmcnt(10)
    v_mfma_f32_32x32x16_bf16 v[40:55], v[188:191], a[100:103], v[40:55]
    ds_read_b64_tr_b16 v[184:185], v213 offset:4800
    ds_read_b64_tr_b16 v[186:187], v213 offset:5952
    s_waitcnt lgkmcnt(10)
    v_mfma_f32_32x32x16_bf16 v[56:71], v[192:195], a[100:103], v[56:71]
    ds_read_b64_tr_b16 v[188:189], v213 offset:4832
    ds_read_b64_tr_b16 v[190:191], v213 offset:5984
    s_waitcnt lgkmcnt(10)
    v_mfma_f32_32x32x16_bf16 v[72:87], v[196:199], a[100:103], v[72:87]
    ds_read_b64_tr_b16 v[192:193], v213 offset:4864
    ds_read_b64_tr_b16 v[194:195], v213 offset:6016
    s_waitcnt lgkmcnt(10)
    v_mfma_f32_32x32x16_bf16 v[88:103], v[200:203], a[100:103], v[88:103]
    s_waitcnt vmcnt(12)
    s_barrier
    v_add_u32 v214, 92800, v212
    ds_read_b64_tr_b16 v[196:197], v214 offset:0
    ds_read_b64_tr_b16 v[198:199], v214 offset:1152
    s_waitcnt lgkmcnt(10)
    v_mfma_f32_32x32x16_bf16 v[104:119], v[204:207], a[100:103], v[104:119]
    ds_read_b64_tr_b16 v[200:201], v214 offset:32
    ds_read_b64_tr_b16 v[202:203], v214 offset:1184
    s_waitcnt lgkmcnt(10)
    v_mfma_f32_32x32x16_bf16 v[120:135], v[208:211], a[100:103], v[120:135]
    ds_read_b64_tr_b16 v[204:205], v214 offset:64
    ds_read_b64_tr_b16 v[206:207], v214 offset:1216
    s_waitcnt lgkmcnt(10)
    v_mfma_f32_32x32x16_bf16 v[136:151], v[184:187], a[100:103], v[136:151]
    ds_read_b64_tr_b16 v[208:209], v214 offset:96
    ds_read_b64_tr_b16 v[210:211], v214 offset:1248
    s_waitcnt lgkmcnt(10)
    v_mfma_f32_32x32x16_bf16 v[152:167], v[188:191], a[100:103], v[152:167]
    ds_read_b64_tr_b16 v[184:185], v214 offset:128
    ds_read_b64_tr_b16 v[186:187], v214 offset:1280
    s_waitcnt lgkmcnt(10)
    v_mfma_f32_32x32x16_bf16 v[168:183], v[192:195], a[100:103], v[168:183]
    ds_read_b64_tr_b16 v[188:189], v214 offset:160
    ds_read_b64_tr_b16 v[190:191], v214 offset:1312
    s_waitcnt lgkmcnt(10)
    v_mfma_f32_32x32x16_bf16 v[40:55], v[196:199], a[104:107], v[40:55]
    ds_read_b64_tr_b16 v[192:193], v214 offset:192
    ds_read_b64_tr_b16 v[194:195], v214 offset:1344
    s_waitcnt lgkmcnt(10)
    v_mfma_f32_32x32x16_bf16 v[56:71], v[200:203], a[104:107], v[56:71]
    ds_read_b64_tr_b16 v[196:197], v214 offset:224
    ds_read_b64_tr_b16 v[198:199], v214 offset:1376
    s_waitcnt lgkmcnt(10)
    v_mfma_f32_32x32x16_bf16 v[72:87], v[204:207], a[104:107], v[72:87]
    ds_read_b64_tr_b16 v[200:201], v214 offset:256
    ds_read_b64_tr_b16 v[202:203], v214 offset:1408
    s_waitcnt lgkmcnt(10)
    v_mfma_f32_32x32x16_bf16 v[88:103], v[208:211], a[104:107], v[88:103]
    ds_read_b64_tr_b16 v[204:205], v214 offset:4608
    ds_read_b64_tr_b16 v[206:207], v214 offset:5760
    s_waitcnt lgkmcnt(10)
    v_mfma_f32_32x32x16_bf16 v[104:119], v[184:187], a[104:107], v[104:119]
    ds_read_b64_tr_b16 v[208:209], v214 offset:4640
    ds_read_b64_tr_b16 v[210:211], v214 offset:5792
    s_waitcnt lgkmcnt(10)
    v_mfma_f32_32x32x16_bf16 v[120:135], v[188:191], a[104:107], v[120:135]
    ds_read_b64_tr_b16 v[184:185], v214 offset:4672
    ds_read_b64_tr_b16 v[186:187], v214 offset:5824
    s_waitcnt lgkmcnt(10)
    v_mfma_f32_32x32x16_bf16 v[136:151], v[192:195], a[104:107], v[136:151]
    ds_read_b64_tr_b16 v[188:189], v214 offset:4704
    ds_read_b64_tr_b16 v[190:191], v214 offset:5856
    s_waitcnt lgkmcnt(10)
    v_mfma_f32_32x32x16_bf16 v[152:167], v[196:199], a[104:107], v[152:167]
    ds_read_b64_tr_b16 v[192:193], v214 offset:4736
    ds_read_b64_tr_b16 v[194:195], v214 offset:5888
    s_waitcnt lgkmcnt(10)
    v_mfma_f32_32x32x16_bf16 v[168:183], v[200:203], a[104:107], v[168:183]
    ds_read_b64_tr_b16 v[196:197], v214 offset:4768
    ds_read_b64_tr_b16 v[198:199], v214 offset:5920
    s_waitcnt lgkmcnt(10)
    v_mfma_f32_32x32x16_bf16 v[40:55], v[204:207], a[108:111], v[40:55]
    ds_read_b64_tr_b16 v[200:201], v214 offset:4800
    ds_read_b64_tr_b16 v[202:203], v214 offset:5952
    s_waitcnt lgkmcnt(10)
    v_mfma_f32_32x32x16_bf16 v[56:71], v[208:211], a[108:111], v[56:71]
    ds_read_b64_tr_b16 v[204:205], v214 offset:4832
    ds_read_b64_tr_b16 v[206:207], v214 offset:5984
    s_waitcnt lgkmcnt(10)
    v_mfma_f32_32x32x16_bf16 v[72:87], v[184:187], a[108:111], v[72:87]
    ds_read_b64_tr_b16 v[208:209], v214 offset:4864
    ds_read_b64_tr_b16 v[210:211], v214 offset:6016
    s_waitcnt lgkmcnt(10)
    v_mfma_f32_32x32x16_bf16 v[88:103], v[188:191], a[108:111], v[88:103]
    s_waitcnt vmcnt(6)
    s_barrier
    v_add_u32 v213, 111360, v212
    ds_read_b64_tr_b16 v[184:185], v213 offset:0
    ds_read_b64_tr_b16 v[186:187], v213 offset:1152
    s_waitcnt lgkmcnt(10)
    v_mfma_f32_32x32x16_bf16 v[104:119], v[192:195], a[108:111], v[104:119]
    ds_read_b64_tr_b16 v[188:189], v213 offset:32
    ds_read_b64_tr_b16 v[190:191], v213 offset:1184
    s_waitcnt lgkmcnt(10)
    v_mfma_f32_32x32x16_bf16 v[120:135], v[196:199], a[108:111], v[120:135]
    ds_read_b64_tr_b16 v[192:193], v213 offset:64
    ds_read_b64_tr_b16 v[194:195], v213 offset:1216
    s_waitcnt lgkmcnt(10)
    v_mfma_f32_32x32x16_bf16 v[136:151], v[200:203], a[108:111], v[136:151]
    ds_read_b64_tr_b16 v[196:197], v213 offset:96
    ds_read_b64_tr_b16 v[198:199], v213 offset:1248
    s_waitcnt lgkmcnt(10)
    v_mfma_f32_32x32x16_bf16 v[152:167], v[204:207], a[108:111], v[152:167]
    ds_read_b64_tr_b16 v[200:201], v213 offset:128
    ds_read_b64_tr_b16 v[202:203], v213 offset:1280
    s_waitcnt lgkmcnt(10)
    v_mfma_f32_32x32x16_bf16 v[168:183], v[208:211], a[108:111], v[168:183]
    ds_read_b64_tr_b16 v[204:205], v213 offset:160
    ds_read_b64_tr_b16 v[206:207], v213 offset:1312
    s_waitcnt lgkmcnt(10)
    v_mfma_f32_32x32x16_bf16 v[40:55], v[184:187], a[112:115], v[40:55]
    ds_read_b64_tr_b16 v[208:209], v213 offset:192
    ds_read_b64_tr_b16 v[210:211], v213 offset:1344
    s_waitcnt lgkmcnt(10)
    v_mfma_f32_32x32x16_bf16 v[56:71], v[188:191], a[112:115], v[56:71]
    ds_read_b64_tr_b16 v[184:185], v213 offset:224
    ds_read_b64_tr_b16 v[186:187], v213 offset:1376
    s_waitcnt lgkmcnt(10)
    v_mfma_f32_32x32x16_bf16 v[72:87], v[192:195], a[112:115], v[72:87]
    ds_read_b64_tr_b16 v[188:189], v213 offset:256
    ds_read_b64_tr_b16 v[190:191], v213 offset:1408
    s_waitcnt lgkmcnt(10)
    v_mfma_f32_32x32x16_bf16 v[88:103], v[196:199], a[112:115], v[88:103]
    ds_read_b64_tr_b16 v[192:193], v213 offset:4608
    ds_read_b64_tr_b16 v[194:195], v213 offset:5760
    s_waitcnt lgkmcnt(10)
    v_mfma_f32_32x32x16_bf16 v[104:119], v[200:203], a[112:115], v[104:119]
    ds_read_b64_tr_b16 v[196:197], v213 offset:4640
    ds_read_b64_tr_b16 v[198:199], v213 offset:5792
    s_waitcnt lgkmcnt(10)
    v_mfma_f32_32x32x16_bf16 v[120:135], v[204:207], a[112:115], v[120:135]
    ds_read_b64_tr_b16 v[200:201], v213 offset:4672
    ds_read_b64_tr_b16 v[202:203], v213 offset:5824
    s_waitcnt lgkmcnt(10)
    v_mfma_f32_32x32x16_bf16 v[136:151], v[208:211], a[112:115], v[136:151]
    ds_read_b64_tr_b16 v[204:205], v213 offset:4704
    ds_read_b64_tr_b16 v[206:207], v213 offset:5856
    s_waitcnt lgkmcnt(10)
    v_mfma_f32_32x32x16_bf16 v[152:167], v[184:187], a[112:115], v[152:167]
    ds_read_b64_tr_b16 v[208:209], v213 offset:4736
    ds_read_b64_tr_b16 v[210:211], v213 offset:5888
    s_waitcnt lgkmcnt(10)
    v_mfma_f32_32x32x16_bf16 v[168:183], v[188:191], a[112:115], v[168:183]
    ds_read_b64_tr_b16 v[184:185], v213 offset:4768
    ds_read_b64_tr_b16 v[186:187], v213 offset:5920
    s_waitcnt lgkmcnt(10)
    v_mfma_f32_32x32x16_bf16 v[40:55], v[192:195], a[116:119], v[40:55]
    ds_read_b64_tr_b16 v[188:189], v213 offset:4800
    ds_read_b64_tr_b16 v[190:191], v213 offset:5952
    s_waitcnt lgkmcnt(10)
    v_mfma_f32_32x32x16_bf16 v[56:71], v[196:199], a[116:119], v[56:71]
    ds_read_b64_tr_b16 v[192:193], v213 offset:4832
    ds_read_b64_tr_b16 v[194:195], v213 offset:5984
    s_waitcnt lgkmcnt(10)
    v_mfma_f32_32x32x16_bf16 v[72:87], v[200:203], a[116:119], v[72:87]
    ds_read_b64_tr_b16 v[196:197], v213 offset:4864
    ds_read_b64_tr_b16 v[198:199], v213 offset:6016
    s_waitcnt lgkmcnt(10)
    v_mfma_f32_32x32x16_bf16 v[88:103], v[204:207], a[116:119], v[88:103]
    s_waitcnt vmcnt(0)
    s_barrier
    v_add_u32 v214, 129920, v212
    ds_read_b64_tr_b16 v[200:201], v214 offset:0
    ds_read_b64_tr_b16 v[202:203], v214 offset:1152
    s_waitcnt lgkmcnt(10)
    v_mfma_f32_32x32x16_bf16 v[104:119], v[208:211], a[116:119], v[104:119]
    ds_read_b64_tr_b16 v[204:205], v214 offset:32
    ds_read_b64_tr_b16 v[206:207], v214 offset:1184
    s_waitcnt lgkmcnt(10)
    v_mfma_f32_32x32x16_bf16 v[120:135], v[184:187], a[116:119], v[120:135]
    ds_read_b64_tr_b16 v[208:209], v214 offset:64
    ds_read_b64_tr_b16 v[210:211], v214 offset:1216
    s_waitcnt lgkmcnt(10)
    v_mfma_f32_32x32x16_bf16 v[136:151], v[188:191], a[116:119], v[136:151]
    ds_read_b64_tr_b16 v[184:185], v214 offset:96
    ds_read_b64_tr_b16 v[186:187], v214 offset:1248
    s_waitcnt lgkmcnt(10)
    v_mfma_f32_32x32x16_bf16 v[152:167], v[192:195], a[116:119], v[152:167]
    ds_read_b64_tr_b16 v[188:189], v214 offset:128
    ds_read_b64_tr_b16 v[190:191], v214 offset:1280
    s_waitcnt lgkmcnt(10)
    v_mfma_f32_32x32x16_bf16 v[168:183], v[196:199], a[116:119], v[168:183]
    ds_read_b64_tr_b16 v[192:193], v214 offset:160
    ds_read_b64_tr_b16 v[194:195], v214 offset:1312
    s_waitcnt lgkmcnt(10)
    v_mfma_f32_32x32x16_bf16 v[40:55], v[200:203], a[120:123], v[40:55]
    ds_read_b64_tr_b16 v[196:197], v214 offset:192
    ds_read_b64_tr_b16 v[198:199], v214 offset:1344
    s_waitcnt lgkmcnt(10)
    v_mfma_f32_32x32x16_bf16 v[56:71], v[204:207], a[120:123], v[56:71]
    ds_read_b64_tr_b16 v[200:201], v214 offset:224
    ds_read_b64_tr_b16 v[202:203], v214 offset:1376
    s_waitcnt lgkmcnt(10)
    v_mfma_f32_32x32x16_bf16 v[72:87], v[208:211], a[120:123], v[72:87]
    ds_read_b64_tr_b16 v[204:205], v214 offset:256
    ds_read_b64_tr_b16 v[206:207], v214 offset:1408
    s_waitcnt lgkmcnt(10)
    v_mfma_f32_32x32x16_bf16 v[88:103], v[184:187], a[120:123], v[88:103]
    ds_read_b64_tr_b16 v[208:209], v214 offset:4608
    ds_read_b64_tr_b16 v[210:211], v214 offset:5760
    s_waitcnt lgkmcnt(10)
    v_mfma_f32_32x32x16_bf16 v[104:119], v[188:191], a[120:123], v[104:119]
    ds_read_b64_tr_b16 v[184:185], v214 offset:4640
    ds_read_b64_tr_b16 v[186:187], v214 offset:5792
    s_waitcnt lgkmcnt(10)
    v_mfma_f32_32x32x16_bf16 v[120:135], v[192:195], a[120:123], v[120:135]
    ds_read_b64_tr_b16 v[188:189], v214 offset:4672
    ds_read_b64_tr_b16 v[190:191], v214 offset:5824
    s_waitcnt lgkmcnt(10)
    v_mfma_f32_32x32x16_bf16 v[136:151], v[196:199], a[120:123], v[136:151]
    ds_read_b64_tr_b16 v[192:193], v214 offset:4704
    ds_read_b64_tr_b16 v[194:195], v214 offset:5856
    s_waitcnt lgkmcnt(10)
    v_mfma_f32_32x32x16_bf16 v[152:167], v[200:203], a[120:123], v[152:167]
    ds_read_b64_tr_b16 v[196:197], v214 offset:4736
    ds_read_b64_tr_b16 v[198:199], v214 offset:5888
    s_waitcnt lgkmcnt(10)
    v_mfma_f32_32x32x16_bf16 v[168:183], v[204:207], a[120:123], v[168:183]
    ds_read_b64_tr_b16 v[200:201], v214 offset:4768
    ds_read_b64_tr_b16 v[202:203], v214 offset:5920
    s_waitcnt lgkmcnt(10)
    v_mfma_f32_32x32x16_bf16 v[40:55], v[208:211], a[124:127], v[40:55]
    ds_read_b64_tr_b16 v[204:205], v214 offset:4800
    ds_read_b64_tr_b16 v[206:207], v214 offset:5952
    s_waitcnt lgkmcnt(10)
    v_mfma_f32_32x32x16_bf16 v[56:71], v[184:187], a[124:127], v[56:71]
    ds_read_b64_tr_b16 v[208:209], v214 offset:4832
    ds_read_b64_tr_b16 v[210:211], v214 offset:5984
    s_waitcnt lgkmcnt(10)
    v_mfma_f32_32x32x16_bf16 v[72:87], v[188:191], a[124:127], v[72:87]
    ds_read_b64_tr_b16 v[184:185], v214 offset:4864
    ds_read_b64_tr_b16 v[186:187], v214 offset:6016
    s_waitcnt lgkmcnt(10)
    v_mfma_f32_32x32x16_bf16 v[88:103], v[192:195], a[124:127], v[88:103]
    s_waitcnt lgkmcnt(8)
    v_mfma_f32_32x32x16_bf16 v[104:119], v[196:199], a[124:127], v[104:119]
    s_waitcnt lgkmcnt(6)
    v_mfma_f32_32x32x16_bf16 v[120:135], v[200:203], a[124:127], v[120:135]
    s_waitcnt lgkmcnt(4)
    v_mfma_f32_32x32x16_bf16 v[136:151], v[204:207], a[124:127], v[136:151]
    s_waitcnt lgkmcnt(2)
    v_mfma_f32_32x32x16_bf16 v[152:167], v[208:211], a[124:127], v[152:167]
    s_waitcnt lgkmcnt(0)
    v_mfma_f32_32x32x16_bf16 v[168:183], v[184:187], a[124:127], v[168:183]
    s_add_u32 s32, s10, 8388608
    s_addc_u32 s33, s11, 0
    s_mov_b32 s34, 5636096
    s_mov_b32 s35, 0x00020000
    s_lshl_b32 s45, s40, 16
    s_mov_b32 s47, 0xbfb8aa3b
    v_cvt_pk_bf16_f32 v224, v40, v41
    v_cvt_pk_bf16_f32 v225, v48, v49
    v_lshlrev_b32 v40, 16, v224
    v_and_b32 v41, 0xffff0000, v224
    v_lshlrev_b32 v48, 16, v225
    v_and_b32 v49, 0xffff0000, v225
    v_mul_f32 v224, s47, v40
    v_mul_f32 v225, s47, v41
    v_exp_f32 v224, v224
    v_exp_f32 v225, v225
    v_add_f32 v224, 1.0, v224
    v_add_f32 v225, 1.0, v225
    v_rcp_f32 v224, v224
    v_rcp_f32 v225, v225
    v_mul_f32 v224, v40, v224
    v_mul_f32 v225, v41, v225
    v_cvt_pk_bf16_f32 v226, v224, v225
    v_lshlrev_b32 v224, 16, v226
    v_and_b32 v225, 0xffff0000, v226
    v_mul_f32 v224, v224, v48
    v_mul_f32 v225, v225, v49
    v_cvt_pk_bf16_f32 v220, v224, v225
    v_cvt_pk_bf16_f32 v224, v42, v43
    v_cvt_pk_bf16_f32 v225, v50, v51
    v_lshlrev_b32 v42, 16, v224
    v_and_b32 v43, 0xffff0000, v224
    v_lshlrev_b32 v50, 16, v225
    v_and_b32 v51, 0xffff0000, v225
    v_mul_f32 v224, s47, v42
    v_mul_f32 v225, s47, v43
    v_exp_f32 v224, v224
    v_exp_f32 v225, v225
    v_add_f32 v224, 1.0, v224
    v_add_f32 v225, 1.0, v225
    v_rcp_f32 v224, v224
    v_rcp_f32 v225, v225
    v_mul_f32 v224, v42, v224
    v_mul_f32 v225, v43, v225
    v_cvt_pk_bf16_f32 v226, v224, v225
    v_lshlrev_b32 v224, 16, v226
    v_and_b32 v225, 0xffff0000, v226
    v_mul_f32 v224, v224, v50
    v_mul_f32 v225, v225, v51
    v_cvt_pk_bf16_f32 v221, v224, v225
    v_cvt_pk_bf16_f32 v224, v44, v45
    v_cvt_pk_bf16_f32 v225, v52, v53
    v_lshlrev_b32 v44, 16, v224
    v_and_b32 v45, 0xffff0000, v224
    v_lshlrev_b32 v52, 16, v225
    v_and_b32 v53, 0xffff0000, v225
    v_mul_f32 v224, s47, v44
    v_mul_f32 v225, s47, v45
    v_exp_f32 v224, v224
    v_exp_f32 v225, v225
    v_add_f32 v224, 1.0, v224
    v_add_f32 v225, 1.0, v225
    v_rcp_f32 v224, v224
    v_rcp_f32 v225, v225
    v_mul_f32 v224, v44, v224
    v_mul_f32 v225, v45, v225
    v_cvt_pk_bf16_f32 v226, v224, v225
    v_lshlrev_b32 v224, 16, v226
    v_and_b32 v225, 0xffff0000, v226
    v_mul_f32 v224, v224, v52
    v_mul_f32 v225, v225, v53
    v_cvt_pk_bf16_f32 v222, v224, v225
    v_cvt_pk_bf16_f32 v224, v46, v47
    v_cvt_pk_bf16_f32 v225, v54, v55
    v_lshlrev_b32 v46, 16, v224
    v_and_b32 v47, 0xffff0000, v224
    v_lshlrev_b32 v54, 16, v225
    v_and_b32 v55, 0xffff0000, v225
    v_mul_f32 v224, s47, v46
    v_mul_f32 v225, s47, v47
    v_exp_f32 v224, v224
    v_exp_f32 v225, v225
    v_add_f32 v224, 1.0, v224
    v_add_f32 v225, 1.0, v225
    v_rcp_f32 v224, v224
    v_rcp_f32 v225, v225
    v_mul_f32 v224, v46, v224
    v_mul_f32 v225, v47, v225
    v_cvt_pk_bf16_f32 v226, v224, v225
    v_lshlrev_b32 v224, 16, v226
    v_and_b32 v225, 0xffff0000, v226
    v_mul_f32 v224, v224, v54
    v_mul_f32 v225, v225, v55
    v_cvt_pk_bf16_f32 v223, v224, v225
    s_add_u32 s46, s45, 0
    buffer_store_dwordx4 v[220:223], v5, s[32:35], s46 offen
    v_cvt_pk_bf16_f32 v224, v56, v57
    v_cvt_pk_bf16_f32 v225, v64, v65
    v_lshlrev_b32 v56, 16, v224
    v_and_b32 v57, 0xffff0000, v224
    v_lshlrev_b32 v64, 16, v225
    v_and_b32 v65, 0xffff0000, v225
    v_mul_f32 v224, s47, v56
    v_mul_f32 v225, s47, v57
    v_exp_f32 v224, v224
    v_exp_f32 v225, v225
    v_add_f32 v224, 1.0, v224
    v_add_f32 v225, 1.0, v225
    v_rcp_f32 v224, v224
    v_rcp_f32 v225, v225
    v_mul_f32 v224, v56, v224
    v_mul_f32 v225, v57, v225
    v_cvt_pk_bf16_f32 v226, v224, v225
    v_lshlrev_b32 v224, 16, v226
    v_and_b32 v225, 0xffff0000, v226
    v_mul_f32 v224, v224, v64
    v_mul_f32 v225, v225, v65
    v_cvt_pk_bf16_f32 v220, v224, v225
    v_cvt_pk_bf16_f32 v224, v58, v59
    v_cvt_pk_bf16_f32 v225, v66, v67
    v_lshlrev_b32 v58, 16, v224
    v_and_b32 v59, 0xffff0000, v224
    v_lshlrev_b32 v66, 16, v225
    v_and_b32 v67, 0xffff0000, v225
    v_mul_f32 v224, s47, v58
    v_mul_f32 v225, s47, v59
    v_exp_f32 v224, v224
    v_exp_f32 v225, v225
    v_add_f32 v224, 1.0, v224
    v_add_f32 v225, 1.0, v225
    v_rcp_f32 v224, v224
    v_rcp_f32 v225, v225
    v_mul_f32 v224, v58, v224
    v_mul_f32 v225, v59, v225
    v_cvt_pk_bf16_f32 v226, v224, v225
    v_lshlrev_b32 v224, 16, v226
    v_and_b32 v225, 0xffff0000, v226
    v_mul_f32 v224, v224, v66
    v_mul_f32 v225, v225, v67
    v_cvt_pk_bf16_f32 v221, v224, v225
    v_cvt_pk_bf16_f32 v224, v60, v61
    v_cvt_pk_bf16_f32 v225, v68, v69
    v_lshlrev_b32 v60, 16, v224
    v_and_b32 v61, 0xffff0000, v224
    v_lshlrev_b32 v68, 16, v225
    v_and_b32 v69, 0xffff0000, v225
    v_mul_f32 v224, s47, v60
    v_mul_f32 v225, s47, v61
    v_exp_f32 v224, v224
    v_exp_f32 v225, v225
    v_add_f32 v224, 1.0, v224
    v_add_f32 v225, 1.0, v225
    v_rcp_f32 v224, v224
    v_rcp_f32 v225, v225
    v_mul_f32 v224, v60, v224
    v_mul_f32 v225, v61, v225
    v_cvt_pk_bf16_f32 v226, v224, v225
    v_lshlrev_b32 v224, 16, v226
    v_and_b32 v225, 0xffff0000, v226
    v_mul_f32 v224, v224, v68
    v_mul_f32 v225, v225, v69
    v_cvt_pk_bf16_f32 v222, v224, v225
    v_cvt_pk_bf16_f32 v224, v62, v63
    v_cvt_pk_bf16_f32 v225, v70, v71
    v_lshlrev_b32 v62, 16, v224
    v_and_b32 v63, 0xffff0000, v224
    v_lshlrev_b32 v70, 16, v225
    v_and_b32 v71, 0xffff0000, v225
    v_mul_f32 v224, s47, v62
    v_mul_f32 v225, s47, v63
    v_exp_f32 v224, v224
    v_exp_f32 v225, v225
    v_add_f32 v224, 1.0, v224
    v_add_f32 v225, 1.0, v225
    v_rcp_f32 v224, v224
    v_rcp_f32 v225, v225
    v_mul_f32 v224, v62, v224
    v_mul_f32 v225, v63, v225
    v_cvt_pk_bf16_f32 v226, v224, v225
    v_lshlrev_b32 v224, 16, v226
    v_and_b32 v225, 0xffff0000, v226
    v_mul_f32 v224, v224, v70
    v_mul_f32 v225, v225, v71
    v_cvt_pk_bf16_f32 v223, v224, v225
    s_add_u32 s46, s45, 65536
    buffer_store_dwordx4 v[220:223], v5, s[32:35], s46 offen
    v_cvt_pk_bf16_f32 v224, v72, v73
    v_cvt_pk_bf16_f32 v225, v80, v81
    v_lshlrev_b32 v72, 16, v224
    v_and_b32 v73, 0xffff0000, v224
    v_lshlrev_b32 v80, 16, v225
    v_and_b32 v81, 0xffff0000, v225
    v_mul_f32 v224, s47, v72
    v_mul_f32 v225, s47, v73
    v_exp_f32 v224, v224
    v_exp_f32 v225, v225
    v_add_f32 v224, 1.0, v224
    v_add_f32 v225, 1.0, v225
    v_rcp_f32 v224, v224
    v_rcp_f32 v225, v225
    v_mul_f32 v224, v72, v224
    v_mul_f32 v225, v73, v225
    v_cvt_pk_bf16_f32 v226, v224, v225
    v_lshlrev_b32 v224, 16, v226
    v_and_b32 v225, 0xffff0000, v226
    v_mul_f32 v224, v224, v80
    v_mul_f32 v225, v225, v81
    v_cvt_pk_bf16_f32 v220, v224, v225
    v_cvt_pk_bf16_f32 v224, v74, v75
    v_cvt_pk_bf16_f32 v225, v82, v83
    v_lshlrev_b32 v74, 16, v224
    v_and_b32 v75, 0xffff0000, v224
    v_lshlrev_b32 v82, 16, v225
    v_and_b32 v83, 0xffff0000, v225
    v_mul_f32 v224, s47, v74
    v_mul_f32 v225, s47, v75
    v_exp_f32 v224, v224
    v_exp_f32 v225, v225
    v_add_f32 v224, 1.0, v224
    v_add_f32 v225, 1.0, v225
    v_rcp_f32 v224, v224
    v_rcp_f32 v225, v225
    v_mul_f32 v224, v74, v224
    v_mul_f32 v225, v75, v225
    v_cvt_pk_bf16_f32 v226, v224, v225
    v_lshlrev_b32 v224, 16, v226
    v_and_b32 v225, 0xffff0000, v226
    v_mul_f32 v224, v224, v82
    v_mul_f32 v225, v225, v83
    v_cvt_pk_bf16_f32 v221, v224, v225
    v_cvt_pk_bf16_f32 v224, v76, v77
    v_cvt_pk_bf16_f32 v225, v84, v85
    v_lshlrev_b32 v76, 16, v224
    v_and_b32 v77, 0xffff0000, v224
    v_lshlrev_b32 v84, 16, v225
    v_and_b32 v85, 0xffff0000, v225
    v_mul_f32 v224, s47, v76
    v_mul_f32 v225, s47, v77
    v_exp_f32 v224, v224
    v_exp_f32 v225, v225
    v_add_f32 v224, 1.0, v224
    v_add_f32 v225, 1.0, v225
    v_rcp_f32 v224, v224
    v_rcp_f32 v225, v225
    v_mul_f32 v224, v76, v224
    v_mul_f32 v225, v77, v225
    v_cvt_pk_bf16_f32 v226, v224, v225
    v_lshlrev_b32 v224, 16, v226
    v_and_b32 v225, 0xffff0000, v226
    v_mul_f32 v224, v224, v84
    v_mul_f32 v225, v225, v85
    v_cvt_pk_bf16_f32 v222, v224, v225
    v_cvt_pk_bf16_f32 v224, v78, v79
    v_cvt_pk_bf16_f32 v225, v86, v87
    v_lshlrev_b32 v78, 16, v224
    v_and_b32 v79, 0xffff0000, v224
    v_lshlrev_b32 v86, 16, v225
    v_and_b32 v87, 0xffff0000, v225
    v_mul_f32 v224, s47, v78
    v_mul_f32 v225, s47, v79
    v_exp_f32 v224, v224
    v_exp_f32 v225, v225
    v_add_f32 v224, 1.0, v224
    v_add_f32 v225, 1.0, v225
    v_rcp_f32 v224, v224
    v_rcp_f32 v225, v225
    v_mul_f32 v224, v78, v224
    v_mul_f32 v225, v79, v225
    v_cvt_pk_bf16_f32 v226, v224, v225
    v_lshlrev_b32 v224, 16, v226
    v_and_b32 v225, 0xffff0000, v226
    v_mul_f32 v224, v224, v86
    v_mul_f32 v225, v225, v87
    v_cvt_pk_bf16_f32 v223, v224, v225
    s_add_u32 s46, s45, 131072
    buffer_store_dwordx4 v[220:223], v5, s[32:35], s46 offen
    v_cvt_pk_bf16_f32 v224, v88, v89
    v_cvt_pk_bf16_f32 v225, v96, v97
    v_lshlrev_b32 v88, 16, v224
    v_and_b32 v89, 0xffff0000, v224
    v_lshlrev_b32 v96, 16, v225
    v_and_b32 v97, 0xffff0000, v225
    v_mul_f32 v224, s47, v88
    v_mul_f32 v225, s47, v89
    v_exp_f32 v224, v224
    v_exp_f32 v225, v225
    v_add_f32 v224, 1.0, v224
    v_add_f32 v225, 1.0, v225
    v_rcp_f32 v224, v224
    v_rcp_f32 v225, v225
    v_mul_f32 v224, v88, v224
    v_mul_f32 v225, v89, v225
    v_cvt_pk_bf16_f32 v226, v224, v225
    v_lshlrev_b32 v224, 16, v226
    v_and_b32 v225, 0xffff0000, v226
    v_mul_f32 v224, v224, v96
    v_mul_f32 v225, v225, v97
    v_cvt_pk_bf16_f32 v220, v224, v225
    v_cvt_pk_bf16_f32 v224, v90, v91
    v_cvt_pk_bf16_f32 v225, v98, v99
    v_lshlrev_b32 v90, 16, v224
    v_and_b32 v91, 0xffff0000, v224
    v_lshlrev_b32 v98, 16, v225
    v_and_b32 v99, 0xffff0000, v225
    v_mul_f32 v224, s47, v90
    v_mul_f32 v225, s47, v91
    v_exp_f32 v224, v224
    v_exp_f32 v225, v225
    v_add_f32 v224, 1.0, v224
    v_add_f32 v225, 1.0, v225
    v_rcp_f32 v224, v224
    v_rcp_f32 v225, v225
    v_mul_f32 v224, v90, v224
    v_mul_f32 v225, v91, v225
    v_cvt_pk_bf16_f32 v226, v224, v225
    v_lshlrev_b32 v224, 16, v226
    v_and_b32 v225, 0xffff0000, v226
    v_mul_f32 v224, v224, v98
    v_mul_f32 v225, v225, v99
    v_cvt_pk_bf16_f32 v221, v224, v225
    v_cvt_pk_bf16_f32 v224, v92, v93
    v_cvt_pk_bf16_f32 v225, v100, v101
    v_lshlrev_b32 v92, 16, v224
    v_and_b32 v93, 0xffff0000, v224
    v_lshlrev_b32 v100, 16, v225
    v_and_b32 v101, 0xffff0000, v225
    v_mul_f32 v224, s47, v92
    v_mul_f32 v225, s47, v93
    v_exp_f32 v224, v224
    v_exp_f32 v225, v225
    v_add_f32 v224, 1.0, v224
    v_add_f32 v225, 1.0, v225
    v_rcp_f32 v224, v224
    v_rcp_f32 v225, v225
    v_mul_f32 v224, v92, v224
    v_mul_f32 v225, v93, v225
    v_cvt_pk_bf16_f32 v226, v224, v225
    v_lshlrev_b32 v224, 16, v226
    v_and_b32 v225, 0xffff0000, v226
    v_mul_f32 v224, v224, v100
    v_mul_f32 v225, v225, v101
    v_cvt_pk_bf16_f32 v222, v224, v225
    v_cvt_pk_bf16_f32 v224, v94, v95
    v_cvt_pk_bf16_f32 v225, v102, v103
    v_lshlrev_b32 v94, 16, v224
    v_and_b32 v95, 0xffff0000, v224
    v_lshlrev_b32 v102, 16, v225
    v_and_b32 v103, 0xffff0000, v225
    v_mul_f32 v224, s47, v94
    v_mul_f32 v225, s47, v95
    v_exp_f32 v224, v224
    v_exp_f32 v225, v225
    v_add_f32 v224, 1.0, v224
    v_add_f32 v225, 1.0, v225
    v_rcp_f32 v224, v224
    v_rcp_f32 v225, v225
    v_mul_f32 v224, v94, v224
    v_mul_f32 v225, v95, v225
    v_cvt_pk_bf16_f32 v226, v224, v225
    v_lshlrev_b32 v224, 16, v226
    v_and_b32 v225, 0xffff0000, v226
    v_mul_f32 v224, v224, v102
    v_mul_f32 v225, v225, v103
    v_cvt_pk_bf16_f32 v223, v224, v225
    s_add_u32 s46, s45, 196608
    buffer_store_dwordx4 v[220:223], v5, s[32:35], s46 offen
    v_cvt_pk_bf16_f32 v224, v104, v105
    v_cvt_pk_bf16_f32 v225, v112, v113
    v_lshlrev_b32 v104, 16, v224
    v_and_b32 v105, 0xffff0000, v224
    v_lshlrev_b32 v112, 16, v225
    v_and_b32 v113, 0xffff0000, v225
    v_mul_f32 v224, s47, v104
    v_mul_f32 v225, s47, v105
    v_exp_f32 v224, v224
    v_exp_f32 v225, v225
    v_add_f32 v224, 1.0, v224
    v_add_f32 v225, 1.0, v225
    v_rcp_f32 v224, v224
    v_rcp_f32 v225, v225
    v_mul_f32 v224, v104, v224
    v_mul_f32 v225, v105, v225
    v_cvt_pk_bf16_f32 v226, v224, v225
    v_lshlrev_b32 v224, 16, v226
    v_and_b32 v225, 0xffff0000, v226
    v_mul_f32 v224, v224, v112
    v_mul_f32 v225, v225, v113
    v_cvt_pk_bf16_f32 v220, v224, v225
    v_cvt_pk_bf16_f32 v224, v106, v107
    v_cvt_pk_bf16_f32 v225, v114, v115
    v_lshlrev_b32 v106, 16, v224
    v_and_b32 v107, 0xffff0000, v224
    v_lshlrev_b32 v114, 16, v225
    v_and_b32 v115, 0xffff0000, v225
    v_mul_f32 v224, s47, v106
    v_mul_f32 v225, s47, v107
    v_exp_f32 v224, v224
    v_exp_f32 v225, v225
    v_add_f32 v224, 1.0, v224
    v_add_f32 v225, 1.0, v225
    v_rcp_f32 v224, v224
    v_rcp_f32 v225, v225
    v_mul_f32 v224, v106, v224
    v_mul_f32 v225, v107, v225
    v_cvt_pk_bf16_f32 v226, v224, v225
    v_lshlrev_b32 v224, 16, v226
    v_and_b32 v225, 0xffff0000, v226
    v_mul_f32 v224, v224, v114
    v_mul_f32 v225, v225, v115
    v_cvt_pk_bf16_f32 v221, v224, v225
    v_cvt_pk_bf16_f32 v224, v108, v109
    v_cvt_pk_bf16_f32 v225, v116, v117
    v_lshlrev_b32 v108, 16, v224
    v_and_b32 v109, 0xffff0000, v224
    v_lshlrev_b32 v116, 16, v225
    v_and_b32 v117, 0xffff0000, v225
    v_mul_f32 v224, s47, v108
    v_mul_f32 v225, s47, v109
    v_exp_f32 v224, v224
    v_exp_f32 v225, v225
    v_add_f32 v224, 1.0, v224
    v_add_f32 v225, 1.0, v225
    v_rcp_f32 v224, v224
    v_rcp_f32 v225, v225
    v_mul_f32 v224, v108, v224
    v_mul_f32 v225, v109, v225
    v_cvt_pk_bf16_f32 v226, v224, v225
    v_lshlrev_b32 v224, 16, v226
    v_and_b32 v225, 0xffff0000, v226
    v_mul_f32 v224, v224, v116
    v_mul_f32 v225, v225, v117
    v_cvt_pk_bf16_f32 v222, v224, v225
    v_cvt_pk_bf16_f32 v224, v110, v111
    v_cvt_pk_bf16_f32 v225, v118, v119
    v_lshlrev_b32 v110, 16, v224
    v_and_b32 v111, 0xffff0000, v224
    v_lshlrev_b32 v118, 16, v225
    v_and_b32 v119, 0xffff0000, v225
    v_mul_f32 v224, s47, v110
    v_mul_f32 v225, s47, v111
    v_exp_f32 v224, v224
    v_exp_f32 v225, v225
    v_add_f32 v224, 1.0, v224
    v_add_f32 v225, 1.0, v225
    v_rcp_f32 v224, v224
    v_rcp_f32 v225, v225
    v_mul_f32 v224, v110, v224
    v_mul_f32 v225, v111, v225
    v_cvt_pk_bf16_f32 v226, v224, v225
    v_lshlrev_b32 v224, 16, v226
    v_and_b32 v225, 0xffff0000, v226
    v_mul_f32 v224, v224, v118
    v_mul_f32 v225, v225, v119
    v_cvt_pk_bf16_f32 v223, v224, v225
    s_add_u32 s46, s45, 262144
    buffer_store_dwordx4 v[220:223], v5, s[32:35], s46 offen
    v_cvt_pk_bf16_f32 v224, v120, v121
    v_cvt_pk_bf16_f32 v225, v128, v129
    v_lshlrev_b32 v120, 16, v224
    v_and_b32 v121, 0xffff0000, v224
    v_lshlrev_b32 v128, 16, v225
    v_and_b32 v129, 0xffff0000, v225
    v_mul_f32 v224, s47, v120
    v_mul_f32 v225, s47, v121
    v_exp_f32 v224, v224
    v_exp_f32 v225, v225
    v_add_f32 v224, 1.0, v224
    v_add_f32 v225, 1.0, v225
    v_rcp_f32 v224, v224
    v_rcp_f32 v225, v225
    v_mul_f32 v224, v120, v224
    v_mul_f32 v225, v121, v225
    v_cvt_pk_bf16_f32 v226, v224, v225
    v_lshlrev_b32 v224, 16, v226
    v_and_b32 v225, 0xffff0000, v226
    v_mul_f32 v224, v224, v128
    v_mul_f32 v225, v225, v129
    v_cvt_pk_bf16_f32 v220, v224, v225
    v_cvt_pk_bf16_f32 v224, v122, v123
    v_cvt_pk_bf16_f32 v225, v130, v131
    v_lshlrev_b32 v122, 16, v224
    v_and_b32 v123, 0xffff0000, v224
    v_lshlrev_b32 v130, 16, v225
    v_and_b32 v131, 0xffff0000, v225
    v_mul_f32 v224, s47, v122
    v_mul_f32 v225, s47, v123
    v_exp_f32 v224, v224
    v_exp_f32 v225, v225
    v_add_f32 v224, 1.0, v224
    v_add_f32 v225, 1.0, v225
    v_rcp_f32 v224, v224
    v_rcp_f32 v225, v225
    v_mul_f32 v224, v122, v224
    v_mul_f32 v225, v123, v225
    v_cvt_pk_bf16_f32 v226, v224, v225
    v_lshlrev_b32 v224, 16, v226
    v_and_b32 v225, 0xffff0000, v226
    v_mul_f32 v224, v224, v130
    v_mul_f32 v225, v225, v131
    v_cvt_pk_bf16_f32 v221, v224, v225
    v_cvt_pk_bf16_f32 v224, v124, v125
    v_cvt_pk_bf16_f32 v225, v132, v133
    v_lshlrev_b32 v124, 16, v224
    v_and_b32 v125, 0xffff0000, v224
    v_lshlrev_b32 v132, 16, v225
    v_and_b32 v133, 0xffff0000, v225
    v_mul_f32 v224, s47, v124
    v_mul_f32 v225, s47, v125
    v_exp_f32 v224, v224
    v_exp_f32 v225, v225
    v_add_f32 v224, 1.0, v224
    v_add_f32 v225, 1.0, v225
    v_rcp_f32 v224, v224
    v_rcp_f32 v225, v225
    v_mul_f32 v224, v124, v224
    v_mul_f32 v225, v125, v225
    v_cvt_pk_bf16_f32 v226, v224, v225
    v_lshlrev_b32 v224, 16, v226
    v_and_b32 v225, 0xffff0000, v226
    v_mul_f32 v224, v224, v132
    v_mul_f32 v225, v225, v133
    v_cvt_pk_bf16_f32 v222, v224, v225
    v_cvt_pk_bf16_f32 v224, v126, v127
    v_cvt_pk_bf16_f32 v225, v134, v135
    v_lshlrev_b32 v126, 16, v224
    v_and_b32 v127, 0xffff0000, v224
    v_lshlrev_b32 v134, 16, v225
    v_and_b32 v135, 0xffff0000, v225
    v_mul_f32 v224, s47, v126
    v_mul_f32 v225, s47, v127
    v_exp_f32 v224, v224
    v_exp_f32 v225, v225
    v_add_f32 v224, 1.0, v224
    v_add_f32 v225, 1.0, v225
    v_rcp_f32 v224, v224
    v_rcp_f32 v225, v225
    v_mul_f32 v224, v126, v224
    v_mul_f32 v225, v127, v225
    v_cvt_pk_bf16_f32 v226, v224, v225
    v_lshlrev_b32 v224, 16, v226
    v_and_b32 v225, 0xffff0000, v226
    v_mul_f32 v224, v224, v134
    v_mul_f32 v225, v225, v135
    v_cvt_pk_bf16_f32 v223, v224, v225
    s_add_u32 s46, s45, 327680
    buffer_store_dwordx4 v[220:223], v5, s[32:35], s46 offen
    v_cvt_pk_bf16_f32 v224, v136, v137
    v_cvt_pk_bf16_f32 v225, v144, v145
    v_lshlrev_b32 v136, 16, v224
    v_and_b32 v137, 0xffff0000, v224
    v_lshlrev_b32 v144, 16, v225
    v_and_b32 v145, 0xffff0000, v225
    v_mul_f32 v224, s47, v136
    v_mul_f32 v225, s47, v137
    v_exp_f32 v224, v224
    v_exp_f32 v225, v225
    v_add_f32 v224, 1.0, v224
    v_add_f32 v225, 1.0, v225
    v_rcp_f32 v224, v224
    v_rcp_f32 v225, v225
    v_mul_f32 v224, v136, v224
    v_mul_f32 v225, v137, v225
    v_cvt_pk_bf16_f32 v226, v224, v225
    v_lshlrev_b32 v224, 16, v226
    v_and_b32 v225, 0xffff0000, v226
    v_mul_f32 v224, v224, v144
    v_mul_f32 v225, v225, v145
    v_cvt_pk_bf16_f32 v220, v224, v225
    v_cvt_pk_bf16_f32 v224, v138, v139
    v_cvt_pk_bf16_f32 v225, v146, v147
    v_lshlrev_b32 v138, 16, v224
    v_and_b32 v139, 0xffff0000, v224
    v_lshlrev_b32 v146, 16, v225
    v_and_b32 v147, 0xffff0000, v225
    v_mul_f32 v224, s47, v138
    v_mul_f32 v225, s47, v139
    v_exp_f32 v224, v224
    v_exp_f32 v225, v225
    v_add_f32 v224, 1.0, v224
    v_add_f32 v225, 1.0, v225
    v_rcp_f32 v224, v224
    v_rcp_f32 v225, v225
    v_mul_f32 v224, v138, v224
    v_mul_f32 v225, v139, v225
    v_cvt_pk_bf16_f32 v226, v224, v225
    v_lshlrev_b32 v224, 16, v226
    v_and_b32 v225, 0xffff0000, v226
    v_mul_f32 v224, v224, v146
    v_mul_f32 v225, v225, v147
    v_cvt_pk_bf16_f32 v221, v224, v225
    v_cvt_pk_bf16_f32 v224, v140, v141
    v_cvt_pk_bf16_f32 v225, v148, v149
    v_lshlrev_b32 v140, 16, v224
    v_and_b32 v141, 0xffff0000, v224
    v_lshlrev_b32 v148, 16, v225
    v_and_b32 v149, 0xffff0000, v225
    v_mul_f32 v224, s47, v140
    v_mul_f32 v225, s47, v141
    v_exp_f32 v224, v224
    v_exp_f32 v225, v225
    v_add_f32 v224, 1.0, v224
    v_add_f32 v225, 1.0, v225
    v_rcp_f32 v224, v224
    v_rcp_f32 v225, v225
    v_mul_f32 v224, v140, v224
    v_mul_f32 v225, v141, v225
    v_cvt_pk_bf16_f32 v226, v224, v225
    v_lshlrev_b32 v224, 16, v226
    v_and_b32 v225, 0xffff0000, v226
    v_mul_f32 v224, v224, v148
    v_mul_f32 v225, v225, v149
    v_cvt_pk_bf16_f32 v222, v224, v225
    v_cvt_pk_bf16_f32 v224, v142, v143
    v_cvt_pk_bf16_f32 v225, v150, v151
    v_lshlrev_b32 v142, 16, v224
    v_and_b32 v143, 0xffff0000, v224
    v_lshlrev_b32 v150, 16, v225
    v_and_b32 v151, 0xffff0000, v225
    v_mul_f32 v224, s47, v142
    v_mul_f32 v225, s47, v143
    v_exp_f32 v224, v224
    v_exp_f32 v225, v225
    v_add_f32 v224, 1.0, v224
    v_add_f32 v225, 1.0, v225
    v_rcp_f32 v224, v224
    v_rcp_f32 v225, v225
    v_mul_f32 v224, v142, v224
    v_mul_f32 v225, v143, v225
    v_cvt_pk_bf16_f32 v226, v224, v225
    v_lshlrev_b32 v224, 16, v226
    v_and_b32 v225, 0xffff0000, v226
    v_mul_f32 v224, v224, v150
    v_mul_f32 v225, v225, v151
    v_cvt_pk_bf16_f32 v223, v224, v225
    s_add_u32 s46, s45, 393216
    buffer_store_dwordx4 v[220:223], v5, s[32:35], s46 offen
    v_cvt_pk_bf16_f32 v224, v152, v153
    v_cvt_pk_bf16_f32 v225, v160, v161
    v_lshlrev_b32 v152, 16, v224
    v_and_b32 v153, 0xffff0000, v224
    v_lshlrev_b32 v160, 16, v225
    v_and_b32 v161, 0xffff0000, v225
    v_mul_f32 v224, s47, v152
    v_mul_f32 v225, s47, v153
    v_exp_f32 v224, v224
    v_exp_f32 v225, v225
    v_add_f32 v224, 1.0, v224
    v_add_f32 v225, 1.0, v225
    v_rcp_f32 v224, v224
    v_rcp_f32 v225, v225
    v_mul_f32 v224, v152, v224
    v_mul_f32 v225, v153, v225
    v_cvt_pk_bf16_f32 v226, v224, v225
    v_lshlrev_b32 v224, 16, v226
    v_and_b32 v225, 0xffff0000, v226
    v_mul_f32 v224, v224, v160
    v_mul_f32 v225, v225, v161
    v_cvt_pk_bf16_f32 v220, v224, v225
    v_cvt_pk_bf16_f32 v224, v154, v155
    v_cvt_pk_bf16_f32 v225, v162, v163
    v_lshlrev_b32 v154, 16, v224
    v_and_b32 v155, 0xffff0000, v224
    v_lshlrev_b32 v162, 16, v225
    v_and_b32 v163, 0xffff0000, v225
    v_mul_f32 v224, s47, v154
    v_mul_f32 v225, s47, v155
    v_exp_f32 v224, v224
    v_exp_f32 v225, v225
    v_add_f32 v224, 1.0, v224
    v_add_f32 v225, 1.0, v225
    v_rcp_f32 v224, v224
    v_rcp_f32 v225, v225
    v_mul_f32 v224, v154, v224
    v_mul_f32 v225, v155, v225
    v_cvt_pk_bf16_f32 v226, v224, v225
    v_lshlrev_b32 v224, 16, v226
    v_and_b32 v225, 0xffff0000, v226
    v_mul_f32 v224, v224, v162
    v_mul_f32 v225, v225, v163
    v_cvt_pk_bf16_f32 v221, v224, v225
    v_cvt_pk_bf16_f32 v224, v156, v157
    v_cvt_pk_bf16_f32 v225, v164, v165
    v_lshlrev_b32 v156, 16, v224
    v_and_b32 v157, 0xffff0000, v224
    v_lshlrev_b32 v164, 16, v225
    v_and_b32 v165, 0xffff0000, v225
    v_mul_f32 v224, s47, v156
    v_mul_f32 v225, s47, v157
    v_exp_f32 v224, v224
    v_exp_f32 v225, v225
    v_add_f32 v224, 1.0, v224
    v_add_f32 v225, 1.0, v225
    v_rcp_f32 v224, v224
    v_rcp_f32 v225, v225
    v_mul_f32 v224, v156, v224
    v_mul_f32 v225, v157, v225
    v_cvt_pk_bf16_f32 v226, v224, v225
    v_lshlrev_b32 v224, 16, v226
    v_and_b32 v225, 0xffff0000, v226
    v_mul_f32 v224, v224, v164
    v_mul_f32 v225, v225, v165
    v_cvt_pk_bf16_f32 v222, v224, v225
    v_cvt_pk_bf16_f32 v224, v158, v159
    v_cvt_pk_bf16_f32 v225, v166, v167
    v_lshlrev_b32 v158, 16, v224
    v_and_b32 v159, 0xffff0000, v224
    v_lshlrev_b32 v166, 16, v225
    v_and_b32 v167, 0xffff0000, v225
    v_mul_f32 v224, s47, v158
    v_mul_f32 v225, s47, v159
    v_exp_f32 v224, v224
    v_exp_f32 v225, v225
    v_add_f32 v224, 1.0, v224
    v_add_f32 v225, 1.0, v225
    v_rcp_f32 v224, v224
    v_rcp_f32 v225, v225
    v_mul_f32 v224, v158, v224
    v_mul_f32 v225, v159, v225
    v_cvt_pk_bf16_f32 v226, v224, v225
    v_lshlrev_b32 v224, 16, v226
    v_and_b32 v225, 0xffff0000, v226
    v_mul_f32 v224, v224, v166
    v_mul_f32 v225, v225, v167
    v_cvt_pk_bf16_f32 v223, v224, v225
    s_add_u32 s46, s45, 458752
    buffer_store_dwordx4 v[220:223], v5, s[32:35], s46 offen
    v_cvt_pk_bf16_f32 v224, v168, v169
    v_cvt_pk_bf16_f32 v225, v176, v177
    v_lshlrev_b32 v168, 16, v224
    v_and_b32 v169, 0xffff0000, v224
    v_lshlrev_b32 v176, 16, v225
    v_and_b32 v177, 0xffff0000, v225
    v_mul_f32 v224, s47, v168
    v_mul_f32 v225, s47, v169
    v_exp_f32 v224, v224
    v_exp_f32 v225, v225
    v_add_f32 v224, 1.0, v224
    v_add_f32 v225, 1.0, v225
    v_rcp_f32 v224, v224
    v_rcp_f32 v225, v225
    v_mul_f32 v224, v168, v224
    v_mul_f32 v225, v169, v225
    v_cvt_pk_bf16_f32 v226, v224, v225
    v_lshlrev_b32 v224, 16, v226
    v_and_b32 v225, 0xffff0000, v226
    v_mul_f32 v224, v224, v176
    v_mul_f32 v225, v225, v177
    v_cvt_pk_bf16_f32 v220, v224, v225
    v_cvt_pk_bf16_f32 v224, v170, v171
    v_cvt_pk_bf16_f32 v225, v178, v179
    v_lshlrev_b32 v170, 16, v224
    v_and_b32 v171, 0xffff0000, v224
    v_lshlrev_b32 v178, 16, v225
    v_and_b32 v179, 0xffff0000, v225
    v_mul_f32 v224, s47, v170
    v_mul_f32 v225, s47, v171
    v_exp_f32 v224, v224
    v_exp_f32 v225, v225
    v_add_f32 v224, 1.0, v224
    v_add_f32 v225, 1.0, v225
    v_rcp_f32 v224, v224
    v_rcp_f32 v225, v225
    v_mul_f32 v224, v170, v224
    v_mul_f32 v225, v171, v225
    v_cvt_pk_bf16_f32 v226, v224, v225
    v_lshlrev_b32 v224, 16, v226
    v_and_b32 v225, 0xffff0000, v226
    v_mul_f32 v224, v224, v178
    v_mul_f32 v225, v225, v179
    v_cvt_pk_bf16_f32 v221, v224, v225
    v_cvt_pk_bf16_f32 v224, v172, v173
    v_cvt_pk_bf16_f32 v225, v180, v181
    v_lshlrev_b32 v172, 16, v224
    v_and_b32 v173, 0xffff0000, v224
    v_lshlrev_b32 v180, 16, v225
    v_and_b32 v181, 0xffff0000, v225
    v_mul_f32 v224, s47, v172
    v_mul_f32 v225, s47, v173
    v_exp_f32 v224, v224
    v_exp_f32 v225, v225
    v_add_f32 v224, 1.0, v224
    v_add_f32 v225, 1.0, v225
    v_rcp_f32 v224, v224
    v_rcp_f32 v225, v225
    v_mul_f32 v224, v172, v224
    v_mul_f32 v225, v173, v225
    v_cvt_pk_bf16_f32 v226, v224, v225
    v_lshlrev_b32 v224, 16, v226
    v_and_b32 v225, 0xffff0000, v226
    v_mul_f32 v224, v224, v180
    v_mul_f32 v225, v225, v181
    v_cvt_pk_bf16_f32 v222, v224, v225
    v_cvt_pk_bf16_f32 v224, v174, v175
    v_cvt_pk_bf16_f32 v225, v182, v183
    v_lshlrev_b32 v174, 16, v224
    v_and_b32 v175, 0xffff0000, v224
    v_lshlrev_b32 v182, 16, v225
    v_and_b32 v183, 0xffff0000, v225
    v_mul_f32 v224, s47, v174
    v_mul_f32 v225, s47, v175
    v_exp_f32 v224, v224
    v_exp_f32 v225, v225
    v_add_f32 v224, 1.0, v224
    v_add_f32 v225, 1.0, v225
    v_rcp_f32 v224, v224
    v_rcp_f32 v225, v225
    v_mul_f32 v224, v174, v224
    v_mul_f32 v225, v175, v225
    v_cvt_pk_bf16_f32 v226, v224, v225
    v_lshlrev_b32 v224, 16, v226
    v_and_b32 v225, 0xffff0000, v226
    v_mul_f32 v224, v224, v182
    v_mul_f32 v225, v225, v183
    v_cvt_pk_bf16_f32 v223, v224, v225
    s_add_u32 s46, s45, 524288
    s_cmp_lt_u32 s41, 9
    s_cbranch_scc1 L_k1_f_nostore
    buffer_store_dwordx4 v[220:223], v5, s[32:35], s46 offen
L_k1_f_nostore:
    s_nop 2
    s_branch L_k1_end
L_k1_end:
    s_endpgm
.globl k2_attn_kernel
.p2align 8
.type k2_attn_kernel,@function
k2_attn_kernel:
    s_cmp_ge_u32 s2, 512
    s_cbranch_scc1 L_k2_end
    s_load_dwordx2 s[4:5], s[0:1], 72
    s_and_b32 s3, s2, 7
    s_lshr_b32 s9, s2, 3
    s_and_b32 s6, s9, 3
    s_lshl_b32 s3, s3, 2
    s_add_u32 s6, s6, s3
    s_lshr_b32 s9, s9, 2
    v_and_b32 v1, 63, v0
    v_lshrrev_b32 v2, 6, v0
    s_nop 0
    v_readfirstlane_b32 s8, v2
    s_lshl_b32 s7, s9, 2
    s_add_u32 s7, s7, s8
    v_and_b32 v2, 31, v1
    v_lshrrev_b32 v3, 5, v1
    v_lshlrev_b32 v92, 5, v2
    v_lshl_add_u32 v92, v3, 4, v92
    v_and_b32 v93, 15, v1
    v_lshlrev_b32 v93, 6, v93
    v_lshrrev_b32 v94, 4, v1
    v_lshl_add_u32 v93, v94, 4, v93
    s_waitcnt lgkmcnt(0)
    s_add_u32 s12, s4, 2097152
    s_addc_u32 s13, s5, 0
    s_mov_b32 s14, 2097152
    s_mov_b32 s15, 0x00020000
    s_add_u32 s16, s4, 4194304
    s_addc_u32 s17, s5, 0
    s_mov_b32 s18, 2097152
    s_mov_b32 s19, 0x00020000
    s_add_u32 s20, s4, 6291456
    s_addc_u32 s21, s5, 0
    s_mov_b32 s22, 2097152
    s_mov_b32 s23, 0x00020000
    s_add_u32 s24, s4, 14680064
    s_addc_u32 s25, s5, 0
    s_mov_b32 s26, 2097152
    s_mov_b32 s27, 0x00020000
    s_lshl_b32 s10, s6, 16
    s_lshl_b32 s11, s7, 10
    s_add_u32 s11, s11, s10
    buffer_load_dwordx4 v[4:7], v92, s[12:15], s11 offen
    s_add_i32 s64, s7, -8
    s_max_i32 s28, s64, 0
    s_lshl_b32 s28, s28, 10
    s_add_u32 s28, s28, s10
    buffer_load_dwordx4 v[8:11], v92, s[16:19], s28 offen
    s_mov_b32 s76, s28
    s_add_i32 s65, s7, -7
    s_max_i32 s28, s65, 0
    s_lshl_b32 s28, s28, 10
    s_add_u32 s28, s28, s10
    buffer_load_dwordx4 v[12:15], v92, s[16:19], s28 offen
    s_mov_b32 s77, s28
    s_add_i32 s66, s7, -6
    s_max_i32 s28, s66, 0
    s_lshl_b32 s28, s28, 10
    s_add_u32 s28, s28, s10
    buffer_load_dwordx4 v[16:19], v92, s[16:19], s28 offen
    s_mov_b32 s78, s28
    s_add_i32 s67, s7, -5
    s_max_i32 s28, s67, 0
    s_lshl_b32 s28, s28, 10
    s_add_u32 s28, s28, s10
    buffer_load_dwordx4 v[20:23], v92, s[16:19], s28 offen
    s_mov_b32 s79, s28
    s_add_i32 s68, s7, -4
    s_max_i32 s28, s68, 0
    s_lshl_b32 s28, s28, 10
    s_add_u32 s28, s28, s10
    buffer_load_dwordx4 v[24:27], v92, s[16:19], s28 offen
    s_mov_b32 s80, s28
    s_add_i32 s69, s7, -3
    s_max_i32 s28, s69, 0
    s_lshl_b32 s28, s28, 10
    s_add_u32 s28, s28, s10
    buffer_load_dwordx4 v[28:31], v92, s[16:19], s28 offen
    s_mov_b32 s81, s28
    s_add_i32 s70, s7, -2
    s_max_i32 s28, s70, 0
    s_lshl_b32 s28, s28, 10
    s_add_u32 s28, s28, s10
    buffer_load_dwordx4 v[32:35], v92, s[16:19], s28 offen
    s_mov_b32 s82, s28
    s_add_i32 s71, s7, -1
    s_max_i32 s28, s71, 0
    s_lshl_b32 s28, s28, 10
    s_add_u32 s28, s28, s10
    buffer_load_dwordx4 v[36:39], v92, s[16:19], s28 offen
    s_mov_b32 s83, s28
    s_add_i32 s72, s7, 0
    s_max_i32 s28, s72, 0
    s_lshl_b32 s28, s28, 10
    s_add_u32 s28, s28, s10
    buffer_load_dwordx4 v[40:43], v92, s[16:19], s28 offen
    s_mov_b32 s84, s28
    buffer_load_dwordx4 v[44:47], v93, s[20:23], s76 offen
    buffer_load_dwordx4 v[48:51], v93, s[20:23], s77 offen
    buffer_load_dwordx4 v[52:55], v93, s[20:23], s78 offen
    buffer_load_dwordx4 v[56:59], v93, s[20:23], s79 offen
    buffer_load_dwordx4 v[60:63], v93, s[20:23], s80 offen
    buffer_load_dwordx4 v[64:67], v93, s[20:23], s81 offen
    buffer_load_dwordx4 v[68:71], v93, s[20:23], s82 offen
    buffer_load_dwordx4 v[72:75], v93, s[20:23], s83 offen
    buffer_load_dwordx4 v[76:79], v93, s[20:23], s84 offen
    v_lshlrev_b32 v94, 2, v3
    v_sub_u32 v94, v2, v94
    v_cmp_ge_i32 s[32:33], v94, 0
    v_cmp_ge_i32 s[34:35], v94, 1
    v_cmp_ge_i32 s[36:37], v94, 2
    v_cmp_ge_i32 s[38:39], v94, 3
    v_cmp_ge_i32 s[40:41], v94, 8
    v_cmp_ge_i32 s[42:43], v94, 9
    v_cmp_ge_i32 s[44:45], v94, 10
    v_cmp_ge_i32 s[46:47], v94, 11
    v_cmp_ge_i32 s[48:49], v94, 16
    v_cmp_ge_i32 s[50:51], v94, 17
    v_cmp_ge_i32 s[52:53], v94, 18
    v_cmp_ge_i32 s[54:55], v94, 19
    v_cmp_ge_i32 s[56:57], v94, 24
    v_cmp_ge_i32 s[58:59], v94, 25
    v_cmp_ge_i32 s[60:61], v94, 26
    v_cmp_ge_i32 s[62:63], v94, 27
    s_waitcnt vmcnt(17)
    v_mfma_f32_32x32x16_bf16 v[96:111], v[8:11], v[4:7], 0
    s_waitcnt vmcnt(16)
    v_mfma_f32_32x32x16_bf16 v[112:127], v[12:15], v[4:7], 0
    s_waitcnt vmcnt(15)
    v_mfma_f32_32x32x16_bf16 v[128:143], v[16:19], v[4:7], 0
    s_waitcnt vmcnt(14)
    v_mfma_f32_32x32x16_bf16 v[144:159], v[20:23], v[4:7], 0
    s_waitcnt vmcnt(13)
    v_mfma_f32_32x32x16_bf16 v[160:175], v[24:27], v[4:7], 0
    s_waitcnt vmcnt(12)
    v_mfma_f32_32x32x16_bf16 v[176:191], v[28:31], v[4:7], 0
    s_waitcnt vmcnt(11)
    v_mfma_f32_32x32x16_bf16 v[192:207], v[32:35], v[4:7], 0
    s_waitcnt vmcnt(10)
    v_mfma_f32_32x32x16_bf16 v[208:223], v[36:39], v[4:7], 0
    s_waitcnt vmcnt(9)
    v_mfma_f32_32x32x16_bf16 v[224:239], v[40:43], v[4:7], 0
    s_cmp_ge_i32 s64, 0
    s_cbranch_scc1 L_k2_ok0
    v_mov_b32 v96, 0xff800000
    s_nop 0
    v_mov_b32 v97, 0xff800000
    s_nop 0
    v_mov_b32 v98, 0xff800000
    s_nop 0
    v_mov_b32 v99, 0xff800000
    s_nop 0
    v_mov_b32 v100, 0xff800000
    s_nop 0
    v_mov_b32 v101, 0xff800000
    s_nop 0
    v_mov_b32 v102, 0xff800000
    s_nop 0
    v_mov_b32 v103, 0xff800000
    s_nop 0
    v_mov_b32 v104, 0xff800000
    s_nop 0
    v_mov_b32 v105, 0xff800000
    s_nop 0
    v_mov_b32 v106, 0xff800000
    s_nop 0
    v_mov_b32 v107, 0xff800000
    s_nop 0
    v_mov_b32 v108, 0xff800000
    s_nop 0
    v_mov_b32 v109, 0xff800000
    s_nop 0
    v_mov_b32 v110, 0xff800000
    s_nop 0
    v_mov_b32 v111, 0xff800000
L_k2_ok0:
    s_nop 0
    s_cmp_ge_i32 s65, 0
    s_cbranch_scc1 L_k2_ok1
    v_mov_b32 v112, 0xff800000
    s_nop 0
    v_mov_b32 v113, 0xff800000
    s_nop 0
    v_mov_b32 v114, 0xff800000
    s_nop 0
    v_mov_b32 v115, 0xff800000
    s_nop 0
    v_mov_b32 v116, 0xff800000
    s_nop 0
    v_mov_b32 v117, 0xff800000
    s_nop 0
    v_mov_b32 v118, 0xff800000
    s_nop 0
    v_mov_b32 v119, 0xff800000
    s_nop 0
    v_mov_b32 v120, 0xff800000
    s_nop 0
    v_mov_b32 v121, 0xff800000
    s_nop 0
    v_mov_b32 v122, 0xff800000
    s_nop 0
    v_mov_b32 v123, 0xff800000
    s_nop 0
    v_mov_b32 v124, 0xff800000
    s_nop 0
    v_mov_b32 v125, 0xff800000
    s_nop 0
    v_mov_b32 v126, 0xff800000
    s_nop 0
    v_mov_b32 v127, 0xff800000
L_k2_ok1:
    s_nop 0
    s_cmp_ge_i32 s66, 0
    s_cbranch_scc1 L_k2_ok2
    v_mov_b32 v128, 0xff800000
    s_nop 0
    v_mov_b32 v129, 0xff800000
    s_nop 0
    v_mov_b32 v130, 0xff800000
    s_nop 0
    v_mov_b32 v131, 0xff800000
    s_nop 0
    v_mov_b32 v132, 0xff800000
    s_nop 0
    v_mov_b32 v133, 0xff800000
    s_nop 0
    v_mov_b32 v134, 0xff800000
    s_nop 0
    v_mov_b32 v135, 0xff800000
    s_nop 0
    v_mov_b32 v136, 0xff800000
    s_nop 0
    v_mov_b32 v137, 0xff800000
    s_nop 0
    v_mov_b32 v138, 0xff800000
    s_nop 0
    v_mov_b32 v139, 0xff800000
    s_nop 0
    v_mov_b32 v140, 0xff800000
    s_nop 0
    v_mov_b32 v141, 0xff800000
    s_nop 0
    v_mov_b32 v142, 0xff800000
    s_nop 0
    v_mov_b32 v143, 0xff800000
L_k2_ok2:
    s_nop 0
    s_cmp_ge_i32 s67, 0
    s_cbranch_scc1 L_k2_ok3
    v_mov_b32 v144, 0xff800000
    s_nop 0
    v_mov_b32 v145, 0xff800000
    s_nop 0
    v_mov_b32 v146, 0xff800000
    s_nop 0
    v_mov_b32 v147, 0xff800000
    s_nop 0
    v_mov_b32 v148, 0xff800000
    s_nop 0
    v_mov_b32 v149, 0xff800000
    s_nop 0
    v_mov_b32 v150, 0xff800000
    s_nop 0
    v_mov_b32 v151, 0xff800000
    s_nop 0
    v_mov_b32 v152, 0xff800000
    s_nop 0
    v_mov_b32 v153, 0xff800000
    s_nop 0
    v_mov_b32 v154, 0xff800000
    s_nop 0
    v_mov_b32 v155, 0xff800000
    s_nop 0
    v_mov_b32 v156, 0xff800000
    s_nop 0
    v_mov_b32 v157, 0xff800000
    s_nop 0
    v_mov_b32 v158, 0xff800000
    s_nop 0
    v_mov_b32 v159, 0xff800000
L_k2_ok3:
    s_nop 0
    s_cmp_ge_i32 s68, 0
    s_cbranch_scc1 L_k2_ok4
    v_mov_b32 v160, 0xff800000
    s_nop 0
    v_mov_b32 v161, 0xff800000
    s_nop 0
    v_mov_b32 v162, 0xff800000
    s_nop 0
    v_mov_b32 v163, 0xff800000
    s_nop 0
    v_mov_b32 v164, 0xff800000
    s_nop 0
    v_mov_b32 v165, 0xff800000
    s_nop 0
    v_mov_b32 v166, 0xff800000
    s_nop 0
    v_mov_b32 v167, 0xff800000
    s_nop 0
    v_mov_b32 v168, 0xff800000
    s_nop 0
    v_mov_b32 v169, 0xff800000
    s_nop 0
    v_mov_b32 v170, 0xff800000
    s_nop 0
    v_mov_b32 v171, 0xff800000
    s_nop 0
    v_mov_b32 v172, 0xff800000
    s_nop 0
    v_mov_b32 v173, 0xff800000
    s_nop 0
    v_mov_b32 v174, 0xff800000
    s_nop 0
    v_mov_b32 v175, 0xff800000
L_k2_ok4:
    s_nop 0
    s_cmp_ge_i32 s69, 0
    s_cbranch_scc1 L_k2_ok5
    v_mov_b32 v176, 0xff800000
    s_nop 0
    v_mov_b32 v177, 0xff800000
    s_nop 0
    v_mov_b32 v178, 0xff800000
    s_nop 0
    v_mov_b32 v179, 0xff800000
    s_nop 0
    v_mov_b32 v180, 0xff800000
    s_nop 0
    v_mov_b32 v181, 0xff800000
    s_nop 0
    v_mov_b32 v182, 0xff800000
    s_nop 0
    v_mov_b32 v183, 0xff800000
    s_nop 0
    v_mov_b32 v184, 0xff800000
    s_nop 0
    v_mov_b32 v185, 0xff800000
    s_nop 0
    v_mov_b32 v186, 0xff800000
    s_nop 0
    v_mov_b32 v187, 0xff800000
    s_nop 0
    v_mov_b32 v188, 0xff800000
    s_nop 0
    v_mov_b32 v189, 0xff800000
    s_nop 0
    v_mov_b32 v190, 0xff800000
    s_nop 0
    v_mov_b32 v191, 0xff800000
L_k2_ok5:
    s_nop 0
    s_cmp_ge_i32 s70, 0
    s_cbranch_scc1 L_k2_ok6
    v_mov_b32 v192, 0xff800000
    s_nop 0
    v_mov_b32 v193, 0xff800000
    s_nop 0
    v_mov_b32 v194, 0xff800000
    s_nop 0
    v_mov_b32 v195, 0xff800000
    s_nop 0
    v_mov_b32 v196, 0xff800000
    s_nop 0
    v_mov_b32 v197, 0xff800000
    s_nop 0
    v_mov_b32 v198, 0xff800000
    s_nop 0
    v_mov_b32 v199, 0xff800000
    s_nop 0
    v_mov_b32 v200, 0xff800000
    s_nop 0
    v_mov_b32 v201, 0xff800000
    s_nop 0
    v_mov_b32 v202, 0xff800000
    s_nop 0
    v_mov_b32 v203, 0xff800000
    s_nop 0
    v_mov_b32 v204, 0xff800000
    s_nop 0
    v_mov_b32 v205, 0xff800000
    s_nop 0
    v_mov_b32 v206, 0xff800000
    s_nop 0
    v_mov_b32 v207, 0xff800000
L_k2_ok6:
    s_nop 0
    s_cmp_ge_i32 s71, 0
    s_cbranch_scc1 L_k2_ok7
    v_mov_b32 v208, 0xff800000
    s_nop 0
    v_mov_b32 v209, 0xff800000
    s_nop 0
    v_mov_b32 v210, 0xff800000
    s_nop 0
    v_mov_b32 v211, 0xff800000
    s_nop 0
    v_mov_b32 v212, 0xff800000
    s_nop 0
    v_mov_b32 v213, 0xff800000
    s_nop 0
    v_mov_b32 v214, 0xff800000
    s_nop 0
    v_mov_b32 v215, 0xff800000
    s_nop 0
    v_mov_b32 v216, 0xff800000
    s_nop 0
    v_mov_b32 v217, 0xff800000
    s_nop 0
    v_mov_b32 v218, 0xff800000
    s_nop 0
    v_mov_b32 v219, 0xff800000
    s_nop 0
    v_mov_b32 v220, 0xff800000
    s_nop 0
    v_mov_b32 v221, 0xff800000
    s_nop 0
    v_mov_b32 v222, 0xff800000
    s_nop 0
    v_mov_b32 v223, 0xff800000
L_k2_ok7:
    s_nop 0
    v_mov_b32 v88, 0xff800000
    v_cndmask_b32 v224, v88, v224, s[32:33]
    v_cndmask_b32 v225, v88, v225, s[34:35]
    v_cndmask_b32 v226, v88, v226, s[36:37]
    v_cndmask_b32 v227, v88, v227, s[38:39]
    v_cndmask_b32 v228, v88, v228, s[40:41]
    v_cndmask_b32 v229, v88, v229, s[42:43]
    v_cndmask_b32 v230, v88, v230, s[44:45]
    v_cndmask_b32 v231, v88, v231, s[46:47]
    v_cndmask_b32 v232, v88, v232, s[48:49]
    v_cndmask_b32 v233, v88, v233, s[50:51]
    v_cndmask_b32 v234, v88, v234, s[52:53]
    v_cndmask_b32 v235, v88, v235, s[54:55]
    v_cndmask_b32 v236, v88, v236, s[56:57]
    v_cndmask_b32 v237, v88, v237, s[58:59]
    v_cndmask_b32 v238, v88, v238, s[60:61]
    v_cndmask_b32 v239, v88, v239, s[62:63]
    v_cndmask_b32 v96, v96, v88, s[32:33]
    v_cndmask_b32 v97, v97, v88, s[34:35]
    v_cndmask_b32 v98, v98, v88, s[36:37]
    v_cndmask_b32 v99, v99, v88, s[38:39]
    v_cndmask_b32 v100, v100, v88, s[40:41]
    v_cndmask_b32 v101, v101, v88, s[42:43]
    v_cndmask_b32 v102, v102, v88, s[44:45]
    v_cndmask_b32 v103, v103, v88, s[46:47]
    v_cndmask_b32 v104, v104, v88, s[48:49]
    v_cndmask_b32 v105, v105, v88, s[50:51]
    v_cndmask_b32 v106, v106, v88, s[52:53]
    v_cndmask_b32 v107, v107, v88, s[54:55]
    v_cndmask_b32 v108, v108, v88, s[56:57]
    v_cndmask_b32 v109, v109, v88, s[58:59]
    v_cndmask_b32 v110, v110, v88, s[60:61]
    v_cndmask_b32 v111, v111, v88, s[62:63]
    v_max_f32 v88, v96, v97
    v_max_f32 v89, v98, v99
    v_max_f32 v90, v100, v101
    v_max_f32 v91, v102, v103
    v_max3_f32 v88, v104, v105, v88
    v_max3_f32 v89, v106, v107, v89
    v_max3_f32 v90, v108, v109, v90
    v_max3_f32 v91, v110, v111, v91
    v_max3_f32 v88, v112, v113, v88
    v_max3_f32 v89, v114, v115, v89
    v_max3_f32 v90, v116, v117, v90
    v_max3_f32 v91, v118, v119, v91
    v_max3_f32 v88, v120, v121, v88
    v_max3_f32 v89, v122, v123, v89
    v_max3_f32 v90, v124, v125, v90
    v_max3_f32 v91, v126, v127, v91
    v_max3_f32 v88, v128, v129, v88
    v_max3_f32 v89, v130, v131, v89
    v_max3_f32 v90, v132, v133, v90
    v_max3_f32 v91, v134, v135, v91
    v_max3_f32 v88, v136, v137, v88
    v_max3_f32 v89, v138, v139, v89
    v_max3_f32 v90, v140, v141, v90
    v_max3_f32 v91, v142, v143, v91
    v_max3_f32 v88, v144, v145, v88
    v_max3_f32 v89, v146, v147, v89
    v_max3_f32 v90, v148, v149, v90
    v_max3_f32 v91, v150, v151, v91
    v_max3_f32 v88, v152, v153, v88
    v_max3_f32 v89, v154, v155, v89
    v_max3_f32 v90, v156, v157, v90
    v_max3_f32 v91, v158, v159, v91
    v_max3_f32 v88, v160, v161, v88
    v_max3_f32 v89, v162, v163, v89
    v_max3_f32 v90, v164, v165, v90
    v_max3_f32 v91, v166, v167, v91
    v_max3_f32 v88, v168, v169, v88
    v_max3_f32 v89, v170, v171, v89
    v_max3_f32 v90, v172, v173, v90
    v_max3_f32 v91, v174, v175, v91
    v_max3_f32 v88, v176, v177, v88
    v_max3_f32 v89, v178, v179, v89
    v_max3_f32 v90, v180, v181, v90
    v_max3_f32 v91, v182, v183, v91
    v_max3_f32 v88, v184, v185, v88
    v_max3_f32 v89, v186, v187, v89
    v_max3_f32 v90, v188, v189, v90
    v_max3_f32 v91, v190, v191, v91
    v_max3_f32 v88, v192, v193, v88
    v_max3_f32 v89, v194, v195, v89
    v_max3_f32 v90, v196, v197, v90
    v_max3_f32 v91, v198, v199, v91
    v_max3_f32 v88, v200, v201, v88
    v_max3_f32 v89, v202, v203, v89
    v_max3_f32 v90, v204, v205, v90
    v_max3_f32 v91, v206, v207, v91
    v_max3_f32 v88, v208, v209, v88
    v_max3_f32 v89, v210, v211, v89
    v_max3_f32 v90, v212, v213, v90
    v_max3_f32 v91, v214, v215, v91
    v_max3_f32 v88, v216, v217, v88
    v_max3_f32 v89, v218, v219, v89
    v_max3_f32 v90, v220, v221, v90
    v_max3_f32 v91, v222, v223, v91
    v_max3_f32 v88, v224, v225, v88
    v_max3_f32 v89, v226, v227, v89
    v_max3_f32 v90, v228, v229, v90
    v_max3_f32 v91, v230, v231, v91
    v_max3_f32 v88, v232, v233, v88
    v_max3_f32 v89, v234, v235, v89
    v_max3_f32 v90, v236, v237, v90
    v_max3_f32 v91, v238, v239, v91
    v_max3_f32 v88, v88, v89, v90
    v_max_f32 v88, v88, v91
    v_mov_b32 v89, v88
    s_nop 1
    v_permlane32_swap_b32 v88, v89
    v_max_f32 v88, v88, v89
    v_cvt_pk_bf16_f32 v89, v88, v88
    v_lshlrev_b32 v88, 16, v89
    s_mov_b32 s29, 0x3eb8aa3b
    v_mul_f32 v88, s29, v88
    v_sub_f32 v88, 0, v88
    v_mov_b32 v89, 0
    v_mov_b32 v90, 0
    v_cvt_pk_bf16_f32 v91, v96, v97
    v_lshlrev_b32 v96, 16, v91
    v_and_b32 v97, 0xffff0000, v91
    v_fma_f32 v96, v96, s29, v88
    v_fma_f32 v97, v97, s29, v88
    v_exp_f32 v96, v96
    v_exp_f32 v97, v97
    v_add_f32 v89, v89, v96
    v_add_f32 v90, v90, v97
    v_cvt_pk_bf16_f32 v91, v98, v99
    v_lshlrev_b32 v98, 16, v91
    v_and_b32 v99, 0xffff0000, v91
    v_fma_f32 v98, v98, s29, v88
    v_fma_f32 v99, v99, s29, v88
    v_exp_f32 v98, v98
    v_exp_f32 v99, v99
    v_add_f32 v89, v89, v98
    v_add_f32 v90, v90, v99
    v_cvt_pk_bf16_f32 v91, v100, v101
    v_lshlrev_b32 v100, 16, v91
    v_and_b32 v101, 0xffff0000, v91
    v_fma_f32 v100, v100, s29, v88
    v_fma_f32 v101, v101, s29, v88
    v_exp_f32 v100, v100
    v_exp_f32 v101, v101
    v_add_f32 v89, v89, v100
    v_add_f32 v90, v90, v101
    v_cvt_pk_bf16_f32 v91, v102, v103
    v_lshlrev_b32 v102, 16, v91
    v_and_b32 v103, 0xffff0000, v91
    v_fma_f32 v102, v102, s29, v88
    v_fma_f32 v103, v103, s29, v88
    v_exp_f32 v102, v102
    v_exp_f32 v103, v103
    v_add_f32 v89, v89, v102
    v_add_f32 v90, v90, v103
    v_cvt_pk_bf16_f32 v91, v104, v105
    v_lshlrev_b32 v104, 16, v91
    v_and_b32 v105, 0xffff0000, v91
    v_fma_f32 v104, v104, s29, v88
    v_fma_f32 v105, v105, s29, v88
    v_exp_f32 v104, v104
    v_exp_f32 v105, v105
    v_add_f32 v89, v89, v104
    v_add_f32 v90, v90, v105
    v_cvt_pk_bf16_f32 v91, v106, v107
    v_lshlrev_b32 v106, 16, v91
    v_and_b32 v107, 0xffff0000, v91
    v_fma_f32 v106, v106, s29, v88
    v_fma_f32 v107, v107, s29, v88
    v_exp_f32 v106, v106
    v_exp_f32 v107, v107
    v_add_f32 v89, v89, v106
    v_add_f32 v90, v90, v107
    v_cvt_pk_bf16_f32 v91, v108, v109
    v_lshlrev_b32 v108, 16, v91
    v_and_b32 v109, 0xffff0000, v91
    v_fma_f32 v108, v108, s29, v88
    v_fma_f32 v109, v109, s29, v88
    v_exp_f32 v108, v108
    v_exp_f32 v109, v109
    v_add_f32 v89, v89, v108
    v_add_f32 v90, v90, v109
    v_cvt_pk_bf16_f32 v91, v110, v111
    v_lshlrev_b32 v110, 16, v91
    v_and_b32 v111, 0xffff0000, v91
    v_fma_f32 v110, v110, s29, v88
    v_fma_f32 v111, v111, s29, v88
    v_exp_f32 v110, v110
    v_exp_f32 v111, v111
    v_add_f32 v89, v89, v110
    v_add_f32 v90, v90, v111
    v_cvt_pk_bf16_f32 v91, v112, v113
    v_lshlrev_b32 v112, 16, v91
    v_and_b32 v113, 0xffff0000, v91
    v_fma_f32 v112, v112, s29, v88
    v_fma_f32 v113, v113, s29, v88
    v_exp_f32 v112, v112
    v_exp_f32 v113, v113
    v_add_f32 v89, v89, v112
    v_add_f32 v90, v90, v113
    v_cvt_pk_bf16_f32 v91, v114, v115
    v_lshlrev_b32 v114, 16, v91
    v_and_b32 v115, 0xffff0000, v91
    v_fma_f32 v114, v114, s29, v88
    v_fma_f32 v115, v115, s29, v88
    v_exp_f32 v114, v114
    v_exp_f32 v115, v115
    v_add_f32 v89, v89, v114
    v_add_f32 v90, v90, v115
    v_cvt_pk_bf16_f32 v91, v116, v117
    v_lshlrev_b32 v116, 16, v91
    v_and_b32 v117, 0xffff0000, v91
    v_fma_f32 v116, v116, s29, v88
    v_fma_f32 v117, v117, s29, v88
    v_exp_f32 v116, v116
    v_exp_f32 v117, v117
    v_add_f32 v89, v89, v116
    v_add_f32 v90, v90, v117
    v_cvt_pk_bf16_f32 v91, v118, v119
    v_lshlrev_b32 v118, 16, v91
    v_and_b32 v119, 0xffff0000, v91
    v_fma_f32 v118, v118, s29, v88
    v_fma_f32 v119, v119, s29, v88
    v_exp_f32 v118, v118
    v_exp_f32 v119, v119
    v_add_f32 v89, v89, v118
    v_add_f32 v90, v90, v119
    v_cvt_pk_bf16_f32 v91, v120, v121
    v_lshlrev_b32 v120, 16, v91
    v_and_b32 v121, 0xffff0000, v91
    v_fma_f32 v120, v120, s29, v88
    v_fma_f32 v121, v121, s29, v88
    v_exp_f32 v120, v120
    v_exp_f32 v121, v121
    v_add_f32 v89, v89, v120
    v_add_f32 v90, v90, v121
    v_cvt_pk_bf16_f32 v91, v122, v123
    v_lshlrev_b32 v122, 16, v91
    v_and_b32 v123, 0xffff0000, v91
    v_fma_f32 v122, v122, s29, v88
    v_fma_f32 v123, v123, s29, v88
    v_exp_f32 v122, v122
    v_exp_f32 v123, v123
    v_add_f32 v89, v89, v122
    v_add_f32 v90, v90, v123
    v_cvt_pk_bf16_f32 v91, v124, v125
    v_lshlrev_b32 v124, 16, v91
    v_and_b32 v125, 0xffff0000, v91
    v_fma_f32 v124, v124, s29, v88
    v_fma_f32 v125, v125, s29, v88
    v_exp_f32 v124, v124
    v_exp_f32 v125, v125
    v_add_f32 v89, v89, v124
    v_add_f32 v90, v90, v125
    v_cvt_pk_bf16_f32 v91, v126, v127
    v_lshlrev_b32 v126, 16, v91
    v_and_b32 v127, 0xffff0000, v91
    v_fma_f32 v126, v126, s29, v88
    v_fma_f32 v127, v127, s29, v88
    v_exp_f32 v126, v126
    v_exp_f32 v127, v127
    v_add_f32 v89, v89, v126
    v_add_f32 v90, v90, v127
    v_cvt_pk_bf16_f32 v91, v128, v129
    v_lshlrev_b32 v128, 16, v91
    v_and_b32 v129, 0xffff0000, v91
    v_fma_f32 v128, v128, s29, v88
    v_fma_f32 v129, v129, s29, v88
    v_exp_f32 v128, v128
    v_exp_f32 v129, v129
    v_add_f32 v89, v89, v128
    v_add_f32 v90, v90, v129
    v_cvt_pk_bf16_f32 v91, v130, v131
    v_lshlrev_b32 v130, 16, v91
    v_and_b32 v131, 0xffff0000, v91
    v_fma_f32 v130, v130, s29, v88
    v_fma_f32 v131, v131, s29, v88
    v_exp_f32 v130, v130
    v_exp_f32 v131, v131
    v_add_f32 v89, v89, v130
    v_add_f32 v90, v90, v131
    v_cvt_pk_bf16_f32 v91, v132, v133
    v_lshlrev_b32 v132, 16, v91
    v_and_b32 v133, 0xffff0000, v91
    v_fma_f32 v132, v132, s29, v88
    v_fma_f32 v133, v133, s29, v88
    v_exp_f32 v132, v132
    v_exp_f32 v133, v133
    v_add_f32 v89, v89, v132
    v_add_f32 v90, v90, v133
    v_cvt_pk_bf16_f32 v91, v134, v135
    v_lshlrev_b32 v134, 16, v91
    v_and_b32 v135, 0xffff0000, v91
    v_fma_f32 v134, v134, s29, v88
    v_fma_f32 v135, v135, s29, v88
    v_exp_f32 v134, v134
    v_exp_f32 v135, v135
    v_add_f32 v89, v89, v134
    v_add_f32 v90, v90, v135
    v_cvt_pk_bf16_f32 v91, v136, v137
    v_lshlrev_b32 v136, 16, v91
    v_and_b32 v137, 0xffff0000, v91
    v_fma_f32 v136, v136, s29, v88
    v_fma_f32 v137, v137, s29, v88
    v_exp_f32 v136, v136
    v_exp_f32 v137, v137
    v_add_f32 v89, v89, v136
    v_add_f32 v90, v90, v137
    v_cvt_pk_bf16_f32 v91, v138, v139
    v_lshlrev_b32 v138, 16, v91
    v_and_b32 v139, 0xffff0000, v91
    v_fma_f32 v138, v138, s29, v88
    v_fma_f32 v139, v139, s29, v88
    v_exp_f32 v138, v138
    v_exp_f32 v139, v139
    v_add_f32 v89, v89, v138
    v_add_f32 v90, v90, v139
    v_cvt_pk_bf16_f32 v91, v140, v141
    v_lshlrev_b32 v140, 16, v91
    v_and_b32 v141, 0xffff0000, v91
    v_fma_f32 v140, v140, s29, v88
    v_fma_f32 v141, v141, s29, v88
    v_exp_f32 v140, v140
    v_exp_f32 v141, v141
    v_add_f32 v89, v89, v140
    v_add_f32 v90, v90, v141
    v_cvt_pk_bf16_f32 v91, v142, v143
    v_lshlrev_b32 v142, 16, v91
    v_and_b32 v143, 0xffff0000, v91
    v_fma_f32 v142, v142, s29, v88
    v_fma_f32 v143, v143, s29, v88
    v_exp_f32 v142, v142
    v_exp_f32 v143, v143
    v_add_f32 v89, v89, v142
    v_add_f32 v90, v90, v143
    v_cvt_pk_bf16_f32 v91, v144, v145
    v_lshlrev_b32 v144, 16, v91
    v_and_b32 v145, 0xffff0000, v91
    v_fma_f32 v144, v144, s29, v88
    v_fma_f32 v145, v145, s29, v88
    v_exp_f32 v144, v144
    v_exp_f32 v145, v145
    v_add_f32 v89, v89, v144
    v_add_f32 v90, v90, v145
    v_cvt_pk_bf16_f32 v91, v146, v147
    v_lshlrev_b32 v146, 16, v91
    v_and_b32 v147, 0xffff0000, v91
    v_fma_f32 v146, v146, s29, v88
    v_fma_f32 v147, v147, s29, v88
    v_exp_f32 v146, v146
    v_exp_f32 v147, v147
    v_add_f32 v89, v89, v146
    v_add_f32 v90, v90, v147
    v_cvt_pk_bf16_f32 v91, v148, v149
    v_lshlrev_b32 v148, 16, v91
    v_and_b32 v149, 0xffff0000, v91
    v_fma_f32 v148, v148, s29, v88
    v_fma_f32 v149, v149, s29, v88
    v_exp_f32 v148, v148
    v_exp_f32 v149, v149
    v_add_f32 v89, v89, v148
    v_add_f32 v90, v90, v149
    v_cvt_pk_bf16_f32 v91, v150, v151
    v_lshlrev_b32 v150, 16, v91
    v_and_b32 v151, 0xffff0000, v91
    v_fma_f32 v150, v150, s29, v88
    v_fma_f32 v151, v151, s29, v88
    v_exp_f32 v150, v150
    v_exp_f32 v151, v151
    v_add_f32 v89, v89, v150
    v_add_f32 v90, v90, v151
    v_cvt_pk_bf16_f32 v91, v152, v153
    v_lshlrev_b32 v152, 16, v91
    v_and_b32 v153, 0xffff0000, v91
    v_fma_f32 v152, v152, s29, v88
    v_fma_f32 v153, v153, s29, v88
    v_exp_f32 v152, v152
    v_exp_f32 v153, v153
    v_add_f32 v89, v89, v152
    v_add_f32 v90, v90, v153
    v_cvt_pk_bf16_f32 v91, v154, v155
    v_lshlrev_b32 v154, 16, v91
    v_and_b32 v155, 0xffff0000, v91
    v_fma_f32 v154, v154, s29, v88
    v_fma_f32 v155, v155, s29, v88
    v_exp_f32 v154, v154
    v_exp_f32 v155, v155
    v_add_f32 v89, v89, v154
    v_add_f32 v90, v90, v155
    v_cvt_pk_bf16_f32 v91, v156, v157
    v_lshlrev_b32 v156, 16, v91
    v_and_b32 v157, 0xffff0000, v91
    v_fma_f32 v156, v156, s29, v88
    v_fma_f32 v157, v157, s29, v88
    v_exp_f32 v156, v156
    v_exp_f32 v157, v157
    v_add_f32 v89, v89, v156
    v_add_f32 v90, v90, v157
    v_cvt_pk_bf16_f32 v91, v158, v159
    v_lshlrev_b32 v158, 16, v91
    v_and_b32 v159, 0xffff0000, v91
    v_fma_f32 v158, v158, s29, v88
    v_fma_f32 v159, v159, s29, v88
    v_exp_f32 v158, v158
    v_exp_f32 v159, v159
    v_add_f32 v89, v89, v158
    v_add_f32 v90, v90, v159
    v_cvt_pk_bf16_f32 v91, v160, v161
    v_lshlrev_b32 v160, 16, v91
    v_and_b32 v161, 0xffff0000, v91
    v_fma_f32 v160, v160, s29, v88
    v_fma_f32 v161, v161, s29, v88
    v_exp_f32 v160, v160
    v_exp_f32 v161, v161
    v_add_f32 v89, v89, v160
    v_add_f32 v90, v90, v161
    v_cvt_pk_bf16_f32 v91, v162, v163
    v_lshlrev_b32 v162, 16, v91
    v_and_b32 v163, 0xffff0000, v91
    v_fma_f32 v162, v162, s29, v88
    v_fma_f32 v163, v163, s29, v88
    v_exp_f32 v162, v162
    v_exp_f32 v163, v163
    v_add_f32 v89, v89, v162
    v_add_f32 v90, v90, v163
    v_cvt_pk_bf16_f32 v91, v164, v165
    v_lshlrev_b32 v164, 16, v91
    v_and_b32 v165, 0xffff0000, v91
    v_fma_f32 v164, v164, s29, v88
    v_fma_f32 v165, v165, s29, v88
    v_exp_f32 v164, v164
    v_exp_f32 v165, v165
    v_add_f32 v89, v89, v164
    v_add_f32 v90, v90, v165
    v_cvt_pk_bf16_f32 v91, v166, v167
    v_lshlrev_b32 v166, 16, v91
    v_and_b32 v167, 0xffff0000, v91
    v_fma_f32 v166, v166, s29, v88
    v_fma_f32 v167, v167, s29, v88
    v_exp_f32 v166, v166
    v_exp_f32 v167, v167
    v_add_f32 v89, v89, v166
    v_add_f32 v90, v90, v167
    v_cvt_pk_bf16_f32 v91, v168, v169
    v_lshlrev_b32 v168, 16, v91
    v_and_b32 v169, 0xffff0000, v91
    v_fma_f32 v168, v168, s29, v88
    v_fma_f32 v169, v169, s29, v88
    v_exp_f32 v168, v168
    v_exp_f32 v169, v169
    v_add_f32 v89, v89, v168
    v_add_f32 v90, v90, v169
    v_cvt_pk_bf16_f32 v91, v170, v171
    v_lshlrev_b32 v170, 16, v91
    v_and_b32 v171, 0xffff0000, v91
    v_fma_f32 v170, v170, s29, v88
    v_fma_f32 v171, v171, s29, v88
    v_exp_f32 v170, v170
    v_exp_f32 v171, v171
    v_add_f32 v89, v89, v170
    v_add_f32 v90, v90, v171
    v_cvt_pk_bf16_f32 v91, v172, v173
    v_lshlrev_b32 v172, 16, v91
    v_and_b32 v173, 0xffff0000, v91
    v_fma_f32 v172, v172, s29, v88
    v_fma_f32 v173, v173, s29, v88
    v_exp_f32 v172, v172
    v_exp_f32 v173, v173
    v_add_f32 v89, v89, v172
    v_add_f32 v90, v90, v173
    v_cvt_pk_bf16_f32 v91, v174, v175
    v_lshlrev_b32 v174, 16, v91
    v_and_b32 v175, 0xffff0000, v91
    v_fma_f32 v174, v174, s29, v88
    v_fma_f32 v175, v175, s29, v88
    v_exp_f32 v174, v174
    v_exp_f32 v175, v175
    v_add_f32 v89, v89, v174
    v_add_f32 v90, v90, v175
    v_cvt_pk_bf16_f32 v91, v176, v177
    v_lshlrev_b32 v176, 16, v91
    v_and_b32 v177, 0xffff0000, v91
    v_fma_f32 v176, v176, s29, v88
    v_fma_f32 v177, v177, s29, v88
    v_exp_f32 v176, v176
    v_exp_f32 v177, v177
    v_add_f32 v89, v89, v176
    v_add_f32 v90, v90, v177
    v_cvt_pk_bf16_f32 v91, v178, v179
    v_lshlrev_b32 v178, 16, v91
    v_and_b32 v179, 0xffff0000, v91
    v_fma_f32 v178, v178, s29, v88
    v_fma_f32 v179, v179, s29, v88
    v_exp_f32 v178, v178
    v_exp_f32 v179, v179
    v_add_f32 v89, v89, v178
    v_add_f32 v90, v90, v179
    v_cvt_pk_bf16_f32 v91, v180, v181
    v_lshlrev_b32 v180, 16, v91
    v_and_b32 v181, 0xffff0000, v91
    v_fma_f32 v180, v180, s29, v88
    v_fma_f32 v181, v181, s29, v88
    v_exp_f32 v180, v180
    v_exp_f32 v181, v181
    v_add_f32 v89, v89, v180
    v_add_f32 v90, v90, v181
    v_cvt_pk_bf16_f32 v91, v182, v183
    v_lshlrev_b32 v182, 16, v91
    v_and_b32 v183, 0xffff0000, v91
    v_fma_f32 v182, v182, s29, v88
    v_fma_f32 v183, v183, s29, v88
    v_exp_f32 v182, v182
    v_exp_f32 v183, v183
    v_add_f32 v89, v89, v182
    v_add_f32 v90, v90, v183
    v_cvt_pk_bf16_f32 v91, v184, v185
    v_lshlrev_b32 v184, 16, v91
    v_and_b32 v185, 0xffff0000, v91
    v_fma_f32 v184, v184, s29, v88
    v_fma_f32 v185, v185, s29, v88
    v_exp_f32 v184, v184
    v_exp_f32 v185, v185
    v_add_f32 v89, v89, v184
    v_add_f32 v90, v90, v185
    v_cvt_pk_bf16_f32 v91, v186, v187
    v_lshlrev_b32 v186, 16, v91
    v_and_b32 v187, 0xffff0000, v91
    v_fma_f32 v186, v186, s29, v88
    v_fma_f32 v187, v187, s29, v88
    v_exp_f32 v186, v186
    v_exp_f32 v187, v187
    v_add_f32 v89, v89, v186
    v_add_f32 v90, v90, v187
    v_cvt_pk_bf16_f32 v91, v188, v189
    v_lshlrev_b32 v188, 16, v91
    v_and_b32 v189, 0xffff0000, v91
    v_fma_f32 v188, v188, s29, v88
    v_fma_f32 v189, v189, s29, v88
    v_exp_f32 v188, v188
    v_exp_f32 v189, v189
    v_add_f32 v89, v89, v188
    v_add_f32 v90, v90, v189
    v_cvt_pk_bf16_f32 v91, v190, v191
    v_lshlrev_b32 v190, 16, v91
    v_and_b32 v191, 0xffff0000, v91
    v_fma_f32 v190, v190, s29, v88
    v_fma_f32 v191, v191, s29, v88
    v_exp_f32 v190, v190
    v_exp_f32 v191, v191
    v_add_f32 v89, v89, v190
    v_add_f32 v90, v90, v191
    v_cvt_pk_bf16_f32 v91, v192, v193
    v_lshlrev_b32 v192, 16, v91
    v_and_b32 v193, 0xffff0000, v91
    v_fma_f32 v192, v192, s29, v88
    v_fma_f32 v193, v193, s29, v88
    v_exp_f32 v192, v192
    v_exp_f32 v193, v193
    v_add_f32 v89, v89, v192
    v_add_f32 v90, v90, v193
    v_cvt_pk_bf16_f32 v91, v194, v195
    v_lshlrev_b32 v194, 16, v91
    v_and_b32 v195, 0xffff0000, v91
    v_fma_f32 v194, v194, s29, v88
    v_fma_f32 v195, v195, s29, v88
    v_exp_f32 v194, v194
    v_exp_f32 v195, v195
    v_add_f32 v89, v89, v194
    v_add_f32 v90, v90, v195
    v_cvt_pk_bf16_f32 v91, v196, v197
    v_lshlrev_b32 v196, 16, v91
    v_and_b32 v197, 0xffff0000, v91
    v_fma_f32 v196, v196, s29, v88
    v_fma_f32 v197, v197, s29, v88
    v_exp_f32 v196, v196
    v_exp_f32 v197, v197
    v_add_f32 v89, v89, v196
    v_add_f32 v90, v90, v197
    v_cvt_pk_bf16_f32 v91, v198, v199
    v_lshlrev_b32 v198, 16, v91
    v_and_b32 v199, 0xffff0000, v91
    v_fma_f32 v198, v198, s29, v88
    v_fma_f32 v199, v199, s29, v88
    v_exp_f32 v198, v198
    v_exp_f32 v199, v199
    v_add_f32 v89, v89, v198
    v_add_f32 v90, v90, v199
    v_cvt_pk_bf16_f32 v91, v200, v201
    v_lshlrev_b32 v200, 16, v91
    v_and_b32 v201, 0xffff0000, v91
    v_fma_f32 v200, v200, s29, v88
    v_fma_f32 v201, v201, s29, v88
    v_exp_f32 v200, v200
    v_exp_f32 v201, v201
    v_add_f32 v89, v89, v200
    v_add_f32 v90, v90, v201
    v_cvt_pk_bf16_f32 v91, v202, v203
    v_lshlrev_b32 v202, 16, v91
    v_and_b32 v203, 0xffff0000, v91
    v_fma_f32 v202, v202, s29, v88
    v_fma_f32 v203, v203, s29, v88
    v_exp_f32 v202, v202
    v_exp_f32 v203, v203
    v_add_f32 v89, v89, v202
    v_add_f32 v90, v90, v203
    v_cvt_pk_bf16_f32 v91, v204, v205
    v_lshlrev_b32 v204, 16, v91
    v_and_b32 v205, 0xffff0000, v91
    v_fma_f32 v204, v204, s29, v88
    v_fma_f32 v205, v205, s29, v88
    v_exp_f32 v204, v204
    v_exp_f32 v205, v205
    v_add_f32 v89, v89, v204
    v_add_f32 v90, v90, v205
    v_cvt_pk_bf16_f32 v91, v206, v207
    v_lshlrev_b32 v206, 16, v91
    v_and_b32 v207, 0xffff0000, v91
    v_fma_f32 v206, v206, s29, v88
    v_fma_f32 v207, v207, s29, v88
    v_exp_f32 v206, v206
    v_exp_f32 v207, v207
    v_add_f32 v89, v89, v206
    v_add_f32 v90, v90, v207
    v_cvt_pk_bf16_f32 v91, v208, v209
    v_lshlrev_b32 v208, 16, v91
    v_and_b32 v209, 0xffff0000, v91
    v_fma_f32 v208, v208, s29, v88
    v_fma_f32 v209, v209, s29, v88
    v_exp_f32 v208, v208
    v_exp_f32 v209, v209
    v_add_f32 v89, v89, v208
    v_add_f32 v90, v90, v209
    v_cvt_pk_bf16_f32 v91, v210, v211
    v_lshlrev_b32 v210, 16, v91
    v_and_b32 v211, 0xffff0000, v91
    v_fma_f32 v210, v210, s29, v88
    v_fma_f32 v211, v211, s29, v88
    v_exp_f32 v210, v210
    v_exp_f32 v211, v211
    v_add_f32 v89, v89, v210
    v_add_f32 v90, v90, v211
    v_cvt_pk_bf16_f32 v91, v212, v213
    v_lshlrev_b32 v212, 16, v91
    v_and_b32 v213, 0xffff0000, v91
    v_fma_f32 v212, v212, s29, v88
    v_fma_f32 v213, v213, s29, v88
    v_exp_f32 v212, v212
    v_exp_f32 v213, v213
    v_add_f32 v89, v89, v212
    v_add_f32 v90, v90, v213
    v_cvt_pk_bf16_f32 v91, v214, v215
    v_lshlrev_b32 v214, 16, v91
    v_and_b32 v215, 0xffff0000, v91
    v_fma_f32 v214, v214, s29, v88
    v_fma_f32 v215, v215, s29, v88
    v_exp_f32 v214, v214
    v_exp_f32 v215, v215
    v_add_f32 v89, v89, v214
    v_add_f32 v90, v90, v215
    v_cvt_pk_bf16_f32 v91, v216, v217
    v_lshlrev_b32 v216, 16, v91
    v_and_b32 v217, 0xffff0000, v91
    v_fma_f32 v216, v216, s29, v88
    v_fma_f32 v217, v217, s29, v88
    v_exp_f32 v216, v216
    v_exp_f32 v217, v217
    v_add_f32 v89, v89, v216
    v_add_f32 v90, v90, v217
    v_cvt_pk_bf16_f32 v91, v218, v219
    v_lshlrev_b32 v218, 16, v91
    v_and_b32 v219, 0xffff0000, v91
    v_fma_f32 v218, v218, s29, v88
    v_fma_f32 v219, v219, s29, v88
    v_exp_f32 v218, v218
    v_exp_f32 v219, v219
    v_add_f32 v89, v89, v218
    v_add_f32 v90, v90, v219
    v_cvt_pk_bf16_f32 v91, v220, v221
    v_lshlrev_b32 v220, 16, v91
    v_and_b32 v221, 0xffff0000, v91
    v_fma_f32 v220, v220, s29, v88
    v_fma_f32 v221, v221, s29, v88
    v_exp_f32 v220, v220
    v_exp_f32 v221, v221
    v_add_f32 v89, v89, v220
    v_add_f32 v90, v90, v221
    v_cvt_pk_bf16_f32 v91, v222, v223
    v_lshlrev_b32 v222, 16, v91
    v_and_b32 v223, 0xffff0000, v91
    v_fma_f32 v222, v222, s29, v88
    v_fma_f32 v223, v223, s29, v88
    v_exp_f32 v222, v222
    v_exp_f32 v223, v223
    v_add_f32 v89, v89, v222
    v_add_f32 v90, v90, v223
    v_cvt_pk_bf16_f32 v91, v224, v225
    v_lshlrev_b32 v224, 16, v91
    v_and_b32 v225, 0xffff0000, v91
    v_fma_f32 v224, v224, s29, v88
    v_fma_f32 v225, v225, s29, v88
    v_exp_f32 v224, v224
    v_exp_f32 v225, v225
    v_add_f32 v89, v89, v224
    v_add_f32 v90, v90, v225
    v_cvt_pk_bf16_f32 v91, v226, v227
    v_lshlrev_b32 v226, 16, v91
    v_and_b32 v227, 0xffff0000, v91
    v_fma_f32 v226, v226, s29, v88
    v_fma_f32 v227, v227, s29, v88
    v_exp_f32 v226, v226
    v_exp_f32 v227, v227
    v_add_f32 v89, v89, v226
    v_add_f32 v90, v90, v227
    v_cvt_pk_bf16_f32 v91, v228, v229
    v_lshlrev_b32 v228, 16, v91
    v_and_b32 v229, 0xffff0000, v91
    v_fma_f32 v228, v228, s29, v88
    v_fma_f32 v229, v229, s29, v88
    v_exp_f32 v228, v228
    v_exp_f32 v229, v229
    v_add_f32 v89, v89, v228
    v_add_f32 v90, v90, v229
    v_cvt_pk_bf16_f32 v91, v230, v231
    v_lshlrev_b32 v230, 16, v91
    v_and_b32 v231, 0xffff0000, v91
    v_fma_f32 v230, v230, s29, v88
    v_fma_f32 v231, v231, s29, v88
    v_exp_f32 v230, v230
    v_exp_f32 v231, v231
    v_add_f32 v89, v89, v230
    v_add_f32 v90, v90, v231
    v_cvt_pk_bf16_f32 v91, v232, v233
    v_lshlrev_b32 v232, 16, v91
    v_and_b32 v233, 0xffff0000, v91
    v_fma_f32 v232, v232, s29, v88
    v_fma_f32 v233, v233, s29, v88
    v_exp_f32 v232, v232
    v_exp_f32 v233, v233
    v_add_f32 v89, v89, v232
    v_add_f32 v90, v90, v233
    v_cvt_pk_bf16_f32 v91, v234, v235
    v_lshlrev_b32 v234, 16, v91
    v_and_b32 v235, 0xffff0000, v91
    v_fma_f32 v234, v234, s29, v88
    v_fma_f32 v235, v235, s29, v88
    v_exp_f32 v234, v234
    v_exp_f32 v235, v235
    v_add_f32 v89, v89, v234
    v_add_f32 v90, v90, v235
    v_cvt_pk_bf16_f32 v91, v236, v237
    v_lshlrev_b32 v236, 16, v91
    v_and_b32 v237, 0xffff0000, v91
    v_fma_f32 v236, v236, s29, v88
    v_fma_f32 v237, v237, s29, v88
    v_exp_f32 v236, v236
    v_exp_f32 v237, v237
    v_add_f32 v89, v89, v236
    v_add_f32 v90, v90, v237
    v_cvt_pk_bf16_f32 v91, v238, v239
    v_lshlrev_b32 v238, 16, v91
    v_and_b32 v239, 0xffff0000, v91
    v_fma_f32 v238, v238, s29, v88
    v_fma_f32 v239, v239, s29, v88
    v_exp_f32 v238, v238
    v_exp_f32 v239, v239
    v_add_f32 v89, v89, v238
    v_add_f32 v90, v90, v239
    v_add_f32 v89, v89, v90
    v_mov_b32 v90, v89
    s_nop 1
    v_permlane32_swap_b32 v89, v90
    v_add_f32 v89, v89, v90
    v_rcp_f32 v89, v89
    s_nop 0
    v_mul_f32 v96, v96, v89
    v_mul_f32 v97, v97, v89
    v_cvt_pk_bf16_f32 v96, v96, v97
    v_mul_f32 v98, v98, v89
    v_mul_f32 v99, v99, v89
    v_cvt_pk_bf16_f32 v97, v98, v99
    v_mul_f32 v100, v100, v89
    v_mul_f32 v101, v101, v89
    v_cvt_pk_bf16_f32 v98, v100, v101
    v_mul_f32 v102, v102, v89
    v_mul_f32 v103, v103, v89
    v_cvt_pk_bf16_f32 v99, v102, v103
    v_mul_f32 v104, v104, v89
    v_mul_f32 v105, v105, v89
    v_cvt_pk_bf16_f32 v100, v104, v105
    v_mul_f32 v106, v106, v89
    v_mul_f32 v107, v107, v89
    v_cvt_pk_bf16_f32 v101, v106, v107
    v_mul_f32 v108, v108, v89
    v_mul_f32 v109, v109, v89
    v_cvt_pk_bf16_f32 v102, v108, v109
    v_mul_f32 v110, v110, v89
    v_mul_f32 v111, v111, v89
    v_cvt_pk_bf16_f32 v103, v110, v111
    v_mul_f32 v112, v112, v89
    v_mul_f32 v113, v113, v89
    v_cvt_pk_bf16_f32 v104, v112, v113
    v_mul_f32 v114, v114, v89
    v_mul_f32 v115, v115, v89
    v_cvt_pk_bf16_f32 v105, v114, v115
    v_mul_f32 v116, v116, v89
    v_mul_f32 v117, v117, v89
    v_cvt_pk_bf16_f32 v106, v116, v117
    v_mul_f32 v118, v118, v89
    v_mul_f32 v119, v119, v89
    v_cvt_pk_bf16_f32 v107, v118, v119
    v_mul_f32 v120, v120, v89
    v_mul_f32 v121, v121, v89
    v_cvt_pk_bf16_f32 v108, v120, v121
    v_mul_f32 v122, v122, v89
    v_mul_f32 v123, v123, v89
    v_cvt_pk_bf16_f32 v109, v122, v123
    v_mul_f32 v124, v124, v89
    v_mul_f32 v125, v125, v89
    v_cvt_pk_bf16_f32 v110, v124, v125
    v_mul_f32 v126, v126, v89
    v_mul_f32 v127, v127, v89
    v_cvt_pk_bf16_f32 v111, v126, v127
    v_mul_f32 v128, v128, v89
    v_mul_f32 v129, v129, v89
    v_cvt_pk_bf16_f32 v112, v128, v129
    v_mul_f32 v130, v130, v89
    v_mul_f32 v131, v131, v89
    v_cvt_pk_bf16_f32 v113, v130, v131
    v_mul_f32 v132, v132, v89
    v_mul_f32 v133, v133, v89
    v_cvt_pk_bf16_f32 v114, v132, v133
    v_mul_f32 v134, v134, v89
    v_mul_f32 v135, v135, v89
    v_cvt_pk_bf16_f32 v115, v134, v135
    v_mul_f32 v136, v136, v89
    v_mul_f32 v137, v137, v89
    v_cvt_pk_bf16_f32 v116, v136, v137
    v_mul_f32 v138, v138, v89
    v_mul_f32 v139, v139, v89
    v_cvt_pk_bf16_f32 v117, v138, v139
    v_mul_f32 v140, v140, v89
    v_mul_f32 v141, v141, v89
    v_cvt_pk_bf16_f32 v118, v140, v141
    v_mul_f32 v142, v142, v89
    v_mul_f32 v143, v143, v89
    v_cvt_pk_bf16_f32 v119, v142, v143
    v_mul_f32 v144, v144, v89
    v_mul_f32 v145, v145, v89
    v_cvt_pk_bf16_f32 v120, v144, v145
    v_mul_f32 v146, v146, v89
    v_mul_f32 v147, v147, v89
    v_cvt_pk_bf16_f32 v121, v146, v147
    v_mul_f32 v148, v148, v89
    v_mul_f32 v149, v149, v89
    v_cvt_pk_bf16_f32 v122, v148, v149
    v_mul_f32 v150, v150, v89
    v_mul_f32 v151, v151, v89
    v_cvt_pk_bf16_f32 v123, v150, v151
    v_mul_f32 v152, v152, v89
    v_mul_f32 v153, v153, v89
    v_cvt_pk_bf16_f32 v124, v152, v153
    v_mul_f32 v154, v154, v89
    v_mul_f32 v155, v155, v89
    v_cvt_pk_bf16_f32 v125, v154, v155
    v_mul_f32 v156, v156, v89
    v_mul_f32 v157, v157, v89
    v_cvt_pk_bf16_f32 v126, v156, v157
    v_mul_f32 v158, v158, v89
    v_mul_f32 v159, v159, v89
    v_cvt_pk_bf16_f32 v127, v158, v159
    v_mul_f32 v160, v160, v89
    v_mul_f32 v161, v161, v89
    v_cvt_pk_bf16_f32 v128, v160, v161
    v_mul_f32 v162, v162, v89
    v_mul_f32 v163, v163, v89
    v_cvt_pk_bf16_f32 v129, v162, v163
    v_mul_f32 v164, v164, v89
    v_mul_f32 v165, v165, v89
    v_cvt_pk_bf16_f32 v130, v164, v165
    v_mul_f32 v166, v166, v89
    v_mul_f32 v167, v167, v89
    v_cvt_pk_bf16_f32 v131, v166, v167
    v_mul_f32 v168, v168, v89
    v_mul_f32 v169, v169, v89
    v_cvt_pk_bf16_f32 v132, v168, v169
    v_mul_f32 v170, v170, v89
    v_mul_f32 v171, v171, v89
    v_cvt_pk_bf16_f32 v133, v170, v171
    v_mul_f32 v172, v172, v89
    v_mul_f32 v173, v173, v89
    v_cvt_pk_bf16_f32 v134, v172, v173
    v_mul_f32 v174, v174, v89
    v_mul_f32 v175, v175, v89
    v_cvt_pk_bf16_f32 v135, v174, v175
    v_mul_f32 v176, v176, v89
    v_mul_f32 v177, v177, v89
    v_cvt_pk_bf16_f32 v136, v176, v177
    v_mul_f32 v178, v178, v89
    v_mul_f32 v179, v179, v89
    v_cvt_pk_bf16_f32 v137, v178, v179
    v_mul_f32 v180, v180, v89
    v_mul_f32 v181, v181, v89
    v_cvt_pk_bf16_f32 v138, v180, v181
    v_mul_f32 v182, v182, v89
    v_mul_f32 v183, v183, v89
    v_cvt_pk_bf16_f32 v139, v182, v183
    v_mul_f32 v184, v184, v89
    v_mul_f32 v185, v185, v89
    v_cvt_pk_bf16_f32 v140, v184, v185
    v_mul_f32 v186, v186, v89
    v_mul_f32 v187, v187, v89
    v_cvt_pk_bf16_f32 v141, v186, v187
    v_mul_f32 v188, v188, v89
    v_mul_f32 v189, v189, v89
    v_cvt_pk_bf16_f32 v142, v188, v189
    v_mul_f32 v190, v190, v89
    v_mul_f32 v191, v191, v89
    v_cvt_pk_bf16_f32 v143, v190, v191
    v_mul_f32 v192, v192, v89
    v_mul_f32 v193, v193, v89
    v_cvt_pk_bf16_f32 v144, v192, v193
    v_mul_f32 v194, v194, v89
    v_mul_f32 v195, v195, v89
    v_cvt_pk_bf16_f32 v145, v194, v195
    v_mul_f32 v196, v196, v89
    v_mul_f32 v197, v197, v89
    v_cvt_pk_bf16_f32 v146, v196, v197
    v_mul_f32 v198, v198, v89
    v_mul_f32 v199, v199, v89
    v_cvt_pk_bf16_f32 v147, v198, v199
    v_mul_f32 v200, v200, v89
    v_mul_f32 v201, v201, v89
    v_cvt_pk_bf16_f32 v148, v200, v201
    v_mul_f32 v202, v202, v89
    v_mul_f32 v203, v203, v89
    v_cvt_pk_bf16_f32 v149, v202, v203
    v_mul_f32 v204, v204, v89
    v_mul_f32 v205, v205, v89
    v_cvt_pk_bf16_f32 v150, v204, v205
    v_mul_f32 v206, v206, v89
    v_mul_f32 v207, v207, v89
    v_cvt_pk_bf16_f32 v151, v206, v207
    v_mul_f32 v208, v208, v89
    v_mul_f32 v209, v209, v89
    v_cvt_pk_bf16_f32 v152, v208, v209
    v_mul_f32 v210, v210, v89
    v_mul_f32 v211, v211, v89
    v_cvt_pk_bf16_f32 v153, v210, v211
    v_mul_f32 v212, v212, v89
    v_mul_f32 v213, v213, v89
    v_cvt_pk_bf16_f32 v154, v212, v213
    v_mul_f32 v214, v214, v89
    v_mul_f32 v215, v215, v89
    v_cvt_pk_bf16_f32 v155, v214, v215
    v_mul_f32 v216, v216, v89
    v_mul_f32 v217, v217, v89
    v_cvt_pk_bf16_f32 v156, v216, v217
    v_mul_f32 v218, v218, v89
    v_mul_f32 v219, v219, v89
    v_cvt_pk_bf16_f32 v157, v218, v219
    v_mul_f32 v220, v220, v89
    v_mul_f32 v221, v221, v89
    v_cvt_pk_bf16_f32 v158, v220, v221
    v_mul_f32 v222, v222, v89
    v_mul_f32 v223, v223, v89
    v_cvt_pk_bf16_f32 v159, v222, v223
    v_mul_f32 v224, v224, v89
    v_mul_f32 v225, v225, v89
    v_cvt_pk_bf16_f32 v160, v224, v225
    v_mul_f32 v226, v226, v89
    v_mul_f32 v227, v227, v89
    v_cvt_pk_bf16_f32 v161, v226, v227
    v_mul_f32 v228, v228, v89
    v_mul_f32 v229, v229, v89
    v_cvt_pk_bf16_f32 v162, v228, v229
    v_mul_f32 v230, v230, v89
    v_mul_f32 v231, v231, v89
    v_cvt_pk_bf16_f32 v163, v230, v231
    v_mul_f32 v232, v232, v89
    v_mul_f32 v233, v233, v89
    v_cvt_pk_bf16_f32 v164, v232, v233
    v_mul_f32 v234, v234, v89
    v_mul_f32 v235, v235, v89
    v_cvt_pk_bf16_f32 v165, v234, v235
    v_mul_f32 v236, v236, v89
    v_mul_f32 v237, v237, v89
    v_cvt_pk_bf16_f32 v166, v236, v237
    v_mul_f32 v238, v238, v89
    v_mul_f32 v239, v239, v89
    v_cvt_pk_bf16_f32 v167, v238, v239
    s_waitcnt vmcnt(0)
    v_permlane16_swap_b32 v96, v100
    v_permlane16_swap_b32 v97, v101
    v_permlane16_swap_b32 v98, v102
    v_permlane16_swap_b32 v99, v103
    s_nop 1
    v_mfma_f32_16x16x32_bf16 v[80:83], v[44:47], v[96:99], 0
    v_mfma_f32_16x16x32_bf16 v[84:87], v[44:47], v[100:103], 0
    v_permlane16_swap_b32 v104, v108
    v_permlane16_swap_b32 v105, v109
    v_permlane16_swap_b32 v106, v110
    v_permlane16_swap_b32 v107, v111
    s_nop 1
    v_mfma_f32_16x16x32_bf16 v[80:83], v[48:51], v[104:107], v[80:83]
    v_mfma_f32_16x16x32_bf16 v[84:87], v[48:51], v[108:111], v[84:87]
    v_permlane16_swap_b32 v112, v116
    v_permlane16_swap_b32 v113, v117
    v_permlane16_swap_b32 v114, v118
    v_permlane16_swap_b32 v115, v119
    s_nop 1
    v_mfma_f32_16x16x32_bf16 v[80:83], v[52:55], v[112:115], v[80:83]
    v_mfma_f32_16x16x32_bf16 v[84:87], v[52:55], v[116:119], v[84:87]
    v_permlane16_swap_b32 v120, v124
    v_permlane16_swap_b32 v121, v125
    v_permlane16_swap_b32 v122, v126
    v_permlane16_swap_b32 v123, v127
    s_nop 1
    v_mfma_f32_16x16x32_bf16 v[80:83], v[56:59], v[120:123], v[80:83]
    v_mfma_f32_16x16x32_bf16 v[84:87], v[56:59], v[124:127], v[84:87]
    v_permlane16_swap_b32 v128, v132
    v_permlane16_swap_b32 v129, v133
    v_permlane16_swap_b32 v130, v134
    v_permlane16_swap_b32 v131, v135
    s_nop 1
    v_mfma_f32_16x16x32_bf16 v[80:83], v[60:63], v[128:131], v[80:83]
    v_mfma_f32_16x16x32_bf16 v[84:87], v[60:63], v[132:135], v[84:87]
    v_permlane16_swap_b32 v136, v140
    v_permlane16_swap_b32 v137, v141
    v_permlane16_swap_b32 v138, v142
    v_permlane16_swap_b32 v139, v143
    s_nop 1
    v_mfma_f32_16x16x32_bf16 v[80:83], v[64:67], v[136:139], v[80:83]
    v_mfma_f32_16x16x32_bf16 v[84:87], v[64:67], v[140:143], v[84:87]
    v_permlane16_swap_b32 v144, v148
    v_permlane16_swap_b32 v145, v149
    v_permlane16_swap_b32 v146, v150
    v_permlane16_swap_b32 v147, v151
    s_nop 1
    v_mfma_f32_16x16x32_bf16 v[80:83], v[68:71], v[144:147], v[80:83]
    v_mfma_f32_16x16x32_bf16 v[84:87], v[68:71], v[148:151], v[84:87]
    v_permlane16_swap_b32 v152, v156
    v_permlane16_swap_b32 v153, v157
    v_permlane16_swap_b32 v154, v158
    v_permlane16_swap_b32 v155, v159
    s_nop 1
    v_mfma_f32_16x16x32_bf16 v[80:83], v[72:75], v[152:155], v[80:83]
    v_mfma_f32_16x16x32_bf16 v[84:87], v[72:75], v[156:159], v[84:87]
    v_permlane16_swap_b32 v160, v164
    v_permlane16_swap_b32 v161, v165
    v_permlane16_swap_b32 v162, v166
    v_permlane16_swap_b32 v163, v167
    s_nop 1
    v_mfma_f32_16x16x32_bf16 v[80:83], v[76:79], v[160:163], v[80:83]
    v_mfma_f32_16x16x32_bf16 v[84:87], v[76:79], v[164:167], v[84:87]
    v_and_b32 v2, 15, v1
    v_lshlrev_b32 v2, 5, v2
    v_lshrrev_b32 v3, 4, v1
    v_lshl_add_u32 v2, v3, 3, v2
    s_nop 2
    v_cvt_pk_bf16_f32 v92, v80, v81
    v_cvt_pk_bf16_f32 v93, v82, v83
    v_cvt_pk_bf16_f32 v94, v84, v85
    v_cvt_pk_bf16_f32 v95, v86, v87
    buffer_store_dwordx2 v[92:93], v2, s[24:27], s11 offen
    buffer_store_dwordx2 v[94:95], v2, s[24:27], s11 offen offset:512
    s_waitcnt vmcnt(0)
    s_nop 0
L_k2_end:
    s_endpgm
.globl k3_out_kernel
.p2align 8
.type k3_out_kernel,@function
k3_out_kernel:
    s_cmp_ge_u32 s2, 256
    s_cbranch_scc1 L_k3_end
    s_load_dwordx2 s[4:5], s[0:1], 0
    s_load_dwordx2 s[6:7], s[0:1], 16
    s_load_dwordx2 s[8:9], s[0:1], 48
    s_load_dwordx2 s[10:11], s[0:1], 56
    s_load_dwordx2 s[12:13], s[0:1], 72
    s_and_b32 s3, s2, 7
    s_lshr_b32 s14, s2, 3
    s_and_b32 s15, s14, 3
    s_lshl_b32 s3, s3, 2
    s_add_u32 s15, s15, s3
    s_lshr_b32 s14, s14, 2
    v_and_b32 v1, 63, v0
    v_lshrrev_b32 v2, 6, v0
    s_nop 0
    v_readfirstlane_b32 s16, v2
    s_lshr_b32 s17, s16, 1
    s_and_b32 s18, s16, 1
    v_and_b32 v2, 31, v1
    v_lshrrev_b32 v3, 5, v1
    s_lshl_b32 s19, s15, 6
    s_lshl_b32 s3, s17, 5
    s_add_u32 s19, s19, s3
    v_add_u32 v4, s19, v2
    v_lshlrev_b32 v5, 5, v4
    v_lshl_add_u32 v5, v3, 4, v5
    s_waitcnt lgkmcnt(0)
    s_mov_b32 s20, s12
    s_mov_b32 s21, s13
    s_mov_b32 s22, 16777216
    s_mov_b32 s23, 0x00020000
    s_mov_b32 s24, s6
    s_mov_b32 s25, s7
    s_mov_b32 s26, 524288
    s_mov_b32 s27, 0x00020000
    s_mov_b32 s28, s8
    s_mov_b32 s29, s9
    s_mov_b32 s30, 1409024
    s_mov_b32 s31, 0x00020000
    v_lshrrev_b32 v6, 3, v1
    v_and_b32 v7, 7, v1
    v_lshrrev_b32 v8, 1, v7
    v_and_b32 v9, 1, v7
    v_lshrrev_b32 v10, 1, v6
    v_and_b32 v10, 1, v10
    v_lshlrev_b32 v10, 1, v10
    v_xor_b32 v8, v8, v10
    v_lshlrev_b32 v8, 5, v8
    v_lshl_add_u32 v8, v9, 4, v8
    v_lshl_add_u32 v8, v6, 10, v8
    s_lshl_b32 s3, s14, 7
    v_add_u32 v8, s3, v8
    s_lshl_b32 s3, s16, 13
    v_add_u32 v8, s3, v8
    s_lshl_b32 s32, s16, 10
    v_lshrrev_b32 v6, 4, v1
    v_and_b32 v6, 1, v6
    v_lshrrev_b32 v7, 2, v1
    v_and_b32 v7, 3, v7
    v_and_b32 v9, 3, v1
    v_lshlrev_b32 v10, 1, v9
    v_and_b32 v10, 2, v10
    v_lshrrev_b32 v11, 1, v9
    v_or_b32 v10, v10, v11
    s_lshl_b32 s3, s18, 1
    v_add_u32 v6, s3, v6
    v_lshrrev_b32 v11, 1, v7
    v_lshlrev_b32 v11, 1, v11
    v_xor_b32 v6, v6, v11
    v_lshl_add_u32 v7, v3, 3, v7
    v_lshlrev_b32 v7, 7, v7
    v_lshl_add_u32 v7, v6, 5, v7
    v_lshl_add_u32 v7, v10, 3, v7
    s_lshl_b32 s44, s15, 11
    s_lshr_b32 s3, s16, 1
    s_lshl_b32 s3, s3, 16
    s_add_u32 s44, s44, s3
    s_and_b32 s3, s16, 1
    s_lshl_b32 s3, s3, 10
    s_add_u32 s44, s44, s3
    v_lshlrev_b32 v9, 4, v1
    s_lshl_b32 s3, s17, 5
    v_add_u32 v10, s3, v2
    v_lshlrev_b32 v10, 5, v10
    v_lshl_add_u32 v10, v3, 4, v10
    v_add_u32 v10, 16384, v10
    s_mov_b32 s33, 0
    s_add_u32 m0, s32, 0
    s_nop 0
    buffer_load_dwordx4 v8, s[24:27], s33 offen lds
    s_mov_b32 s33, 32768
    s_add_u32 m0, s32, 4096
    s_nop 0
    buffer_load_dwordx4 v8, s[24:27], s33 offen lds
    s_mov_b32 s33, 65536
    s_add_u32 m0, s32, 8192
    s_nop 0
    buffer_load_dwordx4 v8, s[24:27], s33 offen lds
    s_mov_b32 s33, 98304
    s_add_u32 m0, s32, 12288
    s_nop 0
    buffer_load_dwordx4 v8, s[24:27], s33 offen lds
    s_add_u32 s33, s44, 14680064
    s_add_u32 m0, s32, 16384
    s_nop 0
    buffer_load_dwordx4 v9, s[20:23], s33 offen lds
    s_add_u32 s33, s44, 14811136
    s_add_u32 m0, s32, 20480
    s_nop 0
    buffer_load_dwordx4 v9, s[20:23], s33 offen lds
    s_add_u32 s33, s44, 14942208
    s_add_u32 m0, s32, 24576
    s_nop 0
    buffer_load_dwordx4 v9, s[20:23], s33 offen lds
    s_add_u32 s33, s44, 15073280
    s_add_u32 m0, s32, 28672
    s_nop 0
    buffer_load_dwordx4 v9, s[20:23], s33 offen lds
    s_mov_b32 s33, 131072
    s_add_u32 m0, s32, 32768
    s_nop 0
    buffer_load_dwordx4 v8, s[24:27], s33 offen lds
    s_mov_b32 s33, 163840
    s_add_u32 m0, s32, 36864
    s_nop 0
    buffer_load_dwordx4 v8, s[24:27], s33 offen lds
    s_mov_b32 s33, 196608
    s_add_u32 m0, s32, 40960
    s_nop 0
    buffer_load_dwordx4 v8, s[24:27], s33 offen lds
    s_mov_b32 s33, 229376
    s_add_u32 m0, s32, 45056
    s_nop 0
    buffer_load_dwordx4 v8, s[24:27], s33 offen lds
    s_add_u32 s33, s44, 15204352
    s_add_u32 m0, s32, 49152
    s_nop 0
    buffer_load_dwordx4 v9, s[20:23], s33 offen lds
    s_add_u32 s33, s44, 15335424
    s_add_u32 m0, s32, 53248
    s_nop 0
    buffer_load_dwordx4 v9, s[20:23], s33 offen lds
    s_add_u32 s33, s44, 15466496
    s_add_u32 m0, s32, 57344
    s_nop 0
    buffer_load_dwordx4 v9, s[20:23], s33 offen lds
    s_add_u32 s33, s44, 15597568
    s_add_u32 m0, s32, 61440
    s_nop 0
    buffer_load_dwordx4 v9, s[20:23], s33 offen lds
    s_mov_b32 s33, 262144
    s_add_u32 m0, s32, 65536
    s_nop 0
    buffer_load_dwordx4 v8, s[24:27], s33 offen lds
    s_mov_b32 s33, 294912
    s_add_u32 m0, s32, 69632
    s_nop 0
    buffer_load_dwordx4 v8, s[24:27], s33 offen lds
    s_mov_b32 s33, 327680
    s_add_u32 m0, s32, 73728
    s_nop 0
    buffer_load_dwordx4 v8, s[24:27], s33 offen lds
    s_mov_b32 s33, 360448
    s_add_u32 m0, s32, 77824
    s_nop 0
    buffer_load_dwordx4 v8, s[24:27], s33 offen lds
    s_add_u32 s33, s44, 15728640
    s_add_u32 m0, s32, 81920
    s_nop 0
    buffer_load_dwordx4 v9, s[20:23], s33 offen lds
    s_add_u32 s33, s44, 15859712
    s_add_u32 m0, s32, 86016
    s_nop 0
    buffer_load_dwordx4 v9, s[20:23], s33 offen lds
    s_add_u32 s33, s44, 15990784
    s_add_u32 m0, s32, 90112
    s_nop 0
    buffer_load_dwordx4 v9, s[20:23], s33 offen lds
    s_add_u32 s33, s44, 16121856
    s_add_u32 m0, s32, 94208
    s_nop 0
    buffer_load_dwordx4 v9, s[20:23], s33 offen lds
    s_waitcnt vmcnt(16)
    s_barrier
    s_mov_b32 s33, 393216
    s_add_u32 m0, s32, 98304
    s_nop 0
    buffer_load_dwordx4 v8, s[24:27], s33 offen lds
    s_mov_b32 s33, 425984
    s_add_u32 m0, s32, 102400
    s_nop 0
    buffer_load_dwordx4 v8, s[24:27], s33 offen lds
    s_mov_b32 s33, 458752
    s_add_u32 m0, s32, 106496
    s_nop 0
    buffer_load_dwordx4 v8, s[24:27], s33 offen lds
    s_mov_b32 s33, 491520
    s_add_u32 m0, s32, 110592
    s_nop 0
    buffer_load_dwordx4 v8, s[24:27], s33 offen lds
    s_add_u32 s33, s44, 16252928
    s_add_u32 m0, s32, 114688
    s_nop 0
    buffer_load_dwordx4 v9, s[20:23], s33 offen lds
    s_add_u32 s33, s44, 16384000
    s_add_u32 m0, s32, 118784
    s_nop 0
    buffer_load_dwordx4 v9, s[20:23], s33 offen lds
    s_add_u32 s33, s44, 16515072
    s_add_u32 m0, s32, 122880
    s_nop 0
    buffer_load_dwordx4 v9, s[20:23], s33 offen lds
    s_add_u32 s33, s44, 16646144
    s_add_u32 m0, s32, 126976
    s_nop 0
    buffer_load_dwordx4 v9, s[20:23], s33 offen lds
    v_add_u32 v132, 0, v7
    v_add_u32 v11, 0, v10
    ds_read_b64_tr_b16 v[112:113], v132 offset:0
    ds_read_b64_tr_b16 v[114:115], v132 offset:512
    ds_read_b128 v[48:51], v11 offset:0
    ds_read_b64_tr_b16 v[116:117], v132 offset:2048
    ds_read_b64_tr_b16 v[118:119], v132 offset:2560
    ds_read_b128 v[52:55], v11 offset:2048
    ds_read_b64_tr_b16 v[120:121], v132 offset:4096
    ds_read_b64_tr_b16 v[122:123], v132 offset:4608
    ds_read_b128 v[56:59], v11 offset:4096
    ds_read_b64_tr_b16 v[124:125], v132 offset:6144
    ds_read_b64_tr_b16 v[126:127], v132 offset:6656
    ds_read_b128 v[60:63], v11 offset:6144
    s_waitcnt lgkmcnt(9)
    v_mfma_f32_32x32x16_bf16 v[16:31], v[112:115], v[48:51], 0
    ds_read_b64_tr_b16 v[128:129], v132 offset:8192
    ds_read_b64_tr_b16 v[130:131], v132 offset:8704
    ds_read_b128 v[64:67], v11 offset:8192
    s_waitcnt lgkmcnt(9)
    v_mfma_f32_32x32x16_bf16 v[16:31], v[116:119], v[52:55], v[16:31]
    ds_read_b64_tr_b16 v[112:113], v132 offset:10240
    ds_read_b64_tr_b16 v[114:115], v132 offset:10752
    ds_read_b128 v[48:51], v11 offset:10240
    s_waitcnt lgkmcnt(9)
    v_mfma_f32_32x32x16_bf16 v[16:31], v[120:123], v[56:59], v[16:31]
    ds_read_b64_tr_b16 v[116:117], v132 offset:12288
    ds_read_b64_tr_b16 v[118:119], v132 offset:12800
    ds_read_b128 v[52:55], v11 offset:12288
    s_waitcnt lgkmcnt(9)
    v_mfma_f32_32x32x16_bf16 v[16:31], v[124:127], v[60:63], v[16:31]
    ds_read_b64_tr_b16 v[120:121], v132 offset:14336
    ds_read_b64_tr_b16 v[122:123], v132 offset:14848
    ds_read_b128 v[56:59], v11 offset:14336
    s_waitcnt lgkmcnt(9)
    v_mfma_f32_32x32x16_bf16 v[16:31], v[128:131], v[64:67], v[16:31]
    s_waitcnt vmcnt(16)
    s_barrier
    s_mov_b32 s33, 0
    s_add_u32 m0, s32, 131072
    s_nop 0
    buffer_load_dwordx4 v8, s[28:31], s33 offen lds
    s_mov_b32 s33, 32768
    s_add_u32 m0, s32, 135168
    s_nop 0
    buffer_load_dwordx4 v8, s[28:31], s33 offen lds
    s_mov_b32 s33, 65536
    s_add_u32 m0, s32, 139264
    s_nop 0
    buffer_load_dwordx4 v8, s[28:31], s33 offen lds
    s_mov_b32 s33, 98304
    s_add_u32 m0, s32, 143360
    s_nop 0
    buffer_load_dwordx4 v8, s[28:31], s33 offen lds
    s_add_u32 s33, s44, 8388608
    s_add_u32 m0, s32, 147456
    s_nop 0
    buffer_load_dwordx4 v9, s[20:23], s33 offen lds
    s_add_u32 s33, s44, 8519680
    s_add_u32 m0, s32, 151552
    s_nop 0
    buffer_load_dwordx4 v9, s[20:23], s33 offen lds
    s_add_u32 s33, s44, 8650752
    s_add_u32 m0, s32, 155648
    s_nop 0
    buffer_load_dwordx4 v9, s[20:23], s33 offen lds
    s_add_u32 s33, s44, 8781824
    s_add_u32 m0, s32, 159744
    s_nop 0
    buffer_load_dwordx4 v9, s[20:23], s33 offen lds
    v_add_u32 v133, 32768, v7
    v_add_u32 v12, 32768, v10
    ds_read_b64_tr_b16 v[124:125], v133 offset:0
    ds_read_b64_tr_b16 v[126:127], v133 offset:512
    ds_read_b128 v[60:63], v12 offset:0
    s_waitcnt lgkmcnt(9)
    v_mfma_f32_32x32x16_bf16 v[16:31], v[112:115], v[48:51], v[16:31]
    ds_read_b64_tr_b16 v[128:129], v133 offset:2048
    ds_read_b64_tr_b16 v[130:131], v133 offset:2560
    ds_read_b128 v[64:67], v12 offset:2048
    s_waitcnt lgkmcnt(9)
    v_mfma_f32_32x32x16_bf16 v[16:31], v[116:119], v[52:55], v[16:31]
    ds_read_b64_tr_b16 v[112:113], v133 offset:4096
    ds_read_b64_tr_b16 v[114:115], v133 offset:4608
    ds_read_b128 v[48:51], v12 offset:4096
    s_waitcnt lgkmcnt(9)
    v_mfma_f32_32x32x16_bf16 v[16:31], v[120:123], v[56:59], v[16:31]
    ds_read_b64_tr_b16 v[116:117], v133 offset:6144
    ds_read_b64_tr_b16 v[118:119], v133 offset:6656
    ds_read_b128 v[52:55], v12 offset:6144
    s_waitcnt lgkmcnt(9)
    v_mfma_f32_32x32x16_bf16 v[16:31], v[124:127], v[60:63], v[16:31]
    ds_read_b64_tr_b16 v[120:121], v133 offset:8192
    ds_read_b64_tr_b16 v[122:123], v133 offset:8704
    ds_read_b128 v[56:59], v12 offset:8192
    s_waitcnt lgkmcnt(9)
    v_mfma_f32_32x32x16_bf16 v[16:31], v[128:131], v[64:67], v[16:31]
    ds_read_b64_tr_b16 v[124:125], v133 offset:10240
    ds_read_b64_tr_b16 v[126:127], v133 offset:10752
    ds_read_b128 v[60:63], v12 offset:10240
    s_waitcnt lgkmcnt(9)
    v_mfma_f32_32x32x16_bf16 v[16:31], v[112:115], v[48:51], v[16:31]
    ds_read_b64_tr_b16 v[128:129], v133 offset:12288
    ds_read_b64_tr_b16 v[130:131], v133 offset:12800
    ds_read_b128 v[64:67], v12 offset:12288
    s_waitcnt lgkmcnt(9)
    v_mfma_f32_32x32x16_bf16 v[16:31], v[116:119], v[52:55], v[16:31]
    ds_read_b64_tr_b16 v[112:113], v133 offset:14336
    ds_read_b64_tr_b16 v[114:115], v133 offset:14848
    ds_read_b128 v[48:51], v12 offset:14336
    s_waitcnt lgkmcnt(9)
    v_mfma_f32_32x32x16_bf16 v[16:31], v[120:123], v[56:59], v[16:31]
    s_waitcnt vmcnt(16)
    s_barrier
    s_mov_b32 s33, 131072
    s_add_u32 m0, s32, 0
    s_nop 0
    buffer_load_dwordx4 v8, s[28:31], s33 offen lds
    s_mov_b32 s33, 163840
    s_add_u32 m0, s32, 4096
    s_nop 0
    buffer_load_dwordx4 v8, s[28:31], s33 offen lds
    s_mov_b32 s33, 196608
    s_add_u32 m0, s32, 8192
    s_nop 0
    buffer_load_dwordx4 v8, s[28:31], s33 offen lds
    s_mov_b32 s33, 229376
    s_add_u32 m0, s32, 12288
    s_nop 0
    buffer_load_dwordx4 v8, s[28:31], s33 offen lds
    s_add_u32 s33, s44, 8912896
    s_add_u32 m0, s32, 16384
    s_nop 0
    buffer_load_dwordx4 v9, s[20:23], s33 offen lds
    s_add_u32 s33, s44, 9043968
    s_add_u32 m0, s32, 20480
    s_nop 0
    buffer_load_dwordx4 v9, s[20:23], s33 offen lds
    s_add_u32 s33, s44, 9175040
    s_add_u32 m0, s32, 24576
    s_nop 0
    buffer_load_dwordx4 v9, s[20:23], s33 offen lds
    s_add_u32 s33, s44, 9306112
    s_add_u32 m0, s32, 28672
    s_nop 0
    buffer_load_dwordx4 v9, s[20:23], s33 offen lds
    v_add_u32 v132, 65536, v7
    v_add_u32 v11, 65536, v10
    ds_read_b64_tr_b16 v[116:117], v132 offset:0
    ds_read_b64_tr_b16 v[118:119], v132 offset:512
    ds_read_b128 v[52:55], v11 offset:0
    s_waitcnt lgkmcnt(9)
    v_mfma_f32_32x32x16_bf16 v[16:31], v[124:127], v[60:63], v[16:31]
    ds_read_b64_tr_b16 v[120:121], v132 offset:2048
    ds_read_b64_tr_b16 v[122:123], v132 offset:2560
    ds_read_b128 v[56:59], v11 offset:2048
    s_waitcnt lgkmcnt(9)
    v_mfma_f32_32x32x16_bf16 v[16:31], v[128:131], v[64:67], v[16:31]
    ds_read_b64_tr_b16 v[124:125], v132 offset:4096
    ds_read_b64_tr_b16 v[126:127], v132 offset:4608
    ds_read_b128 v[60:63], v11 offset:4096
    s_waitcnt lgkmcnt(9)
    v_mfma_f32_32x32x16_bf16 v[16:31], v[112:115], v[48:51], v[16:31]
    ds_read_b64_tr_b16 v[128:129], v132 offset:6144
    ds_read_b64_tr_b16 v[130:131], v132 offset:6656
    ds_read_b128 v[64:67], v11 offset:6144
    s_waitcnt lgkmcnt(9)
    v_mfma_f32_32x32x16_bf16 v[16:31], v[116:119], v[52:55], v[16:31]
    ds_read_b64_tr_b16 v[112:113], v132 offset:8192
    ds_read_b64_tr_b16 v[114:115], v132 offset:8704
    ds_read_b128 v[48:51], v11 offset:8192
    s_waitcnt lgkmcnt(9)
    v_mfma_f32_32x32x16_bf16 v[16:31], v[120:123], v[56:59], v[16:31]
    ds_read_b64_tr_b16 v[116:117], v132 offset:10240
    ds_read_b64_tr_b16 v[118:119], v132 offset:10752
    ds_read_b128 v[52:55], v11 offset:10240
    s_waitcnt lgkmcnt(9)
    v_mfma_f32_32x32x16_bf16 v[16:31], v[124:127], v[60:63], v[16:31]
    ds_read_b64_tr_b16 v[120:121], v132 offset:12288
    ds_read_b64_tr_b16 v[122:123], v132 offset:12800
    ds_read_b128 v[56:59], v11 offset:12288
    s_waitcnt lgkmcnt(9)
    v_mfma_f32_32x32x16_bf16 v[16:31], v[128:131], v[64:67], v[16:31]
    ds_read_b64_tr_b16 v[124:125], v132 offset:14336
    ds_read_b64_tr_b16 v[126:127], v132 offset:14848
    ds_read_b128 v[60:63], v11 offset:14336
    s_waitcnt lgkmcnt(9)
    v_mfma_f32_32x32x16_bf16 v[16:31], v[112:115], v[48:51], v[16:31]
    s_waitcnt vmcnt(16)
    s_barrier
    s_mov_b32 s33, 262144
    s_add_u32 m0, s32, 32768
    s_nop 0
    buffer_load_dwordx4 v8, s[28:31], s33 offen lds
    s_mov_b32 s33, 294912
    s_add_u32 m0, s32, 36864
    s_nop 0
    buffer_load_dwordx4 v8, s[28:31], s33 offen lds
    s_mov_b32 s33, 327680
    s_add_u32 m0, s32, 40960
    s_nop 0
    buffer_load_dwordx4 v8, s[28:31], s33 offen lds
    s_mov_b32 s33, 360448
    s_add_u32 m0, s32, 45056
    s_nop 0
    buffer_load_dwordx4 v8, s[28:31], s33 offen lds
    s_add_u32 s33, s44, 9437184
    s_add_u32 m0, s32, 49152
    s_nop 0
    buffer_load_dwordx4 v9, s[20:23], s33 offen lds
    s_add_u32 s33, s44, 9568256
    s_add_u32 m0, s32, 53248
    s_nop 0
    buffer_load_dwordx4 v9, s[20:23], s33 offen lds
    s_add_u32 s33, s44, 9699328
    s_add_u32 m0, s32, 57344
    s_nop 0
    buffer_load_dwordx4 v9, s[20:23], s33 offen lds
    s_add_u32 s33, s44, 9830400
    s_add_u32 m0, s32, 61440
    s_nop 0
    buffer_load_dwordx4 v9, s[20:23], s33 offen lds
    v_add_u32 v133, 98304, v7
    v_add_u32 v12, 98304, v10
    ds_read_b64_tr_b16 v[128:129], v133 offset:0
    ds_read_b64_tr_b16 v[130:131], v133 offset:512
    ds_read_b128 v[64:67], v12 offset:0
    s_waitcnt lgkmcnt(9)
    v_mfma_f32_32x32x16_bf16 v[16:31], v[116:119], v[52:55], v[16:31]
    ds_read_b64_tr_b16 v[112:113], v133 offset:2048
    ds_read_b64_tr_b16 v[114:115], v133 offset:2560
    ds_read_b128 v[48:51], v12 offset:2048
    s_waitcnt lgkmcnt(9)
    v_mfma_f32_32x32x16_bf16 v[16:31], v[120:123], v[56:59], v[16:31]
    ds_read_b64_tr_b16 v[116:117], v133 offset:4096
    ds_read_b64_tr_b16 v[118:119], v133 offset:4608
    ds_read_b128 v[52:55], v12 offset:4096
    s_waitcnt lgkmcnt(9)
    v_mfma_f32_32x32x16_bf16 v[16:31], v[124:127], v[60:63], v[16:31]
    ds_read_b64_tr_b16 v[120:121], v133 offset:6144
    ds_read_b64_tr_b16 v[122:123], v133 offset:6656
    ds_read_b128 v[56:59], v12 offset:6144
    s_waitcnt lgkmcnt(9)
    v_mfma_f32_32x32x16_bf16 v[16:31], v[128:131], v[64:67], v[16:31]
    ds_read_b64_tr_b16 v[124:125], v133 offset:8192
    ds_read_b64_tr_b16 v[126:127], v133 offset:8704
    ds_read_b128 v[60:63], v12 offset:8192
    s_waitcnt lgkmcnt(9)
    v_mfma_f32_32x32x16_bf16 v[16:31], v[112:115], v[48:51], v[16:31]
    ds_read_b64_tr_b16 v[128:129], v133 offset:10240
    ds_read_b64_tr_b16 v[130:131], v133 offset:10752
    ds_read_b128 v[64:67], v12 offset:10240
    s_waitcnt lgkmcnt(9)
    v_mfma_f32_32x32x16_bf16 v[16:31], v[116:119], v[52:55], v[16:31]
    ds_read_b64_tr_b16 v[112:113], v133 offset:12288
    ds_read_b64_tr_b16 v[114:115], v133 offset:12800
    ds_read_b128 v[48:51], v12 offset:12288
    s_waitcnt lgkmcnt(9)
    v_mfma_f32_32x32x16_bf16 v[16:31], v[120:123], v[56:59], v[16:31]
    ds_read_b64_tr_b16 v[116:117], v133 offset:14336
    ds_read_b64_tr_b16 v[118:119], v133 offset:14848
    ds_read_b128 v[52:55], v12 offset:14336
    s_waitcnt lgkmcnt(9)
    v_mfma_f32_32x32x16_bf16 v[16:31], v[124:127], v[60:63], v[16:31]
    s_waitcnt vmcnt(16)
    s_barrier
    s_mov_b32 s33, 393216
    s_add_u32 m0, s32, 65536
    s_nop 0
    buffer_load_dwordx4 v8, s[28:31], s33 offen lds
    s_mov_b32 s33, 425984
    s_add_u32 m0, s32, 69632
    s_nop 0
    buffer_load_dwordx4 v8, s[28:31], s33 offen lds
    s_mov_b32 s33, 458752
    s_add_u32 m0, s32, 73728
    s_nop 0
    buffer_load_dwordx4 v8, s[28:31], s33 offen lds
    s_mov_b32 s33, 491520
    s_add_u32 m0, s32, 77824
    s_nop 0
    buffer_load_dwordx4 v8, s[28:31], s33 offen lds
    s_add_u32 s33, s44, 9961472
    s_add_u32 m0, s32, 81920
    s_nop 0
    buffer_load_dwordx4 v9, s[20:23], s33 offen lds
    s_add_u32 s33, s44, 10092544
    s_add_u32 m0, s32, 86016
    s_nop 0
    buffer_load_dwordx4 v9, s[20:23], s33 offen lds
    s_add_u32 s33, s44, 10223616
    s_add_u32 m0, s32, 90112
    s_nop 0
    buffer_load_dwordx4 v9, s[20:23], s33 offen lds
    s_add_u32 s33, s44, 10354688
    s_add_u32 m0, s32, 94208
    s_nop 0
    buffer_load_dwordx4 v9, s[20:23], s33 offen lds
    v_add_u32 v132, 131072, v7
    v_add_u32 v11, 131072, v10
    ds_read_b64_tr_b16 v[120:121], v132 offset:0
    ds_read_b64_tr_b16 v[122:123], v132 offset:512
    ds_read_b128 v[56:59], v11 offset:0
    s_waitcnt lgkmcnt(9)
    v_mfma_f32_32x32x16_bf16 v[16:31], v[128:131], v[64:67], v[16:31]
    ds_read_b64_tr_b16 v[124:125], v132 offset:2048
    ds_read_b64_tr_b16 v[126:127], v132 offset:2560
    ds_read_b128 v[60:63], v11 offset:2048
    s_waitcnt lgkmcnt(9)
    v_mfma_f32_32x32x16_bf16 v[16:31], v[112:115], v[48:51], v[16:31]
    ds_read_b64_tr_b16 v[128:129], v132 offset:4096
    ds_read_b64_tr_b16 v[130:131], v132 offset:4608
    ds_read_b128 v[64:67], v11 offset:4096
    s_waitcnt lgkmcnt(9)
    v_mfma_f32_32x32x16_bf16 v[16:31], v[116:119], v[52:55], v[16:31]
    ds_read_b64_tr_b16 v[112:113], v132 offset:6144
    ds_read_b64_tr_b16 v[114:115], v132 offset:6656
    ds_read_b128 v[48:51], v11 offset:6144
    s_waitcnt lgkmcnt(9)
    v_mfma_f32_32x32x16_bf16 v[32:47], v[120:123], v[56:59], 0
    ds_read_b64_tr_b16 v[116:117], v132 offset:8192
    ds_read_b64_tr_b16 v[118:119], v132 offset:8704
    ds_read_b128 v[52:55], v11 offset:8192
    s_waitcnt lgkmcnt(9)
    v_mfma_f32_32x32x16_bf16 v[32:47], v[124:127], v[60:63], v[32:47]
    ds_read_b64_tr_b16 v[120:121], v132 offset:10240
    ds_read_b64_tr_b16 v[122:123], v132 offset:10752
    ds_read_b128 v[56:59], v11 offset:10240
    s_waitcnt lgkmcnt(9)
    v_mfma_f32_32x32x16_bf16 v[32:47], v[128:131], v[64:67], v[32:47]
    ds_read_b64_tr_b16 v[124:125], v132 offset:12288
    ds_read_b64_tr_b16 v[126:127], v132 offset:12800
    ds_read_b128 v[60:63], v11 offset:12288
    s_waitcnt lgkmcnt(9)
    v_mfma_f32_32x32x16_bf16 v[32:47], v[112:115], v[48:51], v[32:47]
    ds_read_b64_tr_b16 v[128:129], v132 offset:14336
    ds_read_b64_tr_b16 v[130:131], v132 offset:14848
    ds_read_b128 v[64:67], v11 offset:14336
    s_waitcnt lgkmcnt(9)
    v_mfma_f32_32x32x16_bf16 v[32:47], v[116:119], v[52:55], v[32:47]
    s_waitcnt vmcnt(16)
    s_barrier
    s_mov_b32 s33, 524288
    s_add_u32 m0, s32, 98304
    s_nop 0
    buffer_load_dwordx4 v8, s[28:31], s33 offen lds
    s_mov_b32 s33, 557056
    s_add_u32 m0, s32, 102400
    s_nop 0
    buffer_load_dwordx4 v8, s[28:31], s33 offen lds
    s_mov_b32 s33, 589824
    s_add_u32 m0, s32, 106496
    s_nop 0
    buffer_load_dwordx4 v8, s[28:31], s33 offen lds
    s_mov_b32 s33, 622592
    s_add_u32 m0, s32, 110592
    s_nop 0
    buffer_load_dwordx4 v8, s[28:31], s33 offen lds
    s_add_u32 s33, s44, 10485760
    s_add_u32 m0, s32, 114688
    s_nop 0
    buffer_load_dwordx4 v9, s[20:23], s33 offen lds
    s_add_u32 s33, s44, 10616832
    s_add_u32 m0, s32, 118784
    s_nop 0
    buffer_load_dwordx4 v9, s[20:23], s33 offen lds
    s_add_u32 s33, s44, 10747904
    s_add_u32 m0, s32, 122880
    s_nop 0
    buffer_load_dwordx4 v9, s[20:23], s33 offen lds
    s_add_u32 s33, s44, 10878976
    s_add_u32 m0, s32, 126976
    s_nop 0
    buffer_load_dwordx4 v9, s[20:23], s33 offen lds
    v_add_u32 v133, 0, v7
    v_add_u32 v12, 0, v10
    ds_read_b64_tr_b16 v[112:113], v133 offset:0
    ds_read_b64_tr_b16 v[114:115], v133 offset:512
    ds_read_b128 v[48:51], v12 offset:0
    s_waitcnt lgkmcnt(9)
    v_mfma_f32_32x32x16_bf16 v[32:47], v[120:123], v[56:59], v[32:47]
    ds_read_b64_tr_b16 v[116:117], v133 offset:2048
    ds_read_b64_tr_b16 v[118:119], v133 offset:2560
    ds_read_b128 v[52:55], v12 offset:2048
    s_waitcnt lgkmcnt(9)
    v_mfma_f32_32x32x16_bf16 v[32:47], v[124:127], v[60:63], v[32:47]
    ds_read_b64_tr_b16 v[120:121], v133 offset:4096
    ds_read_b64_tr_b16 v[122:123], v133 offset:4608
    ds_read_b128 v[56:59], v12 offset:4096
    s_waitcnt lgkmcnt(9)
    v_mfma_f32_32x32x16_bf16 v[32:47], v[128:131], v[64:67], v[32:47]
    ds_read_b64_tr_b16 v[124:125], v133 offset:6144
    ds_read_b64_tr_b16 v[126:127], v133 offset:6656
    ds_read_b128 v[60:63], v12 offset:6144
    s_waitcnt lgkmcnt(9)
    v_mfma_f32_32x32x16_bf16 v[32:47], v[112:115], v[48:51], v[32:47]
    ds_read_b64_tr_b16 v[128:129], v133 offset:8192
    ds_read_b64_tr_b16 v[130:131], v133 offset:8704
    ds_read_b128 v[64:67], v12 offset:8192
    s_waitcnt lgkmcnt(9)
    v_mfma_f32_32x32x16_bf16 v[32:47], v[116:119], v[52:55], v[32:47]
    ds_read_b64_tr_b16 v[112:113], v133 offset:10240
    ds_read_b64_tr_b16 v[114:115], v133 offset:10752
    ds_read_b128 v[48:51], v12 offset:10240
    s_waitcnt lgkmcnt(9)
    v_mfma_f32_32x32x16_bf16 v[32:47], v[120:123], v[56:59], v[32:47]
    ds_read_b64_tr_b16 v[116:117], v133 offset:12288
    ds_read_b64_tr_b16 v[118:119], v133 offset:12800
    ds_read_b128 v[52:55], v12 offset:12288
    s_waitcnt lgkmcnt(9)
    v_mfma_f32_32x32x16_bf16 v[32:47], v[124:127], v[60:63], v[32:47]
    ds_read_b64_tr_b16 v[120:121], v133 offset:14336
    ds_read_b64_tr_b16 v[122:123], v133 offset:14848
    ds_read_b128 v[56:59], v12 offset:14336
    s_waitcnt lgkmcnt(9)
    v_mfma_f32_32x32x16_bf16 v[32:47], v[128:131], v[64:67], v[32:47]
    s_waitcnt vmcnt(16)
    s_barrier
    s_mov_b32 s33, 655360
    s_add_u32 m0, s32, 131072
    s_nop 0
    buffer_load_dwordx4 v8, s[28:31], s33 offen lds
    s_mov_b32 s33, 688128
    s_add_u32 m0, s32, 135168
    s_nop 0
    buffer_load_dwordx4 v8, s[28:31], s33 offen lds
    s_mov_b32 s33, 720896
    s_add_u32 m0, s32, 139264
    s_nop 0
    buffer_load_dwordx4 v8, s[28:31], s33 offen lds
    s_mov_b32 s33, 753664
    s_add_u32 m0, s32, 143360
    s_nop 0
    buffer_load_dwordx4 v8, s[28:31], s33 offen lds
    s_add_u32 s33, s44, 11010048
    s_add_u32 m0, s32, 147456
    s_nop 0
    buffer_load_dwordx4 v9, s[20:23], s33 offen lds
    s_add_u32 s33, s44, 11141120
    s_add_u32 m0, s32, 151552
    s_nop 0
    buffer_load_dwordx4 v9, s[20:23], s33 offen lds
    s_add_u32 s33, s44, 11272192
    s_add_u32 m0, s32, 155648
    s_nop 0
    buffer_load_dwordx4 v9, s[20:23], s33 offen lds
    s_add_u32 s33, s44, 11403264
    s_add_u32 m0, s32, 159744
    s_nop 0
    buffer_load_dwordx4 v9, s[20:23], s33 offen lds
    v_add_u32 v132, 32768, v7
    v_add_u32 v11, 32768, v10
    ds_read_b64_tr_b16 v[124:125], v132 offset:0
    ds_read_b64_tr_b16 v[126:127], v132 offset:512
    ds_read_b128 v[60:63], v11 offset:0
    s_waitcnt lgkmcnt(9)
    v_mfma_f32_32x32x16_bf16 v[32:47], v[112:115], v[48:51], v[32:47]
    ds_read_b64_tr_b16 v[128:129], v132 offset:2048
    ds_read_b64_tr_b16 v[130:131], v132 offset:2560
    ds_read_b128 v[64:67], v11 offset:2048
    s_waitcnt lgkmcnt(9)
    v_mfma_f32_32x32x16_bf16 v[32:47], v[116:119], v[52:55], v[32:47]
    ds_read_b64_tr_b16 v[112:113], v132 offset:4096
    ds_read_b64_tr_b16 v[114:115], v132 offset:4608
    ds_read_b128 v[48:51], v11 offset:4096
    s_waitcnt lgkmcnt(9)
    v_mfma_f32_32x32x16_bf16 v[32:47], v[120:123], v[56:59], v[32:47]
    ds_read_b64_tr_b16 v[116:117], v132 offset:6144
    ds_read_b64_tr_b16 v[118:119], v132 offset:6656
    ds_read_b128 v[52:55], v11 offset:6144
    s_waitcnt lgkmcnt(9)
    v_mfma_f32_32x32x16_bf16 v[32:47], v[124:127], v[60:63], v[32:47]
    ds_read_b64_tr_b16 v[120:121], v132 offset:8192
    ds_read_b64_tr_b16 v[122:123], v132 offset:8704
    ds_read_b128 v[56:59], v11 offset:8192
    s_waitcnt lgkmcnt(9)
    v_mfma_f32_32x32x16_bf16 v[32:47], v[128:131], v[64:67], v[32:47]
    ds_read_b64_tr_b16 v[124:125], v132 offset:10240
    ds_read_b64_tr_b16 v[126:127], v132 offset:10752
    ds_read_b128 v[60:63], v11 offset:10240
    s_waitcnt lgkmcnt(9)
    v_mfma_f32_32x32x16_bf16 v[32:47], v[112:115], v[48:51], v[32:47]
    ds_read_b64_tr_b16 v[128:129], v132 offset:12288
    ds_read_b64_tr_b16 v[130:131], v132 offset:12800
    ds_read_b128 v[64:67], v11 offset:12288
    s_waitcnt lgkmcnt(9)
    v_mfma_f32_32x32x16_bf16 v[32:47], v[116:119], v[52:55], v[32:47]
    ds_read_b64_tr_b16 v[112:113], v132 offset:14336
    ds_read_b64_tr_b16 v[114:115], v132 offset:14848
    ds_read_b128 v[48:51], v11 offset:14336
    s_waitcnt lgkmcnt(9)
    v_mfma_f32_32x32x16_bf16 v[32:47], v[120:123], v[56:59], v[32:47]
    s_waitcnt vmcnt(16)
    s_barrier
    s_mov_b32 s33, 786432
    s_add_u32 m0, s32, 0
    s_nop 0
    buffer_load_dwordx4 v8, s[28:31], s33 offen lds
    s_mov_b32 s33, 819200
    s_add_u32 m0, s32, 4096
    s_nop 0
    buffer_load_dwordx4 v8, s[28:31], s33 offen lds
    s_mov_b32 s33, 851968
    s_add_u32 m0, s32, 8192
    s_nop 0
    buffer_load_dwordx4 v8, s[28:31], s33 offen lds
    s_mov_b32 s33, 884736
    s_add_u32 m0, s32, 12288
    s_nop 0
    buffer_load_dwordx4 v8, s[28:31], s33 offen lds
    s_add_u32 s33, s44, 11534336
    s_add_u32 m0, s32, 16384
    s_nop 0
    buffer_load_dwordx4 v9, s[20:23], s33 offen lds
    s_add_u32 s33, s44, 11665408
    s_add_u32 m0, s32, 20480
    s_nop 0
    buffer_load_dwordx4 v9, s[20:23], s33 offen lds
    s_add_u32 s33, s44, 11796480
    s_add_u32 m0, s32, 24576
    s_nop 0
    buffer_load_dwordx4 v9, s[20:23], s33 offen lds
    s_add_u32 s33, s44, 11927552
    s_add_u32 m0, s32, 28672
    s_nop 0
    buffer_load_dwordx4 v9, s[20:23], s33 offen lds
    v_add_u32 v133, 65536, v7
    v_add_u32 v12, 65536, v10
    ds_read_b64_tr_b16 v[116:117], v133 offset:0
    ds_read_b64_tr_b16 v[118:119], v133 offset:512
    ds_read_b128 v[52:55], v12 offset:0
    s_waitcnt lgkmcnt(9)
    v_mfma_f32_32x32x16_bf16 v[32:47], v[124:127], v[60:63], v[32:47]
    ds_read_b64_tr_b16 v[120:121], v133 offset:2048
    ds_read_b64_tr_b16 v[122:123], v133 offset:2560
    ds_read_b128 v[56:59], v12 offset:2048
    s_waitcnt lgkmcnt(9)
    v_mfma_f32_32x32x16_bf16 v[32:47], v[128:131], v[64:67], v[32:47]
    ds_read_b64_tr_b16 v[124:125], v133 offset:4096
    ds_read_b64_tr_b16 v[126:127], v133 offset:4608
    ds_read_b128 v[60:63], v12 offset:4096
    s_waitcnt lgkmcnt(9)
    v_mfma_f32_32x32x16_bf16 v[32:47], v[112:115], v[48:51], v[32:47]
    ds_read_b64_tr_b16 v[128:129], v133 offset:6144
    ds_read_b64_tr_b16 v[130:131], v133 offset:6656
    ds_read_b128 v[64:67], v12 offset:6144
    s_waitcnt lgkmcnt(9)
    v_mfma_f32_32x32x16_bf16 v[32:47], v[116:119], v[52:55], v[32:47]
    ds_read_b64_tr_b16 v[112:113], v133 offset:8192
    ds_read_b64_tr_b16 v[114:115], v133 offset:8704
    ds_read_b128 v[48:51], v12 offset:8192
    s_waitcnt lgkmcnt(9)
    v_mfma_f32_32x32x16_bf16 v[32:47], v[120:123], v[56:59], v[32:47]
    ds_read_b64_tr_b16 v[116:117], v133 offset:10240
    ds_read_b64_tr_b16 v[118:119], v133 offset:10752
    ds_read_b128 v[52:55], v12 offset:10240
    s_waitcnt lgkmcnt(9)
    v_mfma_f32_32x32x16_bf16 v[32:47], v[124:127], v[60:63], v[32:47]
    ds_read_b64_tr_b16 v[120:121], v133 offset:12288
    ds_read_b64_tr_b16 v[122:123], v133 offset:12800
    ds_read_b128 v[56:59], v12 offset:12288
    s_waitcnt lgkmcnt(9)
    v_mfma_f32_32x32x16_bf16 v[32:47], v[128:131], v[64:67], v[32:47]
    ds_read_b64_tr_b16 v[124:125], v133 offset:14336
    ds_read_b64_tr_b16 v[126:127], v133 offset:14848
    ds_read_b128 v[60:63], v12 offset:14336
    s_waitcnt lgkmcnt(9)
    v_mfma_f32_32x32x16_bf16 v[32:47], v[112:115], v[48:51], v[32:47]
    s_waitcnt vmcnt(16)
    s_barrier
    s_mov_b32 s33, 917504
    s_add_u32 m0, s32, 32768
    s_nop 0
    buffer_load_dwordx4 v8, s[28:31], s33 offen lds
    s_mov_b32 s33, 950272
    s_add_u32 m0, s32, 36864
    s_nop 0
    buffer_load_dwordx4 v8, s[28:31], s33 offen lds
    s_mov_b32 s33, 983040
    s_add_u32 m0, s32, 40960
    s_nop 0
    buffer_load_dwordx4 v8, s[28:31], s33 offen lds
    s_mov_b32 s33, 1015808
    s_add_u32 m0, s32, 45056
    s_nop 0
    buffer_load_dwordx4 v8, s[28:31], s33 offen lds
    s_add_u32 s33, s44, 12058624
    s_add_u32 m0, s32, 49152
    s_nop 0
    buffer_load_dwordx4 v9, s[20:23], s33 offen lds
    s_add_u32 s33, s44, 12189696
    s_add_u32 m0, s32, 53248
    s_nop 0
    buffer_load_dwordx4 v9, s[20:23], s33 offen lds
    s_add_u32 s33, s44, 12320768
    s_add_u32 m0, s32, 57344
    s_nop 0
    buffer_load_dwordx4 v9, s[20:23], s33 offen lds
    s_add_u32 s33, s44, 12451840
    s_add_u32 m0, s32, 61440
    s_nop 0
    buffer_load_dwordx4 v9, s[20:23], s33 offen lds
    v_add_u32 v132, 98304, v7
    v_add_u32 v11, 98304, v10
    ds_read_b64_tr_b16 v[128:129], v132 offset:0
    ds_read_b64_tr_b16 v[130:131], v132 offset:512
    ds_read_b128 v[64:67], v11 offset:0
    s_waitcnt lgkmcnt(9)
    v_mfma_f32_32x32x16_bf16 v[32:47], v[116:119], v[52:55], v[32:47]
    ds_read_b64_tr_b16 v[112:113], v132 offset:2048
    ds_read_b64_tr_b16 v[114:115], v132 offset:2560
    ds_read_b128 v[48:51], v11 offset:2048
    s_waitcnt lgkmcnt(9)
    v_mfma_f32_32x32x16_bf16 v[32:47], v[120:123], v[56:59], v[32:47]
    ds_read_b64_tr_b16 v[116:117], v132 offset:4096
    ds_read_b64_tr_b16 v[118:119], v132 offset:4608
    ds_read_b128 v[52:55], v11 offset:4096
    s_waitcnt lgkmcnt(9)
    v_mfma_f32_32x32x16_bf16 v[32:47], v[124:127], v[60:63], v[32:47]
    ds_read_b64_tr_b16 v[120:121], v132 offset:6144
    ds_read_b64_tr_b16 v[122:123], v132 offset:6656
    ds_read_b128 v[56:59], v11 offset:6144
    s_waitcnt lgkmcnt(9)
    v_mfma_f32_32x32x16_bf16 v[32:47], v[128:131], v[64:67], v[32:47]
    ds_read_b64_tr_b16 v[124:125], v132 offset:8192
    ds_read_b64_tr_b16 v[126:127], v132 offset:8704
    ds_read_b128 v[60:63], v11 offset:8192
    s_waitcnt lgkmcnt(9)
    v_mfma_f32_32x32x16_bf16 v[32:47], v[112:115], v[48:51], v[32:47]
    ds_read_b64_tr_b16 v[128:129], v132 offset:10240
    ds_read_b64_tr_b16 v[130:131], v132 offset:10752
    ds_read_b128 v[64:67], v11 offset:10240
    s_waitcnt lgkmcnt(9)
    v_mfma_f32_32x32x16_bf16 v[32:47], v[116:119], v[52:55], v[32:47]
    ds_read_b64_tr_b16 v[112:113], v132 offset:12288
    ds_read_b64_tr_b16 v[114:115], v132 offset:12800
    ds_read_b128 v[48:51], v11 offset:12288
    s_waitcnt lgkmcnt(9)
    v_mfma_f32_32x32x16_bf16 v[32:47], v[120:123], v[56:59], v[32:47]
    ds_read_b64_tr_b16 v[116:117], v132 offset:14336
    ds_read_b64_tr_b16 v[118:119], v132 offset:14848
    ds_read_b128 v[52:55], v11 offset:14336
    s_waitcnt lgkmcnt(9)
    v_mfma_f32_32x32x16_bf16 v[32:47], v[124:127], v[60:63], v[32:47]
    s_waitcnt vmcnt(16)
    s_barrier
    s_mov_b32 s33, 1048576
    s_add_u32 m0, s32, 65536
    s_nop 0
    buffer_load_dwordx4 v8, s[28:31], s33 offen lds
    s_mov_b32 s33, 1081344
    s_add_u32 m0, s32, 69632
    s_nop 0
    buffer_load_dwordx4 v8, s[28:31], s33 offen lds
    s_mov_b32 s33, 1114112
    s_add_u32 m0, s32, 73728
    s_nop 0
    buffer_load_dwordx4 v8, s[28:31], s33 offen lds
    s_mov_b32 s33, 1146880
    s_add_u32 m0, s32, 77824
    s_nop 0
    buffer_load_dwordx4 v8, s[28:31], s33 offen lds
    s_add_u32 s33, s44, 12582912
    s_add_u32 m0, s32, 81920
    s_nop 0
    buffer_load_dwordx4 v9, s[20:23], s33 offen lds
    s_add_u32 s33, s44, 12713984
    s_add_u32 m0, s32, 86016
    s_nop 0
    buffer_load_dwordx4 v9, s[20:23], s33 offen lds
    s_add_u32 s33, s44, 12845056
    s_add_u32 m0, s32, 90112
    s_nop 0
    buffer_load_dwordx4 v9, s[20:23], s33 offen lds
    s_add_u32 s33, s44, 12976128
    s_add_u32 m0, s32, 94208
    s_nop 0
    buffer_load_dwordx4 v9, s[20:23], s33 offen lds
    v_add_u32 v133, 131072, v7
    v_add_u32 v12, 131072, v10
    ds_read_b64_tr_b16 v[120:121], v133 offset:0
    ds_read_b64_tr_b16 v[122:123], v133 offset:512
    ds_read_b128 v[56:59], v12 offset:0
    s_waitcnt lgkmcnt(9)
    v_mfma_f32_32x32x16_bf16 v[32:47], v[128:131], v[64:67], v[32:47]
    ds_read_b64_tr_b16 v[124:125], v133 offset:2048
    ds_read_b64_tr_b16 v[126:127], v133 offset:2560
    ds_read_b128 v[60:63], v12 offset:2048
    s_waitcnt lgkmcnt(9)
    v_mfma_f32_32x32x16_bf16 v[32:47], v[112:115], v[48:51], v[32:47]
    ds_read_b64_tr_b16 v[128:129], v133 offset:4096
    ds_read_b64_tr_b16 v[130:131], v133 offset:4608
    ds_read_b128 v[64:67], v12 offset:4096
    s_waitcnt lgkmcnt(9)
    v_mfma_f32_32x32x16_bf16 v[32:47], v[116:119], v[52:55], v[32:47]
    ds_read_b64_tr_b16 v[112:113], v133 offset:6144
    ds_read_b64_tr_b16 v[114:115], v133 offset:6656
    ds_read_b128 v[48:51], v12 offset:6144
    s_waitcnt lgkmcnt(9)
    v_mfma_f32_32x32x16_bf16 v[32:47], v[120:123], v[56:59], v[32:47]
    ds_read_b64_tr_b16 v[116:117], v133 offset:8192
    ds_read_b64_tr_b16 v[118:119], v133 offset:8704
    ds_read_b128 v[52:55], v12 offset:8192
    s_waitcnt lgkmcnt(9)
    v_mfma_f32_32x32x16_bf16 v[32:47], v[124:127], v[60:63], v[32:47]
    ds_read_b64_tr_b16 v[120:121], v133 offset:10240
    ds_read_b64_tr_b16 v[122:123], v133 offset:10752
    ds_read_b128 v[56:59], v12 offset:10240
    s_waitcnt lgkmcnt(9)
    v_mfma_f32_32x32x16_bf16 v[32:47], v[128:131], v[64:67], v[32:47]
    ds_read_b64_tr_b16 v[124:125], v133 offset:12288
    ds_read_b64_tr_b16 v[126:127], v133 offset:12800
    ds_read_b128 v[60:63], v12 offset:12288
    s_waitcnt lgkmcnt(9)
    v_mfma_f32_32x32x16_bf16 v[32:47], v[112:115], v[48:51], v[32:47]
    ds_read_b64_tr_b16 v[128:129], v133 offset:14336
    ds_read_b64_tr_b16 v[130:131], v133 offset:14848
    ds_read_b128 v[64:67], v12 offset:14336
    s_waitcnt lgkmcnt(9)
    v_mfma_f32_32x32x16_bf16 v[32:47], v[116:119], v[52:55], v[32:47]
    s_waitcnt vmcnt(16)
    s_barrier
    s_mov_b32 s33, 1179648
    s_add_u32 m0, s32, 98304
    s_nop 0
    buffer_load_dwordx4 v8, s[28:31], s33 offen lds
    s_mov_b32 s33, 1212416
    s_add_u32 m0, s32, 102400
    s_nop 0
    buffer_load_dwordx4 v8, s[28:31], s33 offen lds
    s_mov_b32 s33, 1245184
    s_add_u32 m0, s32, 106496
    s_nop 0
    buffer_load_dwordx4 v8, s[28:31], s33 offen lds
    s_mov_b32 s33, 1277952
    s_add_u32 m0, s32, 110592
    s_nop 0
    buffer_load_dwordx4 v8, s[28:31], s33 offen lds
    s_add_u32 s33, s44, 13107200
    s_add_u32 m0, s32, 114688
    s_nop 0
    buffer_load_dwordx4 v9, s[20:23], s33 offen lds
    s_add_u32 s33, s44, 13238272
    s_add_u32 m0, s32, 118784
    s_nop 0
    buffer_load_dwordx4 v9, s[20:23], s33 offen lds
    s_add_u32 s33, s44, 13369344
    s_add_u32 m0, s32, 122880
    s_nop 0
    buffer_load_dwordx4 v9, s[20:23], s33 offen lds
    s_add_u32 s33, s44, 13500416
    s_add_u32 m0, s32, 126976
    s_nop 0
    buffer_load_dwordx4 v9, s[20:23], s33 offen lds
    v_add_u32 v132, 0, v7
    v_add_u32 v11, 0, v10
    ds_read_b64_tr_b16 v[112:113], v132 offset:0
    ds_read_b64_tr_b16 v[114:115], v132 offset:512
    ds_read_b128 v[48:51], v11 offset:0
    s_waitcnt lgkmcnt(9)
    v_mfma_f32_32x32x16_bf16 v[32:47], v[120:123], v[56:59], v[32:47]
    ds_read_b64_tr_b16 v[116:117], v132 offset:2048
    ds_read_b64_tr_b16 v[118:119], v132 offset:2560
    ds_read_b128 v[52:55], v11 offset:2048
    s_waitcnt lgkmcnt(9)
    v_mfma_f32_32x32x16_bf16 v[32:47], v[124:127], v[60:63], v[32:47]
    ds_read_b64_tr_b16 v[120:121], v132 offset:4096
    ds_read_b64_tr_b16 v[122:123], v132 offset:4608
    ds_read_b128 v[56:59], v11 offset:4096
    s_waitcnt lgkmcnt(9)
    v_mfma_f32_32x32x16_bf16 v[32:47], v[128:131], v[64:67], v[32:47]
    ds_read_b64_tr_b16 v[124:125], v132 offset:6144
    ds_read_b64_tr_b16 v[126:127], v132 offset:6656
    ds_read_b128 v[60:63], v11 offset:6144
    s_waitcnt lgkmcnt(9)
    v_mfma_f32_32x32x16_bf16 v[32:47], v[112:115], v[48:51], v[32:47]
    ds_read_b64_tr_b16 v[128:129], v132 offset:8192
    ds_read_b64_tr_b16 v[130:131], v132 offset:8704
    ds_read_b128 v[64:67], v11 offset:8192
    s_waitcnt lgkmcnt(9)
    v_mfma_f32_32x32x16_bf16 v[32:47], v[116:119], v[52:55], v[32:47]
    ds_read_b64_tr_b16 v[112:113], v132 offset:10240
    ds_read_b64_tr_b16 v[114:115], v132 offset:10752
    ds_read_b128 v[48:51], v11 offset:10240
    s_waitcnt lgkmcnt(9)
    v_mfma_f32_32x32x16_bf16 v[32:47], v[120:123], v[56:59], v[32:47]
    ds_read_b64_tr_b16 v[116:117], v132 offset:12288
    ds_read_b64_tr_b16 v[118:119], v132 offset:12800
    ds_read_b128 v[52:55], v11 offset:12288
    s_waitcnt lgkmcnt(9)
    v_mfma_f32_32x32x16_bf16 v[32:47], v[124:127], v[60:63], v[32:47]
    ds_read_b64_tr_b16 v[120:121], v132 offset:14336
    ds_read_b64_tr_b16 v[122:123], v132 offset:14848
    ds_read_b128 v[56:59], v11 offset:14336
    s_waitcnt lgkmcnt(9)
    v_mfma_f32_32x32x16_bf16 v[32:47], v[128:131], v[64:67], v[32:47]
    s_waitcnt vmcnt(16)
    s_barrier
    s_mov_b32 s33, 1310720
    s_add_u32 m0, s32, 131072
    s_nop 0
    buffer_load_dwordx4 v8, s[28:31], s33 offen lds
    s_mov_b32 s33, 1343488
    s_add_u32 m0, s32, 135168
    s_nop 0
    buffer_load_dwordx4 v8, s[28:31], s33 offen lds
    s_mov_b32 s33, 1376256
    s_add_u32 m0, s32, 139264
    s_nop 0
    buffer_load_dwordx4 v8, s[28:31], s33 offen lds
    s_add_u32 s33, s44, 13631488
    s_add_u32 m0, s32, 147456
    s_nop 0
    buffer_load_dwordx4 v9, s[20:23], s33 offen lds
    s_add_u32 s33, s44, 13762560
    s_add_u32 m0, s32, 151552
    s_nop 0
    buffer_load_dwordx4 v9, s[20:23], s33 offen lds
    s_add_u32 s33, s44, 13893632
    s_add_u32 m0, s32, 155648
    s_nop 0
    buffer_load_dwordx4 v9, s[20:23], s33 offen lds
    v_add_u32 v133, 32768, v7
    v_add_u32 v12, 32768, v10
    ds_read_b64_tr_b16 v[124:125], v133 offset:0
    ds_read_b64_tr_b16 v[126:127], v133 offset:512
    ds_read_b128 v[60:63], v12 offset:0
    s_waitcnt lgkmcnt(9)
    v_mfma_f32_32x32x16_bf16 v[32:47], v[112:115], v[48:51], v[32:47]
    ds_read_b64_tr_b16 v[128:129], v133 offset:2048
    ds_read_b64_tr_b16 v[130:131], v133 offset:2560
    ds_read_b128 v[64:67], v12 offset:2048
    s_waitcnt lgkmcnt(9)
    v_mfma_f32_32x32x16_bf16 v[32:47], v[116:119], v[52:55], v[32:47]
    ds_read_b64_tr_b16 v[112:113], v133 offset:4096
    ds_read_b64_tr_b16 v[114:115], v133 offset:4608
    ds_read_b128 v[48:51], v12 offset:4096
    s_waitcnt lgkmcnt(9)
    v_mfma_f32_32x32x16_bf16 v[32:47], v[120:123], v[56:59], v[32:47]
    ds_read_b64_tr_b16 v[116:117], v133 offset:6144
    ds_read_b64_tr_b16 v[118:119], v133 offset:6656
    ds_read_b128 v[52:55], v12 offset:6144
    s_waitcnt lgkmcnt(9)
    v_mfma_f32_32x32x16_bf16 v[32:47], v[124:127], v[60:63], v[32:47]
    ds_read_b64_tr_b16 v[120:121], v133 offset:8192
    ds_read_b64_tr_b16 v[122:123], v133 offset:8704
    ds_read_b128 v[56:59], v12 offset:8192
    s_waitcnt lgkmcnt(9)
    v_mfma_f32_32x32x16_bf16 v[32:47], v[128:131], v[64:67], v[32:47]
    ds_read_b64_tr_b16 v[124:125], v133 offset:10240
    ds_read_b64_tr_b16 v[126:127], v133 offset:10752
    ds_read_b128 v[60:63], v12 offset:10240
    s_waitcnt lgkmcnt(9)
    v_mfma_f32_32x32x16_bf16 v[32:47], v[112:115], v[48:51], v[32:47]
    ds_read_b64_tr_b16 v[128:129], v133 offset:12288
    ds_read_b64_tr_b16 v[130:131], v133 offset:12800
    ds_read_b128 v[64:67], v12 offset:12288
    s_waitcnt lgkmcnt(9)
    v_mfma_f32_32x32x16_bf16 v[32:47], v[116:119], v[52:55], v[32:47]
    ds_read_b64_tr_b16 v[112:113], v133 offset:14336
    ds_read_b64_tr_b16 v[114:115], v133 offset:14848
    ds_read_b128 v[48:51], v12 offset:14336
    s_waitcnt lgkmcnt(9)
    v_mfma_f32_32x32x16_bf16 v[32:47], v[120:123], v[56:59], v[32:47]
    s_waitcnt vmcnt(14)
    s_barrier
    v_add_u32 v132, 65536, v7
    v_add_u32 v11, 65536, v10
    ds_read_b64_tr_b16 v[116:117], v132 offset:0
    ds_read_b64_tr_b16 v[118:119], v132 offset:512
    ds_read_b128 v[52:55], v11 offset:0
    s_waitcnt lgkmcnt(9)
    v_mfma_f32_32x32x16_bf16 v[32:47], v[124:127], v[60:63], v[32:47]
    ds_read_b64_tr_b16 v[120:121], v132 offset:2048
    ds_read_b64_tr_b16 v[122:123], v132 offset:2560
    ds_read_b128 v[56:59], v11 offset:2048
    s_waitcnt lgkmcnt(9)
    v_mfma_f32_32x32x16_bf16 v[32:47], v[128:131], v[64:67], v[32:47]
    ds_read_b64_tr_b16 v[124:125], v132 offset:4096
    ds_read_b64_tr_b16 v[126:127], v132 offset:4608
    ds_read_b128 v[60:63], v11 offset:4096
    s_waitcnt lgkmcnt(9)
    v_mfma_f32_32x32x16_bf16 v[32:47], v[112:115], v[48:51], v[32:47]
    ds_read_b64_tr_b16 v[128:129], v132 offset:6144
    ds_read_b64_tr_b16 v[130:131], v132 offset:6656
    ds_read_b128 v[64:67], v11 offset:6144
    s_waitcnt lgkmcnt(9)
    v_mfma_f32_32x32x16_bf16 v[32:47], v[116:119], v[52:55], v[32:47]
    ds_read_b64_tr_b16 v[112:113], v132 offset:8192
    ds_read_b64_tr_b16 v[114:115], v132 offset:8704
    ds_read_b128 v[48:51], v11 offset:8192
    s_waitcnt lgkmcnt(9)
    v_mfma_f32_32x32x16_bf16 v[32:47], v[120:123], v[56:59], v[32:47]
    ds_read_b64_tr_b16 v[116:117], v132 offset:10240
    ds_read_b64_tr_b16 v[118:119], v132 offset:10752
    ds_read_b128 v[52:55], v11 offset:10240
    s_waitcnt lgkmcnt(9)
    v_mfma_f32_32x32x16_bf16 v[32:47], v[124:127], v[60:63], v[32:47]
    ds_read_b64_tr_b16 v[120:121], v132 offset:12288
    ds_read_b64_tr_b16 v[122:123], v132 offset:12800
    ds_read_b128 v[56:59], v11 offset:12288
    s_waitcnt lgkmcnt(9)
    v_mfma_f32_32x32x16_bf16 v[32:47], v[128:131], v[64:67], v[32:47]
    ds_read_b64_tr_b16 v[124:125], v132 offset:14336
    ds_read_b64_tr_b16 v[126:127], v132 offset:14848
    ds_read_b128 v[60:63], v11 offset:14336
    s_waitcnt lgkmcnt(9)
    v_mfma_f32_32x32x16_bf16 v[32:47], v[112:115], v[48:51], v[32:47]
    s_waitcnt vmcnt(6)
    s_barrier
    v_add_u32 v133, 98304, v7
    v_add_u32 v12, 98304, v10
    ds_read_b64_tr_b16 v[128:129], v133 offset:0
    ds_read_b64_tr_b16 v[130:131], v133 offset:512
    ds_read_b128 v[64:67], v12 offset:0
    s_waitcnt lgkmcnt(9)
    v_mfma_f32_32x32x16_bf16 v[32:47], v[116:119], v[52:55], v[32:47]
    ds_read_b64_tr_b16 v[112:113], v133 offset:2048
    ds_read_b64_tr_b16 v[114:115], v133 offset:2560
    ds_read_b128 v[48:51], v12 offset:2048
    s_waitcnt lgkmcnt(9)
    v_mfma_f32_32x32x16_bf16 v[32:47], v[120:123], v[56:59], v[32:47]
    ds_read_b64_tr_b16 v[116:117], v133 offset:4096
    ds_read_b64_tr_b16 v[118:119], v133 offset:4608
    ds_read_b128 v[52:55], v12 offset:4096
    s_waitcnt lgkmcnt(9)
    v_mfma_f32_32x32x16_bf16 v[32:47], v[124:127], v[60:63], v[32:47]
    ds_read_b64_tr_b16 v[120:121], v133 offset:6144
    ds_read_b64_tr_b16 v[122:123], v133 offset:6656
    ds_read_b128 v[56:59], v12 offset:6144
    s_waitcnt lgkmcnt(9)
    v_mfma_f32_32x32x16_bf16 v[32:47], v[128:131], v[64:67], v[32:47]
    ds_read_b64_tr_b16 v[124:125], v133 offset:8192
    ds_read_b64_tr_b16 v[126:127], v133 offset:8704
    ds_read_b128 v[60:63], v12 offset:8192
    s_waitcnt lgkmcnt(9)
    v_mfma_f32_32x32x16_bf16 v[32:47], v[112:115], v[48:51], v[32:47]
    ds_read_b64_tr_b16 v[128:129], v133 offset:10240
    ds_read_b64_tr_b16 v[130:131], v133 offset:10752
    ds_read_b128 v[64:67], v12 offset:10240
    s_waitcnt lgkmcnt(9)
    v_mfma_f32_32x32x16_bf16 v[32:47], v[116:119], v[52:55], v[32:47]
    ds_read_b64_tr_b16 v[112:113], v133 offset:12288
    ds_read_b64_tr_b16 v[114:115], v133 offset:12800
    ds_read_b128 v[48:51], v12 offset:12288
    s_waitcnt lgkmcnt(9)
    v_mfma_f32_32x32x16_bf16 v[32:47], v[120:123], v[56:59], v[32:47]
    ds_read_b64_tr_b16 v[116:117], v133 offset:14336
    ds_read_b64_tr_b16 v[118:119], v133 offset:14848
    ds_read_b128 v[52:55], v12 offset:14336
    s_waitcnt lgkmcnt(9)
    v_mfma_f32_32x32x16_bf16 v[32:47], v[124:127], v[60:63], v[32:47]
    s_waitcnt vmcnt(0)
    s_barrier
    v_add_u32 v132, 131072, v7
    v_add_u32 v11, 131072, v10
    ds_read_b64_tr_b16 v[120:121], v132 offset:0
    ds_read_b64_tr_b16 v[122:123], v132 offset:512
    ds_read_b128 v[56:59], v11 offset:0
    s_waitcnt lgkmcnt(9)
    v_mfma_f32_32x32x16_bf16 v[32:47], v[128:131], v[64:67], v[32:47]
    ds_read_b64_tr_b16 v[124:125], v132 offset:2048
    ds_read_b64_tr_b16 v[126:127], v132 offset:2560
    ds_read_b128 v[60:63], v11 offset:2048
    s_waitcnt lgkmcnt(9)
    v_mfma_f32_32x32x16_bf16 v[32:47], v[112:115], v[48:51], v[32:47]
    ds_read_b64_tr_b16 v[128:129], v132 offset:4096
    ds_read_b64_tr_b16 v[130:131], v132 offset:4608
    ds_read_b128 v[64:67], v11 offset:4096
    s_waitcnt lgkmcnt(9)
    v_mfma_f32_32x32x16_bf16 v[32:47], v[116:119], v[52:55], v[32:47]
    ds_read_b64_tr_b16 v[112:113], v132 offset:6144
    ds_read_b64_tr_b16 v[114:115], v132 offset:6656
    ds_read_b128 v[48:51], v11 offset:6144
    s_waitcnt lgkmcnt(9)
    v_mfma_f32_32x32x16_bf16 v[32:47], v[120:123], v[56:59], v[32:47]
    ds_read_b64_tr_b16 v[116:117], v132 offset:8192
    ds_read_b64_tr_b16 v[118:119], v132 offset:8704
    ds_read_b128 v[52:55], v11 offset:8192
    s_waitcnt lgkmcnt(9)
    v_mfma_f32_32x32x16_bf16 v[32:47], v[124:127], v[60:63], v[32:47]
    ds_read_b64_tr_b16 v[120:121], v132 offset:10240
    ds_read_b64_tr_b16 v[122:123], v132 offset:10752
    ds_read_b128 v[56:59], v11 offset:10240
    s_waitcnt lgkmcnt(9)
    v_mfma_f32_32x32x16_bf16 v[32:47], v[128:131], v[64:67], v[32:47]
    s_waitcnt lgkmcnt(6)
    v_mfma_f32_32x32x16_bf16 v[32:47], v[112:115], v[48:51], v[32:47]
    s_waitcnt lgkmcnt(3)
    v_mfma_f32_32x32x16_bf16 v[32:47], v[116:119], v[52:55], v[32:47]
    s_waitcnt lgkmcnt(0)
    v_mfma_f32_32x32x16_bf16 v[32:47], v[120:123], v[56:59], v[32:47]
    s_mov_b32 s36, s4
    s_mov_b32 s37, s5
    s_mov_b32 s38, 2097152
    s_mov_b32 s39, 0x00020000
    s_mov_b32 s40, s10
    s_mov_b32 s41, s11
    s_mov_b32 s42, 2097152
    s_mov_b32 s43, 0x00020000
    v_lshlrev_b32 v6, 10, v4
    s_lshl_b32 s3, s14, 7
    s_lshl_b32 s33, s18, 6
    s_add_u32 s3, s3, s33
    v_add_u32 v6, s3, v6
    v_lshl_add_u32 v6, v3, 4, v6
    buffer_load_dwordx4 v[136:139], v6, s[36:39], 0 offen
    buffer_load_dwordx4 v[140:143], v6, s[36:39], 0 offen offset:32
    s_mov_b32 s33, 0xbfb8aa3b
    s_waitcnt vmcnt(0)
    v_cvt_pk_bf16_f32 v144, v16, v17
    v_cvt_pk_bf16_f32 v145, v32, v33
    v_lshlrev_b32 v16, 16, v144
    v_and_b32 v17, 0xffff0000, v144
    v_lshlrev_b32 v32, 16, v145
    v_and_b32 v33, 0xffff0000, v145
    v_mul_f32 v144, s33, v32
    v_mul_f32 v145, s33, v33
    v_exp_f32 v144, v144
    v_exp_f32 v145, v145
    v_add_f32 v144, 1.0, v144
    v_add_f32 v145, 1.0, v145
    v_rcp_f32 v144, v144
    v_rcp_f32 v145, v145
    v_mul_f32 v144, v32, v144
    v_mul_f32 v145, v33, v145
    v_cvt_pk_bf16_f32 v146, v144, v145
    v_lshlrev_b32 v144, 16, v146
    v_and_b32 v145, 0xffff0000, v146
    v_mul_f32 v144, v144, v16
    v_mul_f32 v145, v145, v17
    v_cvt_pk_bf16_f32 v146, v144, v145
    v_lshlrev_b32 v144, 16, v146
    v_and_b32 v145, 0xffff0000, v146
    v_lshlrev_b32 v147, 16, v136
    v_and_b32 v148, 0xffff0000, v136
    v_add_f32 v144, v144, v147
    v_add_f32 v145, v145, v148
    v_cvt_pk_bf16_f32 v152, v144, v145
    v_cvt_pk_bf16_f32 v144, v18, v19
    v_cvt_pk_bf16_f32 v145, v34, v35
    v_lshlrev_b32 v18, 16, v144
    v_and_b32 v19, 0xffff0000, v144
    v_lshlrev_b32 v34, 16, v145
    v_and_b32 v35, 0xffff0000, v145
    v_mul_f32 v144, s33, v34
    v_mul_f32 v145, s33, v35
    v_exp_f32 v144, v144
    v_exp_f32 v145, v145
    v_add_f32 v144, 1.0, v144
    v_add_f32 v145, 1.0, v145
    v_rcp_f32 v144, v144
    v_rcp_f32 v145, v145
    v_mul_f32 v144, v34, v144
    v_mul_f32 v145, v35, v145
    v_cvt_pk_bf16_f32 v146, v144, v145
    v_lshlrev_b32 v144, 16, v146
    v_and_b32 v145, 0xffff0000, v146
    v_mul_f32 v144, v144, v18
    v_mul_f32 v145, v145, v19
    v_cvt_pk_bf16_f32 v146, v144, v145
    v_lshlrev_b32 v144, 16, v146
    v_and_b32 v145, 0xffff0000, v146
    v_lshlrev_b32 v147, 16, v137
    v_and_b32 v148, 0xffff0000, v137
    v_add_f32 v144, v144, v147
    v_add_f32 v145, v145, v148
    v_cvt_pk_bf16_f32 v153, v144, v145
    v_cvt_pk_bf16_f32 v144, v20, v21
    v_cvt_pk_bf16_f32 v145, v36, v37
    v_lshlrev_b32 v20, 16, v144
    v_and_b32 v21, 0xffff0000, v144
    v_lshlrev_b32 v36, 16, v145
    v_and_b32 v37, 0xffff0000, v145
    v_mul_f32 v144, s33, v36
    v_mul_f32 v145, s33, v37
    v_exp_f32 v144, v144
    v_exp_f32 v145, v145
    v_add_f32 v144, 1.0, v144
    v_add_f32 v145, 1.0, v145
    v_rcp_f32 v144, v144
    v_rcp_f32 v145, v145
    v_mul_f32 v144, v36, v144
    v_mul_f32 v145, v37, v145
    v_cvt_pk_bf16_f32 v146, v144, v145
    v_lshlrev_b32 v144, 16, v146
    v_and_b32 v145, 0xffff0000, v146
    v_mul_f32 v144, v144, v20
    v_mul_f32 v145, v145, v21
    v_cvt_pk_bf16_f32 v146, v144, v145
    v_lshlrev_b32 v144, 16, v146
    v_and_b32 v145, 0xffff0000, v146
    v_lshlrev_b32 v147, 16, v138
    v_and_b32 v148, 0xffff0000, v138
    v_add_f32 v144, v144, v147
    v_add_f32 v145, v145, v148
    v_cvt_pk_bf16_f32 v154, v144, v145
    v_cvt_pk_bf16_f32 v144, v22, v23
    v_cvt_pk_bf16_f32 v145, v38, v39
    v_lshlrev_b32 v22, 16, v144
    v_and_b32 v23, 0xffff0000, v144
    v_lshlrev_b32 v38, 16, v145
    v_and_b32 v39, 0xffff0000, v145
    v_mul_f32 v144, s33, v38
    v_mul_f32 v145, s33, v39
    v_exp_f32 v144, v144
    v_exp_f32 v145, v145
    v_add_f32 v144, 1.0, v144
    v_add_f32 v145, 1.0, v145
    v_rcp_f32 v144, v144
    v_rcp_f32 v145, v145
    v_mul_f32 v144, v38, v144
    v_mul_f32 v145, v39, v145
    v_cvt_pk_bf16_f32 v146, v144, v145
    v_lshlrev_b32 v144, 16, v146
    v_and_b32 v145, 0xffff0000, v146
    v_mul_f32 v144, v144, v22
    v_mul_f32 v145, v145, v23
    v_cvt_pk_bf16_f32 v146, v144, v145
    v_lshlrev_b32 v144, 16, v146
    v_and_b32 v145, 0xffff0000, v146
    v_lshlrev_b32 v147, 16, v139
    v_and_b32 v148, 0xffff0000, v139
    v_add_f32 v144, v144, v147
    v_add_f32 v145, v145, v148
    v_cvt_pk_bf16_f32 v155, v144, v145
    v_cvt_pk_bf16_f32 v144, v24, v25
    v_cvt_pk_bf16_f32 v145, v40, v41
    v_lshlrev_b32 v24, 16, v144
    v_and_b32 v25, 0xffff0000, v144
    v_lshlrev_b32 v40, 16, v145
    v_and_b32 v41, 0xffff0000, v145
    v_mul_f32 v144, s33, v40
    v_mul_f32 v145, s33, v41
    v_exp_f32 v144, v144
    v_exp_f32 v145, v145
    v_add_f32 v144, 1.0, v144
    v_add_f32 v145, 1.0, v145
    v_rcp_f32 v144, v144
    v_rcp_f32 v145, v145
    v_mul_f32 v144, v40, v144
    v_mul_f32 v145, v41, v145
    v_cvt_pk_bf16_f32 v146, v144, v145
    v_lshlrev_b32 v144, 16, v146
    v_and_b32 v145, 0xffff0000, v146
    v_mul_f32 v144, v144, v24
    v_mul_f32 v145, v145, v25
    v_cvt_pk_bf16_f32 v146, v144, v145
    v_lshlrev_b32 v144, 16, v146
    v_and_b32 v145, 0xffff0000, v146
    v_lshlrev_b32 v147, 16, v140
    v_and_b32 v148, 0xffff0000, v140
    v_add_f32 v144, v144, v147
    v_add_f32 v145, v145, v148
    v_cvt_pk_bf16_f32 v156, v144, v145
    v_cvt_pk_bf16_f32 v144, v26, v27
    v_cvt_pk_bf16_f32 v145, v42, v43
    v_lshlrev_b32 v26, 16, v144
    v_and_b32 v27, 0xffff0000, v144
    v_lshlrev_b32 v42, 16, v145
    v_and_b32 v43, 0xffff0000, v145
    v_mul_f32 v144, s33, v42
    v_mul_f32 v145, s33, v43
    v_exp_f32 v144, v144
    v_exp_f32 v145, v145
    v_add_f32 v144, 1.0, v144
    v_add_f32 v145, 1.0, v145
    v_rcp_f32 v144, v144
    v_rcp_f32 v145, v145
    v_mul_f32 v144, v42, v144
    v_mul_f32 v145, v43, v145
    v_cvt_pk_bf16_f32 v146, v144, v145
    v_lshlrev_b32 v144, 16, v146
    v_and_b32 v145, 0xffff0000, v146
    v_mul_f32 v144, v144, v26
    v_mul_f32 v145, v145, v27
    v_cvt_pk_bf16_f32 v146, v144, v145
    v_lshlrev_b32 v144, 16, v146
    v_and_b32 v145, 0xffff0000, v146
    v_lshlrev_b32 v147, 16, v141
    v_and_b32 v148, 0xffff0000, v141
    v_add_f32 v144, v144, v147
    v_add_f32 v145, v145, v148
    v_cvt_pk_bf16_f32 v157, v144, v145
    v_cvt_pk_bf16_f32 v144, v28, v29
    v_cvt_pk_bf16_f32 v145, v44, v45
    v_lshlrev_b32 v28, 16, v144
    v_and_b32 v29, 0xffff0000, v144
    v_lshlrev_b32 v44, 16, v145
    v_and_b32 v45, 0xffff0000, v145
    v_mul_f32 v144, s33, v44
    v_mul_f32 v145, s33, v45
    v_exp_f32 v144, v144
    v_exp_f32 v145, v145
    v_add_f32 v144, 1.0, v144
    v_add_f32 v145, 1.0, v145
    v_rcp_f32 v144, v144
    v_rcp_f32 v145, v145
    v_mul_f32 v144, v44, v144
    v_mul_f32 v145, v45, v145
    v_cvt_pk_bf16_f32 v146, v144, v145
    v_lshlrev_b32 v144, 16, v146
    v_and_b32 v145, 0xffff0000, v146
    v_mul_f32 v144, v144, v28
    v_mul_f32 v145, v145, v29
    v_cvt_pk_bf16_f32 v146, v144, v145
    v_lshlrev_b32 v144, 16, v146
    v_and_b32 v145, 0xffff0000, v146
    v_lshlrev_b32 v147, 16, v142
    v_and_b32 v148, 0xffff0000, v142
    v_add_f32 v144, v144, v147
    v_add_f32 v145, v145, v148
    v_cvt_pk_bf16_f32 v158, v144, v145
    v_cvt_pk_bf16_f32 v144, v30, v31
    v_cvt_pk_bf16_f32 v145, v46, v47
    v_lshlrev_b32 v30, 16, v144
    v_and_b32 v31, 0xffff0000, v144
    v_lshlrev_b32 v46, 16, v145
    v_and_b32 v47, 0xffff0000, v145
    v_mul_f32 v144, s33, v46
    v_mul_f32 v145, s33, v47
    v_exp_f32 v144, v144
    v_exp_f32 v145, v145
    v_add_f32 v144, 1.0, v144
    v_add_f32 v145, 1.0, v145
    v_rcp_f32 v144, v144
    v_rcp_f32 v145, v145
    v_mul_f32 v144, v46, v144
    v_mul_f32 v145, v47, v145
    v_cvt_pk_bf16_f32 v146, v144, v145
    v_lshlrev_b32 v144, 16, v146
    v_and_b32 v145, 0xffff0000, v146
    v_mul_f32 v144, v144, v30
    v_mul_f32 v145, v145, v31
    v_cvt_pk_bf16_f32 v146, v144, v145
    v_lshlrev_b32 v144, 16, v146
    v_and_b32 v145, 0xffff0000, v146
    v_lshlrev_b32 v147, 16, v143
    v_and_b32 v148, 0xffff0000, v143
    v_add_f32 v144, v144, v147
    v_add_f32 v145, v145, v148
    v_cvt_pk_bf16_f32 v159, v144, v145
    buffer_store_dwordx4 v[152:155], v6, s[40:43], 0 offen
    buffer_store_dwordx4 v[156:159], v6, s[40:43], 0 offen offset:32
    s_waitcnt vmcnt(0)
    s_nop 0
L_k3_end:
    s_endpgm
.section .rodata,"a"
.p2align 6
.amdhsa_kernel k0_ln_kernel
  .amdhsa_next_free_vgpr 38
  .amdhsa_next_free_sgpr 16
  .amdhsa_accum_offset 40
  .amdhsa_group_segment_fixed_size 0
  .amdhsa_kernarg_size 80
  .amdhsa_user_sgpr_count 2
  .amdhsa_user_sgpr_kernarg_segment_ptr 1
  .amdhsa_system_sgpr_workgroup_id_x 1
.end_amdhsa_kernel
.p2align 6
.amdhsa_kernel k1_proj_kernel
  .amdhsa_next_free_vgpr 356
  .amdhsa_next_free_sgpr 48
  .amdhsa_accum_offset 228
  .amdhsa_group_segment_fixed_size 0
  .amdhsa_kernarg_size 80
  .amdhsa_user_sgpr_count 2
  .amdhsa_user_sgpr_kernarg_segment_ptr 1
  .amdhsa_system_sgpr_workgroup_id_x 1
.end_amdhsa_kernel
.p2align 6
.amdhsa_kernel k2_attn_kernel
  .amdhsa_next_free_vgpr 240
  .amdhsa_next_free_sgpr 85
  .amdhsa_accum_offset 240
  .amdhsa_group_segment_fixed_size 0
  .amdhsa_kernarg_size 80
  .amdhsa_user_sgpr_count 2
  .amdhsa_user_sgpr_kernarg_segment_ptr 1
  .amdhsa_system_sgpr_workgroup_id_x 1
.end_amdhsa_kernel
.p2align 6
.amdhsa_kernel k3_out_kernel
  .amdhsa_next_free_vgpr 160
  .amdhsa_next_free_sgpr 45
  .amdhsa_accum_offset 160
  .amdhsa_group_segment_fixed_size 0
  .amdhsa_kernarg_size 80
  .amdhsa_user_sgpr_count 2
  .amdhsa_user_sgpr_kernarg_segment_ptr 1
  .amdhsa_system_sgpr_workgroup_id_x 1
.end_amdhsa_kernel
```
